```python
import torch

def _softmax(x, axis=-1):
    return torch.softmax(x, dim=axis)
def _gelu(x):
    return torch.nn.functional.gelu(x, approximate="tanh")
def _silu(x):
    return torch.nn.functional.silu(x)
def _sigmoid(x):
    return torch.sigmoid(x)
def _layernorm(x, axis=-1, eps=1e-5):
    m = x.mean(dim=axis, keepdim=True)
    v = x.var(dim=axis, keepdim=True, unbiased=False)
    return (x - m) / torch.sqrt(v + eps)
def _scatter_add(tgt, idx, src, axis=0):
    return tgt.clone().index_add_(axis, idx, src)
def _segment_sum(src, seg, n):
    out = torch.zeros((n,) + src.shape[1:], dtype=src.dtype)
    return out.index_add_(0, seg, src)
def _pad(x, pw):
    flat = tuple(v for pair in reversed(pw) for v in pair)
    return torch.nn.functional.pad(x, flat)

kernel_name = 'gated_mix__softmax_full_mha__glu_gated_geglu__prompt'

def setup_inputs():

    _w = (lambda a: (lambda t: t.to(torch.bfloat16) if t.is_floating_point() else t)(torch.as_tensor(a)))
    def _A_setup():
        B, S, D = 1, 2048, 512
        return {
            "x": _w((lambda *s: torch.randn(*s, dtype=torch.bfloat16) * 0.05)(B, S, D)),
            "wqkv": _w((lambda *s: torch.randn(*s, dtype=torch.bfloat16) * 0.8)(D, 3 * D)),
            "wo": _w((lambda *s: torch.randn(*s, dtype=torch.bfloat16) * 0.05)(D, D)),
        }
    _A_in = _A_setup()

    def _B_setup():
        B, S, Dm, Df = 1, 2048, 512, 1376
        return {
            "x": _w((lambda *s: torch.randn(*s, dtype=torch.bfloat16) * 0.05)(B, S, Dm)),
            "w_gate": _w((lambda *s: torch.randn(*s, dtype=torch.bfloat16) * 3.2)(Dm, Df) * (Dm ** -0.5)),
            "w_up": _w((lambda *s: torch.randn(*s, dtype=torch.bfloat16) * 3.2)(Dm, Df) * (Dm ** -0.5)),
            "w_down": _w((lambda *s: torch.randn(*s, dtype=torch.bfloat16) * 3.2)(Df, Dm) * (Df ** -0.5)),
        }
    _B_in = _B_setup()

    return {
        "A_x": _A_in["x"],
        "A_wqkv": _A_in["wqkv"],
        "A_wo": _A_in["wo"],
        "B_x": _B_in["x"],
        "B_w_gate": _B_in["w_gate"],
        "B_w_up": _B_in["w_up"],
        "B_w_down": _B_in["w_down"],
        "gate_w": _w((lambda *s: torch.randn(*s, dtype=torch.bfloat16) * 0.05)(512) * 16.0),
    }

def reference(A_x, A_wqkv, A_wo, B_x, B_w_gate, B_w_up, B_w_down, gate_w):
    def _A_ref(x, wqkv, wo):
        B, S, D = x.shape
        H = 32; Dh = D // H
        qkv = (lambda x, *d: x.permute(*d))((x @ wqkv).reshape(B, S, 3, H, Dh), 2, 0, 3, 1, 4)
        q, k, v = qkv[0], qkv[1], qkv[2]
        scale = Dh ** -0.5
        scores = torch.einsum("bhqd,bhkd->bhqk", q, k) * scale
        p = _softmax(scores, axis=-1)
        o = torch.einsum("bhqk,bhkd->bhqd", p, v)
        return (lambda x, *d: x.permute(*d))(o, 0, 2, 1, 3).reshape(B, S, D) @ wo

    def _B_ref(x, w_gate, w_up, w_down):
        g = torch.einsum("bsd,df->bsf", x, w_gate)
        u = torch.einsum("bsd,df->bsf", x, w_up)
        h = _gelu(g) * u
        return torch.einsum("bsf,fd->bsd", h, w_down)

    x = A_x
    g = _sigmoid((x * gate_w).sum(-1, keepdims=True))
    a = _A_ref(x, A_wqkv, A_wo)
    b = _B_ref(x, B_w_gate, B_w_up, B_w_down)
    return g * a + (1 - g) * b
```

```asm
; @launch grid=(256,1,1) block=(512,1,1) lds=163840
.amdgcn_target "amdgcn-amd-amdhsa--gfx950"
.text
.globl gated_mix__softmax_full_mha__glu_gated_geglu__prompt_kernel
.p2align 8
.type gated_mix__softmax_full_mha__glu_gated_geglu__prompt_kernel,@function
gated_mix__softmax_full_mha__glu_gated_geglu__prompt_kernel:
    s_cmp_ge_u32 s2, 256
    s_cbranch_scc1 Lexit
    s_load_dwordx2 s[4:5], s[0:1], 0
    s_load_dwordx2 s[8:9], s[0:1], 8
    s_getpc_b64 s[68:69]
Lpfbase:
    s_lshr_b32 s70, s2, 3
    s_lshl_b32 s70, s70, 11
    v_lshl_add_u32 v16, v0, 2, s70
    v_min_u32 v16, Lcode_end-Lpfbase-4, v16
    v_lshrrev_b32 v2, 6, v0
    s_mov_b32 exec_lo, 1
    s_mov_b32 exec_hi, 1
    global_load_dword v120, v16, s[68:69]
    s_mov_b64 exec, -1
    v_and_b32 v0, 63, v0
    v_readfirstlane_b32 s44, v2
    s_nop 0
    s_xor_b32 s44, s44, 4
    s_and_b32 s45, s44, 3
    s_lshr_b32 s46, s44, 2
    s_cbranch_scc1 Lload
    s_bitcmp1_b32 s2, 3
    s_cbranch_scc1 Lcomp1
    s_branch Lcomp0
Lload:
    s_and_b32 s48, s2, 4
    s_lshl_b32 s48, s48, 1
    s_lshr_b32 s74, s2, 5
    s_add_u32 s48, s48, s74
    s_mul_i32 s73, s2, 1
    s_add_u32 s73, s73, s48
    s_and_b32 s73, s73, 3
    s_mul_i32 s73, s73, 2
    v_lshrrev_b32 v16, 3, v0
    v_lshrrev_b32 v17, 4, v0
    v_and_b32 v18, 7, v0
    v_xor_b32 v18, v18, v17
    v_lshlrev_b32 v18, 4, v18
    v_lshl_add_u32 v2, v16, 10, v18
    v_xor_b32 v3, 64, v2
    v_add_u32 v3, 8192, v3
    s_lshl_b32 s52, s48, 2
    s_add_u32 s52, s52, s45
    s_lshl_b32 s52, s52, 8
    s_add_u32 s52, s52, s73
    s_lshl_b32 s52, s52, 7
    s_lshl_b32 s55, s45, 12
    s_mov_b32 s6, 2097152
    s_mov_b32 s7, 0x20000
    s_waitcnt lgkmcnt(0)
    s_add_u32 m0, s55, 4096
    s_nop 0
    buffer_load_dwordx4 v2, s[4:7], s52 offen lds
    s_add_u32 m0, s55, 5120
    s_add_u32 s79, s52, 16384
    buffer_load_dwordx4 v3, s[4:7], s52 offen lds
    s_add_u32 m0, s55, 6144
    s_nop 0
    buffer_load_dwordx4 v2, s[4:7], s79 offen lds
    s_add_u32 m0, s55, 7168
    s_nop 0
    buffer_load_dwordx4 v3, s[4:7], s79 offen lds
    s_and_b32 s47, s2, 3
    s_lshl_b32 s47, s47, 2
    s_bfe_u32 s74, s2, 0x20003
    s_add_u32 s47, s47, s74
    s_mov_b32 s10, 1572864
    s_mov_b32 s11, 0x20000
    v_lshrrev_b32 v16, 4, v0
    v_and_b32 v16, 2, v16
    v_xor_b32 v16, v16, v0
    v_and_b32 v16, 3, v16
    v_lshrrev_b32 v4, 2, v0
    v_mul_u32_u24 v4, 3072, v4
    v_lshl_add_u32 v4, v16, 4, v4
    s_lshr_b32 s68, s47, 1
    s_and_b32 s69, s47, 1
    s_lshl_b32 s69, s69, 3
    s_add_u32 s68, s68, s69
    s_lshl_b32 s68, s68, 7
    s_lshl_b32 s53, s73, 2
    s_add_u32 s53, s53, s45
    s_mul_i32 s53, s53, 49152
    s_add_u32 s53, s53, s68
    s_addk_i32 s53, 1024
    s_lshl_b32 s56, s45, 11
    s_add_u32 m0, s56, 20480
    s_nop 0
    buffer_load_dwordx4 v4, s[8:11], s53 offen lds
    s_add_u32 m0, s56, 21440
    s_nop 0
    buffer_load_dwordx4 v4, s[8:11], s53 offen offset:64 lds
    s_load_dwordx2 s[80:81], s[0:1], 32
    s_load_dwordx2 s[12:13], s[0:1], 40
    s_load_dwordx2 s[40:41], s[0:1], 56
    s_load_dwordx2 s[36:37], s[0:1], 72
    s_load_dwordx2 s[16:17], s[0:1], 80
    s_load_dwordx2 s[20:21], s[0:1], 80
    s_load_dwordx2 s[24:25], s[0:1], 48
    s_load_dwordx2 s[28:29], s[0:1], 16
    s_load_dwordx2 s[32:33], s[0:1], 64
    v_lshlrev_b32 v1, 4, v0
    s_add_u32 m0, s55, 32768
    s_add_u32 s52, s52, 128
    buffer_load_dwordx4 v2, s[4:7], s52 offen lds
    s_add_u32 m0, s55, 33792
    s_add_u32 s79, s52, 16384
    buffer_load_dwordx4 v3, s[4:7], s52 offen lds
    s_add_u32 m0, s55, 34816
    s_nop 0
    buffer_load_dwordx4 v2, s[4:7], s79 offen lds
    s_add_u32 m0, s55, 35840
    s_nop 0
    buffer_load_dwordx4 v3, s[4:7], s79 offen lds
    s_add_u32 m0, s56, 49152
    s_add_u32 s53, s53, 196608
    buffer_load_dwordx4 v4, s[8:11], s53 offen lds
    s_add_u32 m0, s56, 50112
    s_nop 0
    buffer_load_dwordx4 v4, s[8:11], s53 offen offset:64 lds
    v_and_b32 v16, 15, v0
    s_lshl_b32 s74, s45, 12
    v_lshrrev_b32 v17, 4, v0
    v_lshrrev_b32 v18, 1, v16
    v_xor_b32 v18, v18, v17
    v_lshlrev_b32 v18, 4, v18
    v_lshl_add_u32 v18, v16, 7, v18
    v_add_u32 v6, s74, v18
    v_xor_b32 v7, 64, v6
    s_mov_b32 s42, 1024
    s_mov_b32 s43, 0x20000
    s_lshl_b32 s69, s45, 8
    s_lshl_b32 s68, s73, 7
    s_add_u32 s68, s68, s69
    v_add_u32 v16, s68, v1
    s_add_u32 m0, s69, 0
    v_and_b32 v16, 1023, v16
    s_waitcnt lgkmcnt(0)
    s_mov_b64 exec, 0xffff
    buffer_load_dwordx4 v16, s[40:43], 0 offen lds
    s_mov_b64 exec, -1
    s_mov_b32 s38, 256
    s_mov_b32 s39, 0x20000
    s_mov_b32 s14, 1409024
    s_mov_b32 s15, 0x20000
    s_mov_b32 s82, 1409024
    s_mov_b32 s83, 0x20000
    s_mov_b32 s18, 15728640
    s_mov_b32 s19, 0x20000
    s_mov_b32 s22, 176128
    s_mov_b32 s23, 0x20000
    s_mov_b32 s26, 1409024
    s_mov_b32 s27, 0x20000
    s_mov_b32 s30, 524288
    s_mov_b32 s31, 0x20000
    s_mov_b32 s34, 2097152
    s_mov_b32 s35, 0x20000
    s_and_b32 s68, s47, 12
    s_lshr_b32 s68, 49284, s68
    s_and_b32 s68, s68, 12
    s_and_b32 s87, s47, 3
    s_add_u32 s87, s87, s68
    s_min_u32 s68, s87, 6
    s_mul_i32 s51, s87, 5
    s_add_u32 s51, s51, s68
    s_lshl_b32 s69, s73, 2
    s_add_u32 s69, s69, s45
    s_mul_i32 s54, s69, 44032
    s_lshr_b32 s68, s51, 1
    s_lshl_b32 s68, s68, 6
    s_add_u32 s54, s54, s68
    s_mul_i32 s78, s69, 49152
    s_lshl_b32 s68, s47, 6
    s_add_u32 s78, s78, s68
    s_and_b32 s3, s45, 0
    s_add_u32 s3, s3, s45
    s_mul_i32 s3, s3, 3072
    s_lshl_b32 s57, s45, 10
    v_lshrrev_b32 v14, 4, v0
    v_and_b32 v14, 2, v14
    v_xor_b32 v14, v14, v0
    v_and_b32 v14, 3, v14
    v_lshrrev_b32 v5, 2, v0
    v_mul_u32_u24 v5, 2752, v5
    v_lshl_add_u32 v5, v14, 4, v5
    v_lshrrev_b32 v15, 5, v0
    v_mul_u32_u24 v15, 3072, v15
    v_bfe_u32 v14, v0, 4, 1
    v_mul_u32_u24 v14, 544, v14
    v_add_u32 v15, v15, v14
    v_bfe_u32 v14, v0, 2, 2
    s_add_u32 m0, s55, 61440
    s_cmp_eq_u32 s73, 6
    s_cselect_b32 s74, -7, 1
    s_mul_i32 s74, s74, 128
    s_add_u32 s52, s52, s74
    buffer_load_dwordx4 v2, s[4:7], s52 offen lds
    s_add_u32 m0, s55, 62464
    s_add_u32 s79, s52, 16384
    buffer_load_dwordx4 v3, s[4:7], s52 offen lds
    s_add_u32 m0, s55, 63488
    s_nop 0
    buffer_load_dwordx4 v2, s[4:7], s79 offen lds
    s_add_u32 m0, s55, 64512
    s_nop 0
    buffer_load_dwordx4 v3, s[4:7], s79 offen lds
    s_add_u32 m0, s56, 77824
    s_cmp_eq_u32 s73, 6
    s_cselect_b32 s74, -7, 1
    s_mul_i32 s74, s74, 196608
    s_add_u32 s53, s53, s74
    buffer_load_dwordx4 v4, s[8:11], s53 offen lds
    s_add_u32 m0, s56, 78784
    s_nop 0
    buffer_load_dwordx4 v4, s[8:11], s53 offen offset:64 lds
    s_waitcnt vmcnt(13)
    s_barrier
    s_add_u32 m0, s55, 90112
    s_add_u32 s52, s52, 128
    buffer_load_dwordx4 v2, s[4:7], s52 offen lds
    s_add_u32 m0, s55, 91136
    s_add_u32 s79, s52, 16384
    buffer_load_dwordx4 v3, s[4:7], s52 offen lds
    s_add_u32 m0, s55, 92160
    s_nop 0
    buffer_load_dwordx4 v2, s[4:7], s79 offen lds
    ds_read_b128 v[128:131], v6 offset:4096
    ds_read_b128 v[132:135], v6 offset:6144
    ds_read_b128 v[136:139], v7 offset:4096
    ds_read_b128 v[140:143], v7 offset:6144
    v_lshl_add_u32 v15, v14, 6, v15
    v_and_b32 v14, 3, v0
    v_lshl_add_u32 v15, v14, 3, v15
    s_and_b32 s68, s51, 1
    s_add_u32 s68, s68, 0
    s_lshr_b32 s69, s68, 1
    s_lshl_b32 s69, s69, 10
    s_and_b32 s68, s68, 1
    s_lshl_b32 s68, s68, 5
    v_xor_b32 v9, s68, v15
    s_add_u32 m0, s55, 93184
    s_nop 0
    buffer_load_dwordx4 v3, s[4:7], s79 offen lds
    v_add_u32 v9, s69, v9
    s_and_b32 s68, s51, 1
    s_add_u32 s68, s68, 1
    s_lshr_b32 s69, s68, 1
    s_lshl_b32 s69, s69, 10
    s_and_b32 s68, s68, 1
    s_lshl_b32 s68, s68, 5
    v_xor_b32 v10, s68, v15
    v_add_u32 v10, s69, v10
    s_and_b32 s68, s51, 1
    s_add_u32 m0, s56, 106496
    s_add_u32 s53, s53, 196608
    buffer_load_dwordx4 v4, s[8:11], s53 offen lds
    s_add_u32 m0, s56, 107456
    s_nop 0
    buffer_load_dwordx4 v4, s[8:11], s53 offen offset:64 lds
    s_waitcnt vmcnt(12) lgkmcnt(0)
    s_barrier
    s_add_u32 m0, s55, 118784
    s_cmp_eq_u32 s73, 4
    s_cselect_b32 s74, -7, 1
    s_mul_i32 s74, s74, 128
    s_add_u32 s52, s52, s74
    buffer_load_dwordx4 v2, s[4:7], s52 offen lds
    s_add_u32 m0, s55, 119808
    s_add_u32 s79, s52, 16384
    buffer_load_dwordx4 v3, s[4:7], s52 offen lds
    s_add_u32 m0, s55, 120832
    s_nop 0
    buffer_load_dwordx4 v2, s[4:7], s79 offen lds
    ds_read_b128 v[144:147], v6 offset:32768
    ds_read_b128 v[148:151], v6 offset:34816
    ds_read_b128 v[152:155], v7 offset:32768
    ds_read_b128 v[156:159], v7 offset:34816
    s_add_u32 s68, s68, 2
    s_lshr_b32 s69, s68, 1
    s_lshl_b32 s69, s69, 10
    s_and_b32 s68, s68, 1
    s_lshl_b32 s68, s68, 5
    v_xor_b32 v11, s68, v15
    v_add_u32 v11, s69, v11
    v_lshrrev_b32 v14, 5, v0
    v_lshlrev_b32 v127, 11, v14
    v_sub_u32 v126, v15, v127
    s_add_u32 m0, s55, 121856
    s_nop 0
    buffer_load_dwordx4 v3, s[4:7], s79 offen lds
    v_xor_b32 v126, 32, v126
    s_and_b32 s49, s2, 7
    s_xor_b32 s49, s49, 4
    s_lshl_b32 s49, s49, 2
    s_lshr_b32 s68, s2, 6
    s_add_u32 s49, s49, s68
    s_mul_i32 s68, s49, 176128
    s_add_u32 s68, s68, 9437184
    s_add_u32 s20, s20, s68
    s_addc_u32 s21, s21, 0
    s_bfe_u32 s50, s2, 0x30003
    s_add_u32 m0, s56, 135168
    s_cmp_eq_u32 s73, 4
    s_cselect_b32 s74, -7, 1
    s_mul_i32 s74, s74, 196608
    s_add_u32 s53, s53, s74
    buffer_load_dwordx4 v4, s[8:11], s53 offen lds
    s_add_u32 m0, s56, 136128
    s_nop 0
    buffer_load_dwordx4 v4, s[8:11], s53 offen offset:64 lds
    s_waitcnt vmcnt(12) lgkmcnt(0)
    s_barrier
    s_add_u32 m0, s55, 4096
    s_add_u32 s52, s52, 128
    buffer_load_dwordx4 v2, s[4:7], s52 offen lds
    s_add_u32 m0, s55, 5120
    s_add_u32 s79, s52, 16384
    buffer_load_dwordx4 v3, s[4:7], s52 offen lds
    s_add_u32 m0, s55, 6144
    s_nop 0
    buffer_load_dwordx4 v2, s[4:7], s79 offen lds
    ds_read_b128 v[160:163], v6 offset:61440
    ds_read_b128 v[164:167], v6 offset:63488
    ds_read_b128 v[168:171], v7 offset:61440
    ds_read_b128 v[172:175], v7 offset:63488
    s_mov_b32 s66, 0xffff
    s_mov_b32 s67, 0xffff
    s_mov_b32 s76, 0xbdd2d3e8
    s_mov_b32 s77, s76
    v_and_b32 v127, 15, v0
    v_lshl_add_u32 v127, v14, 4, v127
    v_lshlrev_b32 v127, 4, v127
    s_lshl_b32 s68, s48, 2
    s_add_u32 s68, s68, s45
    s_lshr_b32 s63, s68, 1
    s_add_u32 m0, s55, 7168
    s_nop 0
    buffer_load_dwordx4 v3, s[4:7], s79 offen lds
    s_mul_i32 s63, s63, 86
    s_add_u32 s63, s63, s51
    s_lshl_b32 s63, s63, 1
    s_and_b32 s69, s68, 1
    s_add_u32 s63, s63, s69
    s_lshl_b32 s63, s63, 10
    s_add_u32 s63, s63, 9437184
    s_lshl_b32 s85, s68, 4
    s_add_u32 s85, s85, s47
    s_lshl_b32 s85, s85, 11
    s_add_u32 m0, s56, 20480
    s_add_u32 s53, s53, 196608
    buffer_load_dwordx4 v4, s[8:11], s53 offen lds
    s_add_u32 m0, s56, 21440
    s_nop 0
    buffer_load_dwordx4 v4, s[8:11], s53 offen offset:64 lds
    s_waitcnt vmcnt(12) lgkmcnt(0)
    s_barrier
    s_add_u32 m0, s55, 32768
    s_cmp_eq_u32 s73, 2
    s_cselect_b32 s74, -7, 1
    s_mul_i32 s74, s74, 128
    s_add_u32 s52, s52, s74
    buffer_load_dwordx4 v2, s[4:7], s52 offen lds
    s_add_u32 m0, s55, 33792
    s_add_u32 s79, s52, 16384
    buffer_load_dwordx4 v3, s[4:7], s52 offen lds
    s_add_u32 m0, s55, 34816
    s_nop 0
    buffer_load_dwordx4 v2, s[4:7], s79 offen lds
    v_add_u32 v6, 90112, v6
    v_add_u32 v7, 90112, v7
    ds_read_b128 v[176:179], v6 offset:0
    ds_read_b128 v[180:183], v6 offset:2048
    ds_read_b128 v[184:187], v7 offset:0
    ds_read_b128 v[188:191], v7 offset:2048
    s_add_u32 s85, s85, 6292480
    s_lshl_b32 s61, s47, 3
    s_add_u32 s61, s61, s44
    s_lshl_b32 s61, s61, 15
    s_add_u32 s61, s61, 2097152
    s_and_b32 s62, s48, 7
    s_lshl_b32 s62, s62, 12
    s_and_b32 s60, s47, 14
    s_lshl_b32 s60, s60, 2
    s_add_u32 s60, s60, s45
    s_add_u32 m0, s55, 35840
    s_nop 0
    buffer_load_dwordx4 v3, s[4:7], s79 offen lds
    s_lshl_b32 s60, s60, 9
    s_add_u32 s60, s60, 8388608
    s_add_u32 s40, s45, 1
    s_and_b32 s40, s40, 3
    s_lshl_b32 s40, s40, 10
    s_add_u32 s40, s40, 151552
    s_add_u32 s41, s45, 2
    s_and_b32 s41, s41, 3
    s_lshl_b32 s41, s41, 10
    s_add_u32 s41, s41, 151552
    s_add_u32 m0, s56, 49152
    s_cmp_eq_u32 s73, 2
    s_cselect_b32 s74, -7, 1
    s_mul_i32 s74, s74, 196608
    s_add_u32 s53, s53, s74
    buffer_load_dwordx4 v4, s[8:11], s53 offen lds
    s_add_u32 m0, s56, 50112
    s_nop 0
    buffer_load_dwordx4 v4, s[8:11], s53 offen offset:64 lds
    s_waitcnt vmcnt(12) lgkmcnt(0)
    s_barrier
    s_add_u32 m0, s55, 61440
    s_add_u32 s52, s52, 128
    buffer_load_dwordx4 v2, s[4:7], s52 offen lds
    s_add_u32 m0, s55, 62464
    s_add_u32 s79, s52, 16384
    buffer_load_dwordx4 v3, s[4:7], s52 offen lds
    s_add_u32 m0, s55, 63488
    s_nop 0
    buffer_load_dwordx4 v2, s[4:7], s79 offen lds
    ds_read_b128 v[192:195], v6 offset:28672
    ds_read_b128 v[196:199], v6 offset:30720
    ds_read_b128 v[200:203], v7 offset:28672
    ds_read_b128 v[204:207], v7 offset:30720
    s_add_u32 s42, s45, 3
    s_and_b32 s42, s42, 3
    s_lshl_b32 s42, s42, 10
    s_add_u32 s42, s42, 151552
    s_add_u32 s43, s45, 4
    s_and_b32 s43, s43, 3
    s_lshl_b32 s43, s43, 10
    s_add_u32 s43, s43, 151552
    s_mul_i32 s65, s44, 7168
    s_mul_i32 s64, s44, 180224
    s_add_u32 m0, s55, 64512
    s_nop 0
    buffer_load_dwordx4 v3, s[4:7], s79 offen lds
    s_lshl_b32 s68, s50, 7
    s_add_u32 s64, s64, s68
    v_bfe_u32 v12, v0, 2, 2
    v_lshl_add_u32 v12, v14, 3, v12
    v_lshlrev_b32 v12, 7, v12
    v_bfe_u32 v14, v0, 4, 1
    v_lshl_add_u32 v12, v14, 5, v12
    v_bfe_u32 v14, v0, 3, 1
    v_lshl_add_u32 v12, v14, 6, v12
    v_and_b32 v14, 3, v0
    s_add_u32 m0, s56, 77824
    s_add_u32 s53, s53, 196608
    buffer_load_dwordx4 v4, s[8:11], s53 offen lds
    s_add_u32 m0, s56, 78784
    s_nop 0
    buffer_load_dwordx4 v4, s[8:11], s53 offen offset:64 lds
    s_waitcnt vmcnt(12) lgkmcnt(0)
    s_barrier
    s_add_u32 m0, s57, 114688
    s_nop 0
    buffer_load_dwordx4 v4, s[8:11], s78 offen lds
    s_add_u32 m0, s3, 90112
    s_nop 0
    buffer_load_dwordx4 v5, s[80:83], s54 offen lds
    s_add_u32 m0, s3, 91072
    s_add_u32 s86, s54, 176128
    buffer_load_dwordx4 v5, s[80:83], s54 offen offset:64 lds
    v_subrev_u32 v6, 86016, v6
    v_subrev_u32 v7, 86016, v7
    ds_read_b128 v[208:211], v6 offset:0
    ds_read_b128 v[212:215], v6 offset:2048
    ds_read_b128 v[216:219], v7 offset:0
    ds_read_b128 v[220:223], v7 offset:2048
    v_lshl_add_u32 v12, v14, 3, v12
    v_add_u32 v12, s65, v12
    v_xor_b32 v13, 64, v12
    v_and_b32 v37, 27, v0
    v_cmp_eq_u32 vcc, 16, v37
    v_mov_b32 v37, 0x3f803f80
    s_nop 0
    v_cndmask_b32 v36, 0, v37, vcc
    v_mov_b32 v37, v36
    v_mov_b32 v38, v36
    v_mov_b32 v39, v36
    s_add_u32 m0, s3, 92032
    s_nop 0
    buffer_load_dwordx4 v5, s[80:83], s54 offen offset:128 lds
    v_mov_b32 v40, v36
    v_mov_b32 v41, v36
    v_mov_b32 v42, v36
    v_mov_b32 v43, v36
    v_mov_b32 v44, v36
    v_mov_b32 v45, v36
    v_mov_b32 v46, v36
    v_mov_b32 v47, v36
    v_mov_b32 v48, v36
    v_mov_b32 v49, v36
    s_add_u32 m0, s3, 102400
    s_nop 0
    buffer_load_dwordx4 v5, s[80:83], s86 offen lds
    s_add_u32 m0, s3, 103360
    s_nop 0
    buffer_load_dwordx4 v5, s[80:83], s86 offen offset:64 lds
    s_waitcnt vmcnt(12) lgkmcnt(0)
    s_barrier
    s_add_u32 m0, s3, 104320
    s_nop 0
    buffer_load_dwordx4 v5, s[80:83], s86 offen offset:128 lds
    s_add_u32 m0, s57, 143360
    s_add_u32 s78, s78, 196608
    buffer_load_dwordx4 v4, s[8:11], s78 offen lds
    ds_read_b128 v[224:227], v6 offset:28672
    ds_read_b128 v[228:231], v6 offset:30720
    ds_read_b128 v[232:235], v7 offset:28672
    ds_read_b128 v[236:239], v7 offset:30720
    buffer_load_dwordx2 v[116:117], off, s[36:39], 0 sc1
    v_mov_b32 v50, v36
    v_mov_b32 v51, v36
    s_waitcnt vmcnt(9) lgkmcnt(0)
    s_barrier
    s_add_u32 m0, s3, 118784
    s_cmp_eq_u32 s73, 6
    s_cselect_b32 s74, -3, 1
    s_mul_i32 s74, s74, 352256
    s_add_u32 s54, s54, s74
    buffer_load_dwordx4 v5, s[80:83], s54 offen lds
    s_add_u32 m0, s3, 119744
    s_add_u32 s86, s54, 176128
    buffer_load_dwordx4 v5, s[80:83], s54 offen offset:64 lds
    s_add_u32 m0, s3, 120704
    s_nop 0
    buffer_load_dwordx4 v5, s[80:83], s54 offen offset:128 lds
    ds_read_b128 v[240:243], v6 offset:57344
    ds_read_b128 v[244:247], v6 offset:59392
    ds_read_b128 v[248:251], v7 offset:57344
    ds_read_b128 v[252:255], v7 offset:59392
    s_add_u32 m0, s3, 131072
    s_nop 0
    buffer_load_dwordx4 v5, s[80:83], s86 offen lds
    s_add_u32 m0, s3, 132032
    s_nop 0
    buffer_load_dwordx4 v5, s[80:83], s86 offen offset:64 lds
    s_add_u32 m0, s3, 132992
    s_nop 0
    buffer_load_dwordx4 v5, s[80:83], s86 offen offset:128 lds
    s_waitcnt vmcnt(8) lgkmcnt(0)
    s_barrier
    v_add_u32 v9, 90112, v9
    v_add_u32 v10, 90112, v10
    v_add_u32 v11, 90112, v11
    v_add_u32 v126, 90112, v126
    ds_read_b64_tr_b16 v[16:17], v126 offset:24576
    ds_read_b64_tr_b16 v[18:19], v126 offset:24832
    ds_read_b64_tr_b16 v[20:21], v9 offset:0
    ds_read_b64_tr_b16 v[22:23], v9 offset:256
    ds_read_b64_tr_b16 v[24:25], v10 offset:0
    ds_read_b64_tr_b16 v[26:27], v10 offset:256
    ds_read_b64_tr_b16 v[28:29], v11 offset:0
    ds_read_b64_tr_b16 v[30:31], v11 offset:256
    s_waitcnt lgkmcnt(6)
    v_mfma_f32_16x16x32_bf16 v[52:55], v[16:19], v[128:131], 0
    ds_read_b64_tr_b16 v[32:33], v9 offset:6144
    s_add_u32 m0, s57, 28672
    s_cmp_eq_u32 s73, 6
    s_cselect_b32 s74, -7, 1
    s_mul_i32 s74, s74, 196608
    s_add_u32 s78, s78, s74
    v_mfma_f32_16x16x32_bf16 v[56:59], v[16:19], v[132:135], 0
    ds_read_b64_tr_b16 v[34:35], v9 offset:6400
    buffer_load_dwordx4 v4, s[8:11], s78 offen lds
    s_waitcnt lgkmcnt(6)
    v_mfma_f32_16x16x32_bf16 v[68:71], v[20:23], v[128:131], 0
    ds_read_b64_tr_b16 v[16:17], v10 offset:6144
    s_add_u32 m0, s3, 4096
    s_cmp_eq_u32 s73, 4
    s_cselect_b32 s74, -3, 1
    s_mul_i32 s74, s74, 352256
    s_add_u32 s54, s54, s74
    v_mfma_f32_16x16x32_bf16 v[72:75], v[20:23], v[132:135], 0
    ds_read_b64_tr_b16 v[18:19], v10 offset:6400
    buffer_load_dwordx4 v5, s[80:83], s54 offen lds
    s_waitcnt lgkmcnt(6)
    v_mfma_f32_16x16x32_bf16 v[84:87], v[24:27], v[128:131], 0
    ds_read_b64_tr_b16 v[20:21], v11 offset:6144
    s_add_u32 m0, s3, 5056
    s_add_u32 s86, s54, 176128
    v_mfma_f32_16x16x32_bf16 v[88:91], v[24:27], v[132:135], 0
    ds_read_b64_tr_b16 v[22:23], v11 offset:6400
    buffer_load_dwordx4 v5, s[80:83], s54 offen offset:64 lds
    s_waitcnt lgkmcnt(6)
    v_mfma_f32_16x16x32_bf16 v[100:103], v[28:31], v[128:131], 0
    ds_read_b64_tr_b16 v[24:25], v126 offset:26624
    v_mfma_f32_16x16x32_bf16 v[104:107], v[28:31], v[132:135], 0
    ds_read_b64_tr_b16 v[26:27], v126 offset:26880
    s_waitcnt lgkmcnt(6)
    v_mfma_f32_16x16x32_bf16 v[68:71], v[32:35], v[136:139], v[68:71]
    ds_read_b64_tr_b16 v[28:29], v9 offset:12288
    s_add_u32 m0, s3, 6016
    v_mfma_f32_16x16x32_bf16 v[72:75], v[32:35], v[140:143], v[72:75]
    ds_read_b64_tr_b16 v[30:31], v9 offset:12544
    buffer_load_dwordx4 v5, s[80:83], s54 offen offset:128 lds
    s_waitcnt lgkmcnt(6)
    v_mfma_f32_16x16x32_bf16 v[84:87], v[16:19], v[136:139], v[84:87]
    ds_read_b64_tr_b16 v[32:33], v10 offset:12288
    s_add_u32 m0, s3, 16384
    v_mfma_f32_16x16x32_bf16 v[88:91], v[16:19], v[140:143], v[88:91]
    ds_read_b64_tr_b16 v[34:35], v10 offset:12544
    buffer_load_dwordx4 v5, s[80:83], s86 offen lds
    s_waitcnt lgkmcnt(6)
    v_mfma_f32_16x16x32_bf16 v[100:103], v[20:23], v[136:139], v[100:103]
    ds_read_b64_tr_b16 v[16:17], v11 offset:12288
    v_mfma_f32_16x16x32_bf16 v[104:107], v[20:23], v[140:143], v[104:107]
    ds_read_b64_tr_b16 v[18:19], v11 offset:12544
    s_waitcnt lgkmcnt(6)
    v_mfma_f32_16x16x32_bf16 v[52:55], v[24:27], v[136:139], v[52:55]
    ds_read_b64_tr_b16 v[20:21], v9 offset:18432
    s_add_u32 m0, s3, 17344
    v_mfma_f32_16x16x32_bf16 v[56:59], v[24:27], v[140:143], v[56:59]
    ds_read_b64_tr_b16 v[22:23], v9 offset:18688
    buffer_load_dwordx4 v5, s[80:83], s86 offen offset:64 lds
    s_waitcnt lgkmcnt(6)
    v_mfma_f32_16x16x32_bf16 v[68:71], v[28:31], v[144:147], v[68:71]
    ds_read_b64_tr_b16 v[24:25], v10 offset:18432
    s_add_u32 m0, s3, 18304
    v_mfma_f32_16x16x32_bf16 v[72:75], v[28:31], v[148:151], v[72:75]
    ds_read_b64_tr_b16 v[26:27], v10 offset:18688
    buffer_load_dwordx4 v5, s[80:83], s86 offen offset:128 lds
    s_waitcnt lgkmcnt(6)
    v_mfma_f32_16x16x32_bf16 v[84:87], v[32:35], v[144:147], v[84:87]
    ds_read_b64_tr_b16 v[28:29], v11 offset:18432
    v_mfma_f32_16x16x32_bf16 v[88:91], v[32:35], v[148:151], v[88:91]
    ds_read_b64_tr_b16 v[30:31], v11 offset:18688
    s_waitcnt lgkmcnt(6)
    v_mfma_f32_16x16x32_bf16 v[100:103], v[16:19], v[144:147], v[100:103]
    s_waitcnt vmcnt(7)
    s_barrier
    ds_read_b64_tr_b16 v[32:33], v126 offset:53248
    s_lshl_b32 s68, s45, 8
    v_and_b32 v124, 15, v0
    v_mfma_f32_16x16x32_bf16 v[104:107], v[16:19], v[148:151], v[104:107]
    ds_read_b64_tr_b16 v[34:35], v126 offset:53504
    s_waitcnt lgkmcnt(6)
    v_mfma_f32_16x16x32_bf16 v[68:71], v[20:23], v[152:155], v[68:71]
    ds_read_b64_tr_b16 v[16:17], v9 offset:28672
    s_add_u32 m0, s57, 57344
    s_add_u32 s78, s78, 196608
    v_lshl_add_u32 v124, v124, 2, s68
    v_mfma_f32_16x16x32_bf16 v[72:75], v[20:23], v[156:159], v[72:75]
    ds_read_b64_tr_b16 v[18:19], v9 offset:28928
    buffer_load_dwordx4 v4, s[8:11], s78 offen lds
    s_waitcnt lgkmcnt(6)
    v_mfma_f32_16x16x32_bf16 v[84:87], v[24:27], v[152:155], v[84:87]
    ds_read_b64_tr_b16 v[20:21], v10 offset:28672
    v_add_u32 v124, 1024, v124
    ds_read2_b32 v[124:125], v124 offset0:0 offset1:16
    v_mfma_f32_16x16x32_bf16 v[88:91], v[24:27], v[156:159], v[88:91]
    ds_read_b64_tr_b16 v[22:23], v10 offset:28928
    s_waitcnt lgkmcnt(7)
    v_mfma_f32_16x16x32_bf16 v[100:103], v[28:31], v[152:155], v[100:103]
    ds_read_b64_tr_b16 v[24:25], v11 offset:28672
    s_add_u32 m0, s3, 32768
    s_cmp_eq_u32 s73, 2
    s_cselect_b32 s74, -3, 1
    s_mul_i32 s74, s74, 352256
    s_add_u32 s54, s54, s74
    v_cmp_eq_u32 vcc, 0, v117
    s_cbranch_vccnz Lnonr_1
Lnonc_2:
    v_readfirstlane_b32 s58, v116
    v_readfirstlane_b32 s59, v117
    v_mfma_f32_16x16x32_bf16 v[104:107], v[28:31], v[156:159], v[104:107]
    ds_read_b64_tr_b16 v[26:27], v11 offset:28928
    buffer_load_dwordx4 v5, s[80:83], s54 offen lds
    s_waitcnt lgkmcnt(7)
    v_mfma_f32_16x16x32_bf16 v[52:55], v[32:35], v[144:147], v[52:55]
    ds_read_b64_tr_b16 v[28:29], v9 offset:34816
    v_and_b32 v6, 4, v0
    v_mul_u32_u24 v6, 3, v6
    v_mfma_f32_16x16x32_bf16 v[56:59], v[32:35], v[148:151], v[56:59]
    ds_read_b64_tr_b16 v[30:31], v9 offset:35072
    s_waitcnt lgkmcnt(7)
    v_mfma_f32_16x16x32_bf16 v[68:71], v[16:19], v[160:163], v[68:71]
    ds_read_b64_tr_b16 v[32:33], v10 offset:34816
    s_add_u32 m0, s3, 33728
    s_add_u32 s86, s54, 176128
    v_add_u32 v6, v6, v0
    v_mfma_f32_16x16x32_bf16 v[72:75], v[16:19], v[164:167], v[72:75]
    ds_read_b64_tr_b16 v[34:35], v10 offset:35072
    buffer_load_dwordx4 v5, s[80:83], s54 offen offset:64 lds
    s_waitcnt lgkmcnt(6)
    v_mfma_f32_16x16x32_bf16 v[84:87], v[20:23], v[160:163], v[84:87]
    ds_read_b64_tr_b16 v[16:17], v11 offset:34816
    v_lshl_add_u32 v6, v6, 7, s60
    v_lshrrev_b32 v2, 3, v0
    v_mfma_f32_16x16x32_bf16 v[88:91], v[20:23], v[164:167], v[88:91]
    ds_read_b64_tr_b16 v[18:19], v11 offset:35072
    s_waitcnt lgkmcnt(6)
    v_mfma_f32_16x16x32_bf16 v[100:103], v[24:27], v[160:163], v[100:103]
    ds_read_b64_tr_b16 v[20:21], v126 offset:55296
    s_add_u32 m0, s3, 34688
    v_lshrrev_b32 v14, 2, v0
    v_mfma_f32_16x16x32_bf16 v[104:107], v[24:27], v[164:167], v[104:107]
    ds_read_b64_tr_b16 v[22:23], v126 offset:55552
    buffer_load_dwordx4 v5, s[80:83], s54 offen offset:128 lds
    s_waitcnt lgkmcnt(6)
    v_mfma_f32_16x16x32_bf16 v[68:71], v[28:31], v[168:171], v[68:71]
    ds_read_b64_tr_b16 v[24:25], v9 offset:40960
    v_and_b32 v14, 4, v14
    v_xor_b32 v14, v14, v0
    v_mfma_f32_16x16x32_bf16 v[72:75], v[28:31], v[172:175], v[72:75]
    ds_read_b64_tr_b16 v[26:27], v9 offset:41216
    s_waitcnt lgkmcnt(6)
    v_mfma_f32_16x16x32_bf16 v[84:87], v[32:35], v[168:171], v[84:87]
    ds_read_b64_tr_b16 v[28:29], v10 offset:40960
    s_add_u32 m0, s3, 45056
    v_and_b32 v14, 7, v14
    v_mfma_f32_16x16x32_bf16 v[88:91], v[32:35], v[172:175], v[88:91]
    ds_read_b64_tr_b16 v[30:31], v10 offset:41216
    buffer_load_dwordx4 v5, s[80:83], s86 offen lds
    s_waitcnt lgkmcnt(6)
    v_mfma_f32_16x16x32_bf16 v[100:103], v[16:19], v[168:171], v[100:103]
    ds_read_b64_tr_b16 v[32:33], v11 offset:40960
    v_lshlrev_b32 v14, 4, v14
    v_lshl_add_u32 v2, v2, 10, v14
    v_mfma_f32_16x16x32_bf16 v[104:107], v[16:19], v[172:175], v[104:107]
    ds_read_b64_tr_b16 v[34:35], v11 offset:41216
    s_waitcnt lgkmcnt(6)
    v_mfma_f32_16x16x32_bf16 v[52:55], v[20:23], v[152:155], v[52:55]
    ds_read_b64_tr_b16 v[16:17], v9 offset:47104
    s_add_u32 m0, s3, 46016
    v_add_u32 v3, 7168, v2
    v_mfma_f32_16x16x32_bf16 v[56:59], v[20:23], v[156:159], v[56:59]
    ds_read_b64_tr_b16 v[18:19], v9 offset:47360
    buffer_load_dwordx4 v5, s[80:83], s86 offen offset:64 lds
    s_waitcnt lgkmcnt(6)
    v_mfma_f32_16x16x32_bf16 v[68:71], v[24:27], v[176:179], v[68:71]
    ds_read_b64_tr_b16 v[20:21], v10 offset:47104
    v_add_u32 v7, s65, v1
    v_lshl_add_u32 v8, v0, 2, s65
    v_mfma_f32_16x16x32_bf16 v[72:75], v[24:27], v[180:183], v[72:75]
    ds_read_b64_tr_b16 v[22:23], v10 offset:47360
    s_waitcnt lgkmcnt(6)
    v_mfma_f32_16x16x32_bf16 v[84:87], v[28:31], v[176:179], v[84:87]
    ds_read_b64_tr_b16 v[24:25], v11 offset:47104
    s_add_u32 m0, s3, 46976
    v_mul_f32 v124, 0x3fb8aa3b, v124
    v_mfma_f32_16x16x32_bf16 v[88:91], v[28:31], v[180:183], v[88:91]
    ds_read_b64_tr_b16 v[26:27], v11 offset:47360
    buffer_load_dwordx4 v5, s[80:83], s86 offen offset:128 lds
    s_waitcnt lgkmcnt(6)
    v_mfma_f32_16x16x32_bf16 v[100:103], v[32:35], v[176:179], v[100:103]
    s_waitcnt vmcnt(7)
    s_barrier
    v_subrev_u32 v9, 86016, v9
    v_subrev_u32 v10, 86016, v10
    v_subrev_u32 v11, 86016, v11
    v_subrev_u32 v126, 86016, v126
    ds_read_b64_tr_b16 v[28:29], v126 offset:24576
    v_mul_f32 v125, 0x3fb8aa3b, v125
    v_exp_f32 v124, v124
    v_mfma_f32_16x16x32_bf16 v[104:107], v[32:35], v[180:183], v[104:107]
    ds_read_b64_tr_b16 v[30:31], v126 offset:24832
    s_waitcnt lgkmcnt(6)
    v_mfma_f32_16x16x32_bf16 v[68:71], v[16:19], v[184:187], v[68:71]
    ds_read_b64_tr_b16 v[32:33], v9 offset:0
    s_add_u32 m0, s57, 86016
    s_cmp_eq_u32 s73, 4
    s_cselect_b32 s74, -7, 1
    s_mul_i32 s74, s74, 196608
    s_add_u32 s78, s78, s74
    v_exp_f32 v125, v125
    v_mfma_f32_16x16x32_bf16 v[72:75], v[16:19], v[188:191], v[72:75]
    ds_read_b64_tr_b16 v[34:35], v9 offset:256
    buffer_load_dwordx4 v4, s[8:11], s78 offen lds
    s_waitcnt lgkmcnt(6)
    v_mfma_f32_16x16x32_bf16 v[84:87], v[20:23], v[184:187], v[84:87]
    ds_read_b64_tr_b16 v[16:17], v10 offset:0
    v_add_f32 v124, 1.0, v124
    v_add_f32 v125, 1.0, v125
    v_mfma_f32_16x16x32_bf16 v[88:91], v[20:23], v[188:191], v[88:91]
    ds_read_b64_tr_b16 v[18:19], v10 offset:256
    s_waitcnt lgkmcnt(6)
    v_mfma_f32_16x16x32_bf16 v[100:103], v[24:27], v[184:187], v[100:103]
    ds_read_b64_tr_b16 v[20:21], v11 offset:0
    s_add_u32 m0, s3, 61440
    s_cmp_eq_u32 s73, 0
    s_cselect_b32 s74, -3, 1
    s_mul_i32 s74, s74, 352256
    s_add_u32 s54, s54, s74
    v_mov_b32 v60, 0xc0135761
    v_mfma_f32_16x16x32_bf16 v[104:107], v[24:27], v[188:191], v[104:107]
    ds_read_b64_tr_b16 v[22:23], v11 offset:256
    buffer_load_dwordx4 v5, s[12:15], s54 offen lds
    s_waitcnt lgkmcnt(6)
    v_mfma_f32_16x16x32_bf16 v[52:55], v[28:31], v[160:163], v[52:55]
    ds_read_b64_tr_b16 v[24:25], v9 offset:6144
    v_mov_b32 v61, v60
    v_min_f32 v62, 0x71800000, v124
    v_mfma_f32_16x16x32_bf16 v[56:59], v[28:31], v[164:167], v[56:59]
    ds_read_b64_tr_b16 v[26:27], v9 offset:6400
    s_waitcnt lgkmcnt(6)
    v_mfma_f32_16x16x32_bf16 v[68:71], v[32:35], v[192:195], v[68:71]
    ds_read_b64_tr_b16 v[28:29], v10 offset:6144
    s_add_u32 m0, s3, 62400
    s_add_u32 s86, s54, 176128
    v_min_f32 v63, 0x71800000, v124
    v_mfma_f32_16x16x32_bf16 v[72:75], v[32:35], v[196:199], v[72:75]
    ds_read_b64_tr_b16 v[30:31], v10 offset:6400
    buffer_load_dwordx4 v5, s[12:15], s54 offen offset:64 lds
    s_waitcnt lgkmcnt(6)
    v_mfma_f32_16x16x32_bf16 v[84:87], v[16:19], v[192:195], v[84:87]
    ds_read_b64_tr_b16 v[32:33], v11 offset:6144
    v_min_f32 v64, 0x71800000, v125
    v_min_f32 v65, 0x71800000, v125
    v_mfma_f32_16x16x32_bf16 v[88:91], v[16:19], v[196:199], v[88:91]
    ds_read_b64_tr_b16 v[34:35], v11 offset:6400
    s_waitcnt lgkmcnt(6)
    v_mfma_f32_16x16x32_bf16 v[100:103], v[20:23], v[192:195], v[100:103]
    ds_read_b64_tr_b16 v[16:17], v126 offset:26624
    s_add_u32 m0, s3, 63360
    v_add_u32 v124, s61, v1
    v_mfma_f32_16x16x32_bf16 v[104:107], v[20:23], v[196:199], v[104:107]
    ds_read_b64_tr_b16 v[18:19], v126 offset:26880
    buffer_load_dwordx4 v5, s[12:15], s54 offen offset:128 lds
    s_waitcnt lgkmcnt(6)
    v_mfma_f32_16x16x32_bf16 v[68:71], v[24:27], v[200:203], v[68:71]
    ds_read_b64_tr_b16 v[20:21], v9 offset:12288
    v_add_u32 v125, s61, v127
    v_mfma_f32_16x16x32_bf16 v[72:75], v[24:27], v[204:207], v[72:75]
    ds_read_b64_tr_b16 v[22:23], v9 offset:12544
    s_waitcnt lgkmcnt(6)
    v_mfma_f32_16x16x32_bf16 v[84:87], v[28:31], v[200:203], v[84:87]
    ds_read_b64_tr_b16 v[24:25], v10 offset:12288
    s_add_u32 m0, s3, 73728
    v_mfma_f32_16x16x32_bf16 v[88:91], v[28:31], v[204:207], v[88:91]
    ds_read_b64_tr_b16 v[26:27], v10 offset:12544
    buffer_load_dwordx4 v5, s[12:15], s86 offen lds
    s_waitcnt lgkmcnt(6)
    v_mfma_f32_16x16x32_bf16 v[100:103], v[32:35], v[200:203], v[100:103]
    ds_read_b64_tr_b16 v[28:29], v11 offset:12288
    v_mfma_f32_16x16x32_bf16 v[104:107], v[32:35], v[204:207], v[104:107]
    ds_read_b64_tr_b16 v[30:31], v11 offset:12544
    s_waitcnt lgkmcnt(6)
    v_mfma_f32_16x16x32_bf16 v[52:55], v[16:19], v[168:171], v[52:55]
    ds_read_b64_tr_b16 v[32:33], v9 offset:18432
    s_add_u32 m0, s3, 74688
    v_mfma_f32_16x16x32_bf16 v[56:59], v[16:19], v[172:175], v[56:59]
    ds_read_b64_tr_b16 v[34:35], v9 offset:18688
    buffer_load_dwordx4 v5, s[12:15], s86 offen offset:64 lds
    s_waitcnt lgkmcnt(6)
    v_mfma_f32_16x16x32_bf16 v[68:71], v[20:23], v[208:211], v[68:71]
    ds_read_b64_tr_b16 v[16:17], v10 offset:18432
    v_mfma_f32_16x16x32_bf16 v[72:75], v[20:23], v[212:215], v[72:75]
    ds_read_b64_tr_b16 v[18:19], v10 offset:18688
    s_waitcnt lgkmcnt(6)
    v_mfma_f32_16x16x32_bf16 v[84:87], v[24:27], v[208:211], v[84:87]
    ds_read_b64_tr_b16 v[20:21], v11 offset:18432
    s_add_u32 m0, s3, 75648
    v_mfma_f32_16x16x32_bf16 v[88:91], v[24:27], v[212:215], v[88:91]
    ds_read_b64_tr_b16 v[22:23], v11 offset:18688
    buffer_load_dwordx4 v5, s[12:15], s86 offen offset:128 lds
    s_waitcnt lgkmcnt(6)
    v_mfma_f32_16x16x32_bf16 v[100:103], v[28:31], v[208:211], v[100:103]
    s_waitcnt vmcnt(7)
    s_barrier
    ds_read_b64_tr_b16 v[24:25], v126 offset:53248
    v_mfma_f32_16x16x32_bf16 v[104:107], v[28:31], v[212:215], v[104:107]
    ds_read_b64_tr_b16 v[26:27], v126 offset:53504
    s_waitcnt lgkmcnt(6)
    v_mfma_f32_16x16x32_bf16 v[68:71], v[32:35], v[216:219], v[68:71]
    ds_read_b64_tr_b16 v[28:29], v9 offset:28672
    s_add_u32 m0, s57, 114688
    s_add_u32 s78, s78, 196608
    v_mfma_f32_16x16x32_bf16 v[72:75], v[32:35], v[220:223], v[72:75]
    ds_read_b64_tr_b16 v[30:31], v9 offset:28928
    buffer_load_dwordx4 v4, s[8:11], s78 offen lds
    s_waitcnt lgkmcnt(6)
    v_mfma_f32_16x16x32_bf16 v[84:87], v[16:19], v[216:219], v[84:87]
    ds_read_b64_tr_b16 v[32:33], v10 offset:28672
    v_mfma_f32_16x16x32_bf16 v[88:91], v[16:19], v[220:223], v[88:91]
    ds_read_b64_tr_b16 v[34:35], v10 offset:28928
    s_waitcnt lgkmcnt(6)
    v_mfma_f32_16x16x32_bf16 v[100:103], v[20:23], v[216:219], v[100:103]
    ds_read_b64_tr_b16 v[16:17], v11 offset:28672
    s_add_u32 m0, s3, 90112
    s_cmp_eq_u32 s73, 6
    s_cselect_b32 s74, -3, 1
    s_mul_i32 s74, s74, 352256
    s_add_u32 s54, s54, s74
    v_mfma_f32_16x16x32_bf16 v[104:107], v[20:23], v[220:223], v[104:107]
    ds_read_b64_tr_b16 v[18:19], v11 offset:28928
    buffer_load_dwordx4 v5, s[12:15], s54 offen lds
    s_waitcnt lgkmcnt(6)
    v_mfma_f32_16x16x32_bf16 v[52:55], v[24:27], v[176:179], v[52:55]
    ds_read_b64_tr_b16 v[20:21], v9 offset:34816
    v_mfma_f32_16x16x32_bf16 v[56:59], v[24:27], v[180:183], v[56:59]
    ds_read_b64_tr_b16 v[22:23], v9 offset:35072
    s_waitcnt lgkmcnt(6)
    v_mfma_f32_16x16x32_bf16 v[68:71], v[28:31], v[224:227], v[68:71]
    ds_read_b64_tr_b16 v[24:25], v10 offset:34816
    s_add_u32 m0, s3, 91072
    s_add_u32 s86, s54, 176128
    v_mfma_f32_16x16x32_bf16 v[72:75], v[28:31], v[228:231], v[72:75]
    ds_read_b64_tr_b16 v[26:27], v10 offset:35072
    buffer_load_dwordx4 v5, s[12:15], s54 offen offset:64 lds
    s_waitcnt lgkmcnt(6)
    v_mfma_f32_16x16x32_bf16 v[84:87], v[32:35], v[224:227], v[84:87]
    ds_read_b64_tr_b16 v[28:29], v11 offset:34816
    v_mfma_f32_16x16x32_bf16 v[88:91], v[32:35], v[228:231], v[88:91]
    ds_read_b64_tr_b16 v[30:31], v11 offset:35072
    s_waitcnt lgkmcnt(6)
    v_mfma_f32_16x16x32_bf16 v[100:103], v[16:19], v[224:227], v[100:103]
    ds_read_b64_tr_b16 v[32:33], v126 offset:55296
    s_add_u32 m0, s3, 92032
    v_mfma_f32_16x16x32_bf16 v[104:107], v[16:19], v[228:231], v[104:107]
    ds_read_b64_tr_b16 v[34:35], v126 offset:55552
    buffer_load_dwordx4 v5, s[12:15], s54 offen offset:128 lds
    s_waitcnt lgkmcnt(6)
    v_mfma_f32_16x16x32_bf16 v[68:71], v[20:23], v[232:235], v[68:71]
    ds_read_b64_tr_b16 v[16:17], v9 offset:40960
    v_mfma_f32_16x16x32_bf16 v[72:75], v[20:23], v[236:239], v[72:75]
    ds_read_b64_tr_b16 v[18:19], v9 offset:41216
    s_waitcnt lgkmcnt(6)
    v_mfma_f32_16x16x32_bf16 v[84:87], v[24:27], v[232:235], v[84:87]
    ds_read_b64_tr_b16 v[20:21], v10 offset:40960
    s_add_u32 m0, s3, 102400
    v_mfma_f32_16x16x32_bf16 v[88:91], v[24:27], v[236:239], v[88:91]
    ds_read_b64_tr_b16 v[22:23], v10 offset:41216
    buffer_load_dwordx4 v5, s[12:15], s86 offen lds
    s_waitcnt lgkmcnt(6)
    v_mfma_f32_16x16x32_bf16 v[100:103], v[28:31], v[232:235], v[100:103]
    ds_read_b64_tr_b16 v[24:25], v11 offset:40960
    v_mfma_f32_16x16x32_bf16 v[104:107], v[28:31], v[236:239], v[104:107]
    ds_read_b64_tr_b16 v[26:27], v11 offset:41216
    s_waitcnt lgkmcnt(6)
    v_mfma_f32_16x16x32_bf16 v[52:55], v[32:35], v[184:187], v[52:55]
    ds_read_b64_tr_b16 v[28:29], v9 offset:47104
    s_add_u32 m0, s3, 103360
    v_mfma_f32_16x16x32_bf16 v[56:59], v[32:35], v[188:191], v[56:59]
    ds_read_b64_tr_b16 v[30:31], v9 offset:47360
    buffer_load_dwordx4 v5, s[12:15], s86 offen offset:64 lds
    s_waitcnt lgkmcnt(6)
    v_mfma_f32_16x16x32_bf16 v[68:71], v[16:19], v[240:243], v[68:71]
    ds_read_b64_tr_b16 v[32:33], v10 offset:47104
    v_mfma_f32_16x16x32_bf16 v[72:75], v[16:19], v[244:247], v[72:75]
    ds_read_b64_tr_b16 v[34:35], v10 offset:47360
    s_waitcnt lgkmcnt(6)
    v_mfma_f32_16x16x32_bf16 v[84:87], v[20:23], v[240:243], v[84:87]
    ds_read_b64_tr_b16 v[16:17], v11 offset:47104
    s_add_u32 m0, s3, 104320
    v_mfma_f32_16x16x32_bf16 v[88:91], v[20:23], v[244:247], v[88:91]
    ds_read_b64_tr_b16 v[18:19], v11 offset:47360
    buffer_load_dwordx4 v5, s[12:15], s86 offen offset:128 lds
    s_waitcnt lgkmcnt(6)
    v_mfma_f32_16x16x32_bf16 v[100:103], v[24:27], v[240:243], v[100:103]
    s_waitcnt vmcnt(7)
    s_barrier
    v_add_u32 v9, 57344, v9
    v_add_u32 v10, 57344, v10
    v_add_u32 v11, 57344, v11
    v_add_u32 v126, 57344, v126
    ds_read_b64_tr_b16 v[20:21], v126 offset:24576
    v_mfma_f32_16x16x32_bf16 v[104:107], v[24:27], v[244:247], v[104:107]
    ds_read_b64_tr_b16 v[22:23], v126 offset:24832
    s_waitcnt lgkmcnt(6)
    v_mfma_f32_16x16x32_bf16 v[68:71], v[28:31], v[248:251], v[68:71]
    ds_read_b64_tr_b16 v[24:25], v9 offset:0
    s_add_u32 m0, s57, 143360
    s_cmp_eq_u32 s73, 2
    s_cselect_b32 s74, -7, 1
    s_mul_i32 s74, s74, 196608
    s_add_u32 s78, s78, s74
    v_mfma_f32_16x16x32_bf16 v[72:75], v[28:31], v[252:255], v[72:75]
    ds_read_b64_tr_b16 v[26:27], v9 offset:256
    buffer_load_dwordx4 v4, s[8:11], s78 offen lds
    s_waitcnt lgkmcnt(6)
    v_mfma_f32_16x16x32_bf16 v[84:87], v[32:35], v[248:251], v[84:87]
    ds_read_b64_tr_b16 v[28:29], v10 offset:0
    v_mfma_f32_16x16x32_bf16 v[88:91], v[32:35], v[252:255], v[88:91]
    ds_read_b64_tr_b16 v[30:31], v10 offset:256
    s_waitcnt lgkmcnt(6)
    v_mfma_f32_16x16x32_bf16 v[100:103], v[16:19], v[248:251], v[100:103]
    ds_read_b64_tr_b16 v[32:33], v11 offset:0
    s_add_u32 m0, s3, 118784
    s_cmp_eq_u32 s73, 4
    s_cselect_b32 s74, -3, 1
    s_mul_i32 s74, s74, 352256
    s_add_u32 s54, s54, s74
    v_mfma_f32_16x16x32_bf16 v[104:107], v[16:19], v[252:255], v[104:107]
    ds_read_b64_tr_b16 v[34:35], v11 offset:256
    buffer_load_dwordx4 v5, s[12:15], s54 offen lds
    s_waitcnt lgkmcnt(6)
    v_mfma_f32_16x16x32_bf16 v[52:55], v[20:23], v[192:195], v[52:55]
    ds_read_b64_tr_b16 v[16:17], v9 offset:6144
    v_mfma_f32_16x16x32_bf16 v[56:59], v[20:23], v[196:199], v[56:59]
    ds_read_b64_tr_b16 v[18:19], v9 offset:6400
    s_waitcnt lgkmcnt(6)
    v_mfma_f32_16x16x32_bf16 v[76:79], v[24:27], v[128:131], 0
    ds_read_b64_tr_b16 v[20:21], v10 offset:6144
    s_add_u32 m0, s3, 119744
    s_add_u32 s86, s54, 176128
    v_mfma_f32_16x16x32_bf16 v[80:83], v[24:27], v[132:135], 0
    ds_read_b64_tr_b16 v[22:23], v10 offset:6400
    buffer_load_dwordx4 v5, s[12:15], s54 offen offset:64 lds
    s_waitcnt lgkmcnt(6)
    v_mfma_f32_16x16x32_bf16 v[92:95], v[28:31], v[128:131], 0
    ds_read_b64_tr_b16 v[24:25], v11 offset:6144
    v_mfma_f32_16x16x32_bf16 v[96:99], v[28:31], v[132:135], 0
    ds_read_b64_tr_b16 v[26:27], v11 offset:6400
    s_setprio 3
    s_waitcnt lgkmcnt(6)
    v_mfma_f32_16x16x32_bf16 v[108:111], v[32:35], v[128:131], 0
    ds_read_b64_tr_b16 v[28:29], v126 offset:26624
    s_add_u32 m0, s3, 120704
    v_mfma_f32_16x16x32_bf16 v[112:115], v[32:35], v[132:135], 0
    ds_read_b64_tr_b16 v[30:31], v126 offset:26880
    buffer_load_dwordx4 v5, s[12:15], s54 offen offset:128 lds
    s_waitcnt lgkmcnt(6)
    v_mfma_f32_16x16x32_bf16 v[76:79], v[16:19], v[136:139], v[76:79]
    ds_read_b64_tr_b16 v[32:33], v9 offset:12288
    v_mfma_f32_16x16x32_bf16 v[80:83], v[16:19], v[140:143], v[80:83]
    ds_read_b64_tr_b16 v[34:35], v9 offset:12544
    s_waitcnt lgkmcnt(6)
    v_mfma_f32_16x16x32_bf16 v[92:95], v[20:23], v[136:139], v[92:95]
    ds_read_b64_tr_b16 v[16:17], v10 offset:12288
    s_add_u32 m0, s3, 131072
    v_mfma_f32_16x16x32_bf16 v[96:99], v[20:23], v[140:143], v[96:99]
    ds_read_b64_tr_b16 v[18:19], v10 offset:12544
    buffer_load_dwordx4 v5, s[12:15], s86 offen lds
    s_waitcnt lgkmcnt(6)
    v_mfma_f32_16x16x32_bf16 v[108:111], v[24:27], v[136:139], v[108:111]
    ds_read_b64_tr_b16 v[20:21], v11 offset:12288
    v_mfma_f32_16x16x32_bf16 v[112:115], v[24:27], v[140:143], v[112:115]
    ds_read_b64_tr_b16 v[22:23], v11 offset:12544
    s_waitcnt lgkmcnt(6)
    v_mfma_f32_16x16x32_bf16 v[52:55], v[28:31], v[200:203], v[52:55]
    ds_read_b64_tr_b16 v[24:25], v9 offset:18432
    s_add_u32 m0, s3, 132032
    v_mfma_f32_16x16x32_bf16 v[56:59], v[28:31], v[204:207], v[56:59]
    ds_read_b64_tr_b16 v[26:27], v9 offset:18688
    buffer_load_dwordx4 v5, s[12:15], s86 offen offset:64 lds
    s_waitcnt lgkmcnt(6)
    v_mfma_f32_16x16x32_bf16 v[76:79], v[32:35], v[144:147], v[76:79]
    ds_read_b64_tr_b16 v[28:29], v10 offset:18432
    v_mfma_f32_16x16x32_bf16 v[80:83], v[32:35], v[148:151], v[80:83]
    ds_read_b64_tr_b16 v[30:31], v10 offset:18688
    s_waitcnt lgkmcnt(6)
    v_mfma_f32_16x16x32_bf16 v[92:95], v[16:19], v[144:147], v[92:95]
    ds_read_b64_tr_b16 v[32:33], v11 offset:18432
    s_add_u32 m0, s3, 132992
    v_mfma_f32_16x16x32_bf16 v[96:99], v[16:19], v[148:151], v[96:99]
    ds_read_b64_tr_b16 v[34:35], v11 offset:18688
    buffer_load_dwordx4 v5, s[12:15], s86 offen offset:128 lds
    s_waitcnt lgkmcnt(6)
    v_mfma_f32_16x16x32_bf16 v[108:111], v[20:23], v[144:147], v[108:111]
    s_waitcnt vmcnt(7)
    s_barrier
    ds_read_b64_tr_b16 v[16:17], v126 offset:53248
    v_mfma_f32_16x16x32_bf16 v[112:115], v[20:23], v[148:151], v[112:115]
    ds_read_b64_tr_b16 v[18:19], v126 offset:53504
    s_waitcnt lgkmcnt(6)
    v_mfma_f32_16x16x32_bf16 v[76:79], v[24:27], v[152:155], v[76:79]
    ds_read_b64_tr_b16 v[20:21], v9 offset:28672
    s_add_u32 m0, s57, 28672
    s_add_u32 s78, s78, 196608
    v_mfma_f32_16x16x32_bf16 v[80:83], v[24:27], v[156:159], v[80:83]
    ds_read_b64_tr_b16 v[22:23], v9 offset:28928
    buffer_load_dwordx4 v4, s[8:11], s78 offen lds
    s_waitcnt lgkmcnt(6)
    v_mfma_f32_16x16x32_bf16 v[92:95], v[28:31], v[152:155], v[92:95]
    ds_read_b64_tr_b16 v[24:25], v10 offset:28672
    v_mfma_f32_16x16x32_bf16 v[96:99], v[28:31], v[156:159], v[96:99]
    ds_read_b64_tr_b16 v[26:27], v10 offset:28928
    s_waitcnt lgkmcnt(6)
    v_mfma_f32_16x16x32_bf16 v[108:111], v[32:35], v[152:155], v[108:111]
    ds_read_b64_tr_b16 v[28:29], v11 offset:28672
    s_add_u32 m0, s3, 4096
    s_cmp_eq_u32 s73, 2
    s_cselect_b32 s74, -3, 1
    s_mul_i32 s74, s74, 352256
    s_add_u32 s54, s54, s74
    v_mfma_f32_16x16x32_bf16 v[112:115], v[32:35], v[156:159], v[112:115]
    ds_read_b64_tr_b16 v[30:31], v11 offset:28928
    buffer_load_dwordx4 v5, s[12:15], s54 offen lds
    s_waitcnt lgkmcnt(6)
    v_mfma_f32_16x16x32_bf16 v[52:55], v[16:19], v[208:211], v[52:55]
    ds_read_b64_tr_b16 v[32:33], v9 offset:34816
    v_mfma_f32_16x16x32_bf16 v[56:59], v[16:19], v[212:215], v[56:59]
    ds_read_b64_tr_b16 v[34:35], v9 offset:35072
    s_waitcnt lgkmcnt(6)
    v_mfma_f32_16x16x32_bf16 v[76:79], v[20:23], v[160:163], v[76:79]
    ds_read_b64_tr_b16 v[16:17], v10 offset:34816
    s_add_u32 m0, s3, 5056
    s_add_u32 s86, s54, 176128
    v_mfma_f32_16x16x32_bf16 v[80:83], v[20:23], v[164:167], v[80:83]
    ds_read_b64_tr_b16 v[18:19], v10 offset:35072
    buffer_load_dwordx4 v5, s[12:15], s54 offen offset:64 lds
    s_waitcnt lgkmcnt(6)
    v_mfma_f32_16x16x32_bf16 v[92:95], v[24:27], v[160:163], v[92:95]
    ds_read_b64_tr_b16 v[20:21], v11 offset:34816
    v_mfma_f32_16x16x32_bf16 v[96:99], v[24:27], v[164:167], v[96:99]
    ds_read_b64_tr_b16 v[22:23], v11 offset:35072
    s_waitcnt lgkmcnt(6)
    v_mfma_f32_16x16x32_bf16 v[108:111], v[28:31], v[160:163], v[108:111]
    ds_read_b64_tr_b16 v[24:25], v126 offset:55296
    s_add_u32 m0, s3, 6016
    v_mfma_f32_16x16x32_bf16 v[112:115], v[28:31], v[164:167], v[112:115]
    ds_read_b64_tr_b16 v[26:27], v126 offset:55552
    buffer_load_dwordx4 v5, s[12:15], s54 offen offset:128 lds
    s_waitcnt lgkmcnt(6)
    v_mfma_f32_16x16x32_bf16 v[76:79], v[32:35], v[168:171], v[76:79]
    ds_read_b64_tr_b16 v[28:29], v9 offset:40960
    v_mfma_f32_16x16x32_bf16 v[80:83], v[32:35], v[172:175], v[80:83]
    ds_read_b64_tr_b16 v[30:31], v9 offset:41216
    s_waitcnt lgkmcnt(6)
    v_mfma_f32_16x16x32_bf16 v[92:95], v[16:19], v[168:171], v[92:95]
    ds_read_b64_tr_b16 v[32:33], v10 offset:40960
    s_add_u32 m0, s3, 16384
    v_mfma_f32_16x16x32_bf16 v[96:99], v[16:19], v[172:175], v[96:99]
    ds_read_b64_tr_b16 v[34:35], v10 offset:41216
    buffer_load_dwordx4 v5, s[12:15], s86 offen lds
    s_waitcnt lgkmcnt(6)
    v_mfma_f32_16x16x32_bf16 v[108:111], v[20:23], v[168:171], v[108:111]
    ds_read_b64_tr_b16 v[16:17], v11 offset:40960
    v_mfma_f32_16x16x32_bf16 v[112:115], v[20:23], v[172:175], v[112:115]
    ds_read_b64_tr_b16 v[18:19], v11 offset:41216
    s_waitcnt lgkmcnt(6)
    v_mfma_f32_16x16x32_bf16 v[52:55], v[24:27], v[216:219], v[52:55]
    ds_read_b64_tr_b16 v[20:21], v9 offset:47104
    s_add_u32 m0, s3, 17344
    v_mfma_f32_16x16x32_bf16 v[56:59], v[24:27], v[220:223], v[56:59]
    ds_read_b64_tr_b16 v[22:23], v9 offset:47360
    buffer_load_dwordx4 v5, s[12:15], s86 offen offset:64 lds
    s_waitcnt lgkmcnt(6)
    v_mfma_f32_16x16x32_bf16 v[76:79], v[28:31], v[176:179], v[76:79]
    ds_read_b64_tr_b16 v[24:25], v10 offset:47104
    v_mfma_f32_16x16x32_bf16 v[80:83], v[28:31], v[180:183], v[80:83]
    ds_read_b64_tr_b16 v[26:27], v10 offset:47360
    s_waitcnt lgkmcnt(6)
    v_mfma_f32_16x16x32_bf16 v[92:95], v[32:35], v[176:179], v[92:95]
    ds_read_b64_tr_b16 v[28:29], v11 offset:47104
    s_add_u32 m0, s3, 18304
    v_mfma_f32_16x16x32_bf16 v[96:99], v[32:35], v[180:183], v[96:99]
    ds_read_b64_tr_b16 v[30:31], v11 offset:47360
    buffer_load_dwordx4 v5, s[12:15], s86 offen offset:128 lds
    s_waitcnt lgkmcnt(6)
    v_mfma_f32_16x16x32_bf16 v[108:111], v[16:19], v[176:179], v[108:111]
    s_waitcnt vmcnt(7)
    s_barrier
    v_add_u32 v9, 57344, v9
    v_add_u32 v10, 57344, v10
    v_add_u32 v11, 57344, v11
    v_add_u32 v126, 57344, v126
    ds_read_b64_tr_b16 v[32:33], v126 offset:24576
    v_mfma_f32_16x16x32_bf16 v[112:115], v[16:19], v[180:183], v[112:115]
    ds_read_b64_tr_b16 v[34:35], v126 offset:24832
    s_waitcnt lgkmcnt(6)
    v_mfma_f32_16x16x32_bf16 v[76:79], v[20:23], v[184:187], v[76:79]
    ds_read_b64_tr_b16 v[16:17], v9 offset:0
    v_mfma_f32_16x16x32_bf16 v[80:83], v[20:23], v[188:191], v[80:83]
    ds_read_b64_tr_b16 v[18:19], v9 offset:256
    s_waitcnt lgkmcnt(6)
    v_mfma_f32_16x16x32_bf16 v[92:95], v[24:27], v[184:187], v[92:95]
    ds_read_b64_tr_b16 v[20:21], v10 offset:0
    v_mfma_f32_16x16x32_bf16 v[96:99], v[24:27], v[188:191], v[96:99]
    ds_read_b64_tr_b16 v[22:23], v10 offset:256
    s_waitcnt lgkmcnt(6)
    v_mfma_f32_16x16x32_bf16 v[108:111], v[28:31], v[184:187], v[108:111]
    ds_read_b64_tr_b16 v[24:25], v11 offset:0
    v_mfma_f32_16x16x32_bf16 v[112:115], v[28:31], v[188:191], v[112:115]
    ds_read_b64_tr_b16 v[26:27], v11 offset:256
    s_waitcnt lgkmcnt(6)
    v_mfma_f32_16x16x32_bf16 v[52:55], v[32:35], v[224:227], v[52:55]
    ds_read_b64_tr_b16 v[28:29], v9 offset:6144
    v_mfma_f32_16x16x32_bf16 v[56:59], v[32:35], v[228:231], v[56:59]
    ds_read_b64_tr_b16 v[30:31], v9 offset:6400
    s_waitcnt lgkmcnt(6)
    v_mfma_f32_16x16x32_bf16 v[76:79], v[16:19], v[192:195], v[76:79]
    ds_read_b64_tr_b16 v[32:33], v10 offset:6144
    v_mfma_f32_16x16x32_bf16 v[80:83], v[16:19], v[196:199], v[80:83]
    ds_read_b64_tr_b16 v[34:35], v10 offset:6400
    s_waitcnt lgkmcnt(6)
    v_mfma_f32_16x16x32_bf16 v[92:95], v[20:23], v[192:195], v[92:95]
    ds_read_b64_tr_b16 v[16:17], v11 offset:6144
    v_mfma_f32_16x16x32_bf16 v[96:99], v[20:23], v[196:199], v[96:99]
    ds_read_b64_tr_b16 v[18:19], v11 offset:6400
    s_waitcnt lgkmcnt(6)
    v_mfma_f32_16x16x32_bf16 v[108:111], v[24:27], v[192:195], v[108:111]
    ds_read_b64_tr_b16 v[20:21], v126 offset:26624
    s_mov_b64 exec, 0xff
    buffer_load_dwordx2 v[14:15], v6, s[16:19], 0 offen sc1
    s_mov_b64 exec, -1
    v_mfma_f32_16x16x32_bf16 v[112:115], v[24:27], v[196:199], v[112:115]
    ds_read_b64_tr_b16 v[22:23], v126 offset:26880
    s_waitcnt lgkmcnt(6)
    v_mfma_f32_16x16x32_bf16 v[76:79], v[28:31], v[200:203], v[76:79]
    ds_read_b64_tr_b16 v[24:25], v9 offset:12288
    v_mfma_f32_16x16x32_bf16 v[80:83], v[28:31], v[204:207], v[80:83]
    ds_read_b64_tr_b16 v[26:27], v9 offset:12544
    s_waitcnt lgkmcnt(6)
    v_mfma_f32_16x16x32_bf16 v[92:95], v[32:35], v[200:203], v[92:95]
    ds_read_b64_tr_b16 v[28:29], v10 offset:12288
    v_mfma_f32_16x16x32_bf16 v[96:99], v[32:35], v[204:207], v[96:99]
    ds_read_b64_tr_b16 v[30:31], v10 offset:12544
    s_waitcnt lgkmcnt(6)
    v_mfma_f32_16x16x32_bf16 v[108:111], v[16:19], v[200:203], v[108:111]
    ds_read_b64_tr_b16 v[32:33], v11 offset:12288
    v_mfma_f32_16x16x32_bf16 v[112:115], v[16:19], v[204:207], v[112:115]
    ds_read_b64_tr_b16 v[34:35], v11 offset:12544
    s_waitcnt lgkmcnt(6)
    v_mfma_f32_16x16x32_bf16 v[52:55], v[20:23], v[232:235], v[52:55]
    ds_read_b64_tr_b16 v[16:17], v9 offset:18432
    v_mfma_f32_16x16x32_bf16 v[56:59], v[20:23], v[236:239], v[56:59]
    ds_read_b64_tr_b16 v[18:19], v9 offset:18688
    s_waitcnt lgkmcnt(6)
    v_mfma_f32_16x16x32_bf16 v[76:79], v[24:27], v[208:211], v[76:79]
    ds_read_b64_tr_b16 v[20:21], v10 offset:18432
    v_mfma_f32_16x16x32_bf16 v[80:83], v[24:27], v[212:215], v[80:83]
    ds_read_b64_tr_b16 v[22:23], v10 offset:18688
    s_waitcnt lgkmcnt(6)
    v_mfma_f32_16x16x32_bf16 v[92:95], v[28:31], v[208:211], v[92:95]
    ds_read_b64_tr_b16 v[24:25], v11 offset:18432
    v_mfma_f32_16x16x32_bf16 v[96:99], v[28:31], v[212:215], v[96:99]
    ds_read_b64_tr_b16 v[26:27], v11 offset:18688
    s_waitcnt lgkmcnt(6)
    v_mfma_f32_16x16x32_bf16 v[108:111], v[32:35], v[208:211], v[108:111]
    s_waitcnt vmcnt(1)
    s_barrier
    v_subrev_u32 v9, 114688, v9
    v_subrev_u32 v10, 114688, v10
    v_subrev_u32 v11, 114688, v11
    v_subrev_u32 v126, 114688, v126
    ds_read_b64_tr_b16 v[28:29], v126 offset:24576
    v_mfma_f32_16x16x32_bf16 v[112:115], v[32:35], v[212:215], v[112:115]
    ds_read_b64_tr_b16 v[30:31], v126 offset:24832
    s_waitcnt lgkmcnt(6)
    v_mfma_f32_16x16x32_bf16 v[76:79], v[16:19], v[216:219], v[76:79]
    ds_read_b64_tr_b16 v[32:33], v126 offset:26624
    v_mfma_f32_16x16x32_bf16 v[80:83], v[16:19], v[220:223], v[80:83]
    ds_read_b64_tr_b16 v[34:35], v126 offset:26880
    s_waitcnt lgkmcnt(6)
    v_mfma_f32_16x16x32_bf16 v[92:95], v[20:23], v[216:219], v[92:95]
    ds_read_b64_tr_b16 v[16:17], v9 offset:0
    v_mfma_f32_16x16x32_bf16 v[96:99], v[20:23], v[220:223], v[96:99]
    ds_read_b64_tr_b16 v[18:19], v9 offset:256
    s_waitcnt lgkmcnt(6)
    v_mfma_f32_16x16x32_bf16 v[108:111], v[24:27], v[216:219], v[108:111]
    ds_read_b64_tr_b16 v[20:21], v10 offset:0
    s_waitcnt vmcnt(0)
    s_mov_b64 exec, 0xff
    v_cmp_ne_u64 vcc, s[58:59], v[14:15]
    s_mov_b64 exec, -1
    s_cbranch_vccnz Lal_3
    buffer_load_dwordx4 v[116:119], v124, s[16:19], s62 offen sc1
Lal_3:
    v_mfma_f32_16x16x32_bf16 v[112:115], v[24:27], v[220:223], v[112:115]
    ds_read_b64_tr_b16 v[22:23], v10 offset:256
    s_waitcnt lgkmcnt(6)
    v_mfma_f32_16x16x32_bf16 v[52:55], v[28:31], v[240:243], v[52:55]
    ds_read_b64_tr_b16 v[24:25], v11 offset:0
    v_mfma_f32_16x16x32_bf16 v[56:59], v[28:31], v[244:247], v[56:59]
    ds_read_b64_tr_b16 v[26:27], v11 offset:256
    s_waitcnt lgkmcnt(6)
    v_mfma_f32_16x16x32_bf16 v[52:55], v[32:35], v[248:251], v[52:55]
    ds_read_b64_tr_b16 v[28:29], v9 offset:6144
    v_add_u32 v192, s40, v1
    v_add_u32 v196, s41, v1
    v_mfma_f32_16x16x32_bf16 v[56:59], v[32:35], v[252:255], v[56:59]
    ds_read_b64_tr_b16 v[30:31], v9 offset:6400
    s_waitcnt lgkmcnt(6)
    v_mfma_f32_16x16x32_bf16 v[76:79], v[16:19], v[224:227], v[76:79]
    ds_read_b64_tr_b16 v[32:33], v10 offset:6144
    v_add_u32 v200, s42, v1
    v_add_u32 v193, s43, v1
    v_mfma_f32_16x16x32_bf16 v[80:83], v[16:19], v[228:231], v[80:83]
    ds_read_b64_tr_b16 v[34:35], v10 offset:6400
    s_waitcnt lgkmcnt(6)
    v_mfma_f32_16x16x32_bf16 v[92:95], v[20:23], v[224:227], v[92:95]
    ds_read_b64_tr_b16 v[16:17], v11 offset:6144
    s_cbranch_vccnz Lal_4
    s_mov_b64 exec, s[66:67]
    buffer_load_dwordx4 v[36:39], v125, s[16:19], s62 offen offset:1024 sc1
    buffer_load_dwordx4 v[40:43], v125, s[16:19], s62 offen offset:1536 sc1
    s_mov_b64 exec, -1
    s_addk_i32 s62, 2048
    s_bitset0_b32 s62, 15
Lal_4:
    v_mfma_f32_16x16x32_bf16 v[96:99], v[20:23], v[228:231], v[96:99]
    ds_read_b64_tr_b16 v[18:19], v11 offset:6400
    s_waitcnt lgkmcnt(6)
    v_mfma_f32_16x16x32_bf16 v[108:111], v[24:27], v[224:227], v[108:111]
    ds_read_b64_tr_b16 v[20:21], v9 offset:12288
    v_mul_f32 v52, 0x3eb8aa3b, v52
    v_mul_f32 v53, 0x3eb8aa3b, v53
    v_mfma_f32_16x16x32_bf16 v[112:115], v[24:27], v[228:231], v[112:115]
    ds_read_b64_tr_b16 v[22:23], v9 offset:12544
    v_mul_f32 v54, 0x3eb8aa3b, v54
    s_waitcnt lgkmcnt(6)
    v_mfma_f32_16x16x32_bf16 v[76:79], v[28:31], v[232:235], v[76:79]
    ds_read_b64_tr_b16 v[24:25], v10 offset:12288
    v_mul_f32 v55, 0x3eb8aa3b, v55
    v_mul_f32 v56, 0x3eb8aa3b, v56
    v_mfma_f32_16x16x32_bf16 v[80:83], v[28:31], v[236:239], v[80:83]
    ds_read_b64_tr_b16 v[26:27], v10 offset:12544
    v_mul_f32 v57, 0x3eb8aa3b, v57
    s_waitcnt lgkmcnt(6)
    v_mfma_f32_16x16x32_bf16 v[92:95], v[32:35], v[232:235], v[92:95]
    ds_read_b64_tr_b16 v[28:29], v11 offset:12288
    v_mul_f32 v58, 0x3eb8aa3b, v58
    v_mul_f32 v59, 0x3eb8aa3b, v59
    v_mfma_f32_16x16x32_bf16 v[96:99], v[32:35], v[236:239], v[96:99]
    ds_read_b64_tr_b16 v[30:31], v11 offset:12544
    v_cvt_pk_bf16_f32 v204, v52, v53
    s_waitcnt lgkmcnt(6)
    v_mfma_f32_16x16x32_bf16 v[108:111], v[16:19], v[232:235], v[108:111]
    ds_read_b64_tr_b16 v[32:33], v9 offset:18432
    v_cvt_pk_bf16_f32 v205, v54, v55
    v_cvt_pk_bf16_f32 v206, v56, v57
    v_mfma_f32_16x16x32_bf16 v[112:115], v[16:19], v[236:239], v[112:115]
    ds_read_b64_tr_b16 v[34:35], v9 offset:18688
    v_cvt_pk_bf16_f32 v207, v58, v59
    s_waitcnt lgkmcnt(6)
    v_mfma_f32_16x16x32_bf16 v[76:79], v[20:23], v[240:243], v[76:79]
    ds_read_b64_tr_b16 v[16:17], v10 offset:18432
    v_permlane16_swap_b32 v204, v206
    v_permlane16_swap_b32 v205, v207
    v_mfma_f32_16x16x32_bf16 v[80:83], v[20:23], v[244:247], v[80:83]
    ds_read_b64_tr_b16 v[18:19], v10 offset:18688
    ds_write_b128 v193, v[204:207]
    s_waitcnt lgkmcnt(7)
    v_mfma_f32_16x16x32_bf16 v[92:95], v[24:27], v[240:243], v[92:95]
    ds_read_b64_tr_b16 v[20:21], v11 offset:18432
    v_mfma_f32_16x16x32_bf16 v[96:99], v[24:27], v[244:247], v[96:99]
    ds_read_b64_tr_b16 v[22:23], v11 offset:18688
    s_waitcnt lgkmcnt(7)
    v_mfma_f32_16x16x32_bf16 v[108:111], v[28:31], v[240:243], v[108:111]
    s_cbranch_vccnz Lal_5
    buffer_load_dwordx4 v[120:123], v124, s[16:19], s62 offen sc1
Lal_5:
    v_mfma_f32_16x16x32_bf16 v[112:115], v[28:31], v[244:247], v[112:115]
    s_waitcnt lgkmcnt(5)
    v_mfma_f32_16x16x32_bf16 v[76:79], v[32:35], v[248:251], v[76:79]
    s_cbranch_vccnz Lal_6
    s_mov_b64 exec, s[66:67]
    buffer_load_dwordx4 v[44:47], v125, s[16:19], s62 offen offset:1024 sc1
    buffer_load_dwordx4 v[48:51], v125, s[16:19], s62 offen offset:1536 sc1
    s_mov_b64 exec, -1
    s_addk_i32 s62, 2048
    s_bitset0_b32 s62, 15
Lal_6:
    v_mfma_f32_16x16x32_bf16 v[80:83], v[32:35], v[252:255], v[80:83]
    s_waitcnt lgkmcnt(3)
    v_mfma_f32_16x16x32_bf16 v[92:95], v[16:19], v[248:251], v[92:95]
    v_mfma_f32_16x16x32_bf16 v[96:99], v[16:19], v[252:255], v[96:99]
    s_waitcnt lgkmcnt(0)
    v_mfma_f32_16x16x32_bf16 v[108:111], v[20:23], v[248:251], v[108:111]
    v_mfma_f32_16x16x32_bf16 v[112:115], v[20:23], v[252:255], v[112:115]
    s_barrier
    ds_read_b128 v[192:195], v192
    ds_read_b128 v[196:199], v196
    ds_read_b128 v[200:203], v200
    v_mov_b32 v240, -1
    v_mov_b32 v241, -1
    v_mov_b32 v242, -1
    v_mov_b32 v243, -1
    buffer_store_dwordx4 v[240:243], v1, s[16:19], s85 offen sc1
    v_pk_mul_f32 v[52:53], v[100:101], v[100:101]
    v_pk_mul_f32 v[54:55], v[102:103], v[102:103]
    v_pk_mul_f32 v[56:57], v[104:105], v[104:105]
    v_pk_mul_f32 v[58:59], v[106:107], v[106:107]
    v_pk_fma_f32 v[52:53], v[52:53], s[76:77], v[60:61]
    v_pk_fma_f32 v[54:55], v[54:55], s[76:77], v[60:61]
    v_pk_fma_f32 v[56:57], v[56:57], s[76:77], v[60:61]
    v_pk_fma_f32 v[58:59], v[58:59], s[76:77], v[60:61]
    v_pk_mul_f32 v[52:53], v[52:53], v[100:101]
    v_pk_mul_f32 v[54:55], v[54:55], v[102:103]
    v_pk_mul_f32 v[56:57], v[56:57], v[104:105]
    v_pk_mul_f32 v[58:59], v[58:59], v[106:107]
    v_exp_f32 v52, v52
    v_exp_f32 v53, v53
    v_exp_f32 v54, v54
    v_exp_f32 v55, v55
    v_exp_f32 v56, v56
    v_exp_f32 v57, v57
    v_exp_f32 v58, v58
    v_exp_f32 v59, v59
    v_pk_mul_f32 v[100:101], v[100:101], v[108:109]
    v_pk_mul_f32 v[102:103], v[102:103], v[110:111]
    v_pk_mul_f32 v[104:105], v[104:105], v[112:113]
    v_pk_mul_f32 v[106:107], v[106:107], v[114:115]
    v_pk_fma_f32 v[52:53], v[52:53], v[62:63], v[62:63]
    v_pk_fma_f32 v[54:55], v[54:55], v[62:63], v[62:63]
    v_pk_fma_f32 v[56:57], v[56:57], v[64:65], v[64:65]
    v_pk_fma_f32 v[58:59], v[58:59], v[64:65], v[64:65]
    v_rcp_f32 v52, v52
    v_rcp_f32 v53, v53
    v_rcp_f32 v54, v54
    v_rcp_f32 v55, v55
    v_rcp_f32 v56, v56
    v_rcp_f32 v57, v57
    v_rcp_f32 v58, v58
    v_rcp_f32 v59, v59
    v_pk_mul_f32 v[100:101], v[100:101], v[52:53]
    v_pk_mul_f32 v[102:103], v[102:103], v[54:55]
    v_pk_mul_f32 v[104:105], v[104:105], v[56:57]
    v_pk_mul_f32 v[106:107], v[106:107], v[58:59]
    v_cvt_pk_bf16_f32 v108, v100, v101
    v_cvt_pk_bf16_f32 v110, v104, v105
    v_cvt_pk_bf16_f32 v109, v102, v103
    v_cvt_pk_bf16_f32 v111, v106, v107
    v_permlane16_swap_b32 v108, v110
    s_nop 0
    v_permlane16_swap_b32 v109, v111
    s_add_u32 s68, s63, 4096
    buffer_store_dwordx4 v[108:111], v1, s[16:19], s68 offen sc1
    v_pk_mul_f32 v[52:53], v[84:85], v[84:85]
    v_pk_mul_f32 v[54:55], v[86:87], v[86:87]
    v_pk_mul_f32 v[56:57], v[88:89], v[88:89]
    v_pk_mul_f32 v[58:59], v[90:91], v[90:91]
    v_pk_fma_f32 v[52:53], v[52:53], s[76:77], v[60:61]
    v_pk_fma_f32 v[54:55], v[54:55], s[76:77], v[60:61]
    v_pk_fma_f32 v[56:57], v[56:57], s[76:77], v[60:61]
    v_pk_fma_f32 v[58:59], v[58:59], s[76:77], v[60:61]
    v_pk_mul_f32 v[52:53], v[52:53], v[84:85]
    v_pk_mul_f32 v[54:55], v[54:55], v[86:87]
    v_pk_mul_f32 v[56:57], v[56:57], v[88:89]
    v_pk_mul_f32 v[58:59], v[58:59], v[90:91]
    v_exp_f32 v52, v52
    v_exp_f32 v53, v53
    v_exp_f32 v54, v54
    v_exp_f32 v55, v55
    v_exp_f32 v56, v56
    v_exp_f32 v57, v57
    v_exp_f32 v58, v58
    v_exp_f32 v59, v59
    v_pk_mul_f32 v[84:85], v[84:85], v[92:93]
    v_pk_mul_f32 v[86:87], v[86:87], v[94:95]
    v_pk_mul_f32 v[88:89], v[88:89], v[96:97]
    v_pk_mul_f32 v[90:91], v[90:91], v[98:99]
    v_pk_fma_f32 v[52:53], v[52:53], v[62:63], v[62:63]
    v_pk_fma_f32 v[54:55], v[54:55], v[62:63], v[62:63]
    v_pk_fma_f32 v[56:57], v[56:57], v[64:65], v[64:65]
    v_pk_fma_f32 v[58:59], v[58:59], v[64:65], v[64:65]
    v_rcp_f32 v52, v52
    v_rcp_f32 v53, v53
    v_rcp_f32 v54, v54
    v_rcp_f32 v55, v55
    v_rcp_f32 v56, v56
    v_rcp_f32 v57, v57
    v_rcp_f32 v58, v58
    v_rcp_f32 v59, v59
    v_pk_mul_f32 v[84:85], v[84:85], v[52:53]
    v_pk_mul_f32 v[86:87], v[86:87], v[54:55]
    v_pk_mul_f32 v[88:89], v[88:89], v[56:57]
    v_pk_mul_f32 v[90:91], v[90:91], v[58:59]
    v_cvt_pk_bf16_f32 v92, v84, v85
    v_cvt_pk_bf16_f32 v94, v88, v89
    v_cvt_pk_bf16_f32 v93, v86, v87
    v_cvt_pk_bf16_f32 v95, v90, v91
    v_permlane16_swap_b32 v92, v94
    s_nop 0
    v_permlane16_swap_b32 v93, v95
    s_add_u32 s68, s63, 2048
    buffer_store_dwordx4 v[92:95], v1, s[16:19], s68 offen sc1
    v_pk_mul_f32 v[52:53], v[68:69], v[68:69]
    v_pk_mul_f32 v[54:55], v[70:71], v[70:71]
    v_pk_mul_f32 v[56:57], v[72:73], v[72:73]
    v_pk_mul_f32 v[58:59], v[74:75], v[74:75]
    v_pk_fma_f32 v[52:53], v[52:53], s[76:77], v[60:61]
    v_pk_fma_f32 v[54:55], v[54:55], s[76:77], v[60:61]
    v_pk_fma_f32 v[56:57], v[56:57], s[76:77], v[60:61]
    v_pk_fma_f32 v[58:59], v[58:59], s[76:77], v[60:61]
    v_pk_mul_f32 v[52:53], v[52:53], v[68:69]
    v_pk_mul_f32 v[54:55], v[54:55], v[70:71]
    v_pk_mul_f32 v[56:57], v[56:57], v[72:73]
    v_pk_mul_f32 v[58:59], v[58:59], v[74:75]
    v_exp_f32 v52, v52
    v_exp_f32 v53, v53
    v_exp_f32 v54, v54
    v_exp_f32 v55, v55
    v_exp_f32 v56, v56
    v_exp_f32 v57, v57
    v_exp_f32 v58, v58
    v_exp_f32 v59, v59
    v_pk_mul_f32 v[68:69], v[68:69], v[76:77]
    v_pk_mul_f32 v[70:71], v[70:71], v[78:79]
    v_pk_mul_f32 v[72:73], v[72:73], v[80:81]
    v_pk_mul_f32 v[74:75], v[74:75], v[82:83]
    v_pk_fma_f32 v[52:53], v[52:53], v[62:63], v[62:63]
    v_pk_fma_f32 v[54:55], v[54:55], v[62:63], v[62:63]
    v_pk_fma_f32 v[56:57], v[56:57], v[64:65], v[64:65]
    v_pk_fma_f32 v[58:59], v[58:59], v[64:65], v[64:65]
    v_rcp_f32 v52, v52
    v_rcp_f32 v53, v53
    v_rcp_f32 v54, v54
    v_rcp_f32 v55, v55
    v_rcp_f32 v56, v56
    v_rcp_f32 v57, v57
    v_rcp_f32 v58, v58
    v_rcp_f32 v59, v59
    v_pk_mul_f32 v[68:69], v[68:69], v[52:53]
    v_pk_mul_f32 v[70:71], v[70:71], v[54:55]
    v_pk_mul_f32 v[72:73], v[72:73], v[56:57]
    v_pk_mul_f32 v[74:75], v[74:75], v[58:59]
    v_cvt_pk_bf16_f32 v76, v68, v69
    v_cvt_pk_bf16_f32 v78, v72, v73
    v_cvt_pk_bf16_f32 v77, v70, v71
    v_cvt_pk_bf16_f32 v79, v74, v75
    v_permlane16_swap_b32 v76, v78
    s_nop 0
    v_permlane16_swap_b32 v77, v79
    s_add_u32 s68, s63, 0
    buffer_store_dwordx4 v[76:79], v1, s[16:19], s68 offen sc1
    s_setprio 2
    s_branch Lffn
Lcomp0:
    s_load_dwordx2 s[36:37], s[0:1], 72
    s_load_dwordx2 s[16:17], s[0:1], 80
    s_load_dwordx2 s[20:21], s[0:1], 80
    s_load_dwordx2 s[24:25], s[0:1], 48
    s_load_dwordx2 s[28:29], s[0:1], 16
    s_load_dwordx2 s[32:33], s[0:1], 64
    v_lshlrev_b32 v1, 4, v0
    s_and_b32 s48, s2, 4
    s_lshl_b32 s48, s48, 1
    s_lshr_b32 s74, s2, 5
    s_add_u32 s48, s48, s74
    s_mul_i32 s73, s2, 1
    s_add_u32 s73, s73, s48
    s_and_b32 s73, s73, 3
    s_mul_i32 s73, s73, 2
    s_and_b32 s47, s2, 3
    s_lshl_b32 s47, s47, 2
    s_bfe_u32 s74, s2, 0x20003
    s_add_u32 s47, s47, s74
    s_memrealtime s[58:59]
    v_mov_b32 v16, 0
    v_mov_b32 v17, 2048
    ds_write2_b32 v17, v16, v16 offset0:0 offset1:1
    s_mov_b32 s38, 256
    s_mov_b32 s39, 0x20000
    v_and_b32 v3, 48, v0
    v_and_b32 v16, 15, v0
    s_lshl_b32 s74, s45, 12
    v_lshrrev_b32 v17, 4, v0
    v_lshrrev_b32 v18, 1, v16
    v_xor_b32 v18, v18, v17
    v_lshlrev_b32 v18, 4, v18
    v_lshl_add_u32 v18, v16, 7, v18
    v_add_u32 v6, s74, v18
    v_xor_b32 v7, 64, v6
    v_lshrrev_b32 v8, 5, v0
    v_mul_u32_u24 v8, 2048, v8
    v_bfe_u32 v16, v0, 4, 1
    v_mul_u32_u24 v16, 544, v16
    v_add_u32 v8, v8, v16
    v_bfe_u32 v16, v0, 2, 2
    v_lshl_add_u32 v8, v16, 6, v8
    v_and_b32 v16, 3, v0
    v_lshl_add_u32 v8, v16, 3, v8
    v_xor_b32 v2, 32, v8
    s_waitcnt lgkmcnt(0)
    s_or_b32 s74, s2, s44
    s_cbranch_scc1 Lnn_7
    s_or_b32 s59, s59, 0x80000000
    v_mov_b32 v16, s58
    v_mov_b32 v17, s59
    s_mov_b64 exec, 1
    buffer_store_dwordx2 v[16:17], off, s[36:39], 0 sc1
    s_mov_b64 exec, -1
Lnn_7:
    s_mov_b32 s18, 15728640
    s_mov_b32 s19, 0x20000
    s_mov_b32 s22, 176128
    s_mov_b32 s23, 0x20000
    s_mov_b32 s26, 1409024
    s_mov_b32 s27, 0x20000
    s_mov_b32 s30, 524288
    s_mov_b32 s31, 0x20000
    s_mov_b32 s34, 2097152
    s_mov_b32 s35, 0x20000
    s_and_b32 s68, s47, 12
    s_lshr_b32 s68, 49284, s68
    s_and_b32 s68, s68, 12
    s_and_b32 s87, s47, 3
    s_add_u32 s87, s87, s68
    s_min_u32 s68, s87, 6
    s_mul_i32 s51, s87, 5
    s_add_u32 s51, s51, s68
    v_lshrrev_b32 v15, 5, v0
    v_mul_u32_u24 v15, 3072, v15
    v_bfe_u32 v14, v0, 4, 1
    v_mul_u32_u24 v14, 544, v14
    v_add_u32 v15, v15, v14
    v_bfe_u32 v14, v0, 2, 2
    v_lshl_add_u32 v15, v14, 6, v15
    v_and_b32 v14, 3, v0
    v_lshl_add_u32 v15, v14, 3, v15
    s_and_b32 s68, s51, 1
    s_add_u32 s68, s68, 3
    s_lshr_b32 s69, s68, 1
    s_lshl_b32 s69, s69, 10
    s_and_b32 s68, s68, 1
    s_lshl_b32 s68, s68, 5
    v_xor_b32 v9, s68, v15
    v_add_u32 v9, s69, v9
    s_and_b32 s68, s51, 1
    s_add_u32 s68, s68, 4
    s_lshr_b32 s69, s68, 1
    s_lshl_b32 s69, s69, 10
    s_and_b32 s68, s68, 1
    s_barrier
    ds_read_b128 v[128:131], v6 offset:4096
    ds_read_b64_tr_b16 v[16:17], v8 offset:20480
    ds_read_b128 v[132:135], v6 offset:6144
    ds_read_b64_tr_b16 v[18:19], v8 offset:20736
    ds_read_b64_tr_b16 v[20:21], v2 offset:20480
    ds_read_b64_tr_b16 v[22:23], v2 offset:20736
    ds_read_b64_tr_b16 v[24:25], v8 offset:21504
    ds_read_b64_tr_b16 v[26:27], v8 offset:21760
    ds_read_b64_tr_b16 v[28:29], v2 offset:21504
    ds_read_b64_tr_b16 v[30:31], v2 offset:21760
    s_waitcnt lgkmcnt(6)
    v_mfma_f32_16x16x32_bf16 v[36:39], v[16:19], v[128:131], 0
    ds_read_b128 v[136:139], v7 offset:4096
    ds_read_b64_tr_b16 v[32:33], v8 offset:24576
    s_lshl_b32 s68, s68, 5
    v_xor_b32 v10, s68, v15
    v_mfma_f32_16x16x32_bf16 v[40:43], v[16:19], v[132:135], 0
    ds_read_b128 v[140:143], v7 offset:6144
    ds_read_b64_tr_b16 v[34:35], v8 offset:24832
    s_waitcnt lgkmcnt(8)
    v_mfma_f32_16x16x32_bf16 v[44:47], v[20:23], v[128:131], 0
    ds_read_b64_tr_b16 v[16:17], v2 offset:24576
    v_add_u32 v10, s69, v10
    s_and_b32 s68, s51, 1
    v_mfma_f32_16x16x32_bf16 v[48:51], v[20:23], v[132:135], 0
    ds_read_b64_tr_b16 v[18:19], v2 offset:24832
    s_waitcnt lgkmcnt(8)
    v_mfma_f32_16x16x32_bf16 v[52:55], v[24:27], v[128:131], 0
    ds_read_b64_tr_b16 v[20:21], v8 offset:25600
    s_add_u32 s68, s68, 5
    s_lshr_b32 s69, s68, 1
    v_mfma_f32_16x16x32_bf16 v[56:59], v[24:27], v[132:135], 0
    ds_read_b64_tr_b16 v[22:23], v8 offset:25856
    s_waitcnt lgkmcnt(8)
    v_mfma_f32_16x16x32_bf16 v[60:63], v[28:31], v[128:131], 0
    ds_read_b64_tr_b16 v[24:25], v2 offset:25600
    s_lshl_b32 s69, s69, 10
    s_and_b32 s68, s68, 1
    v_mfma_f32_16x16x32_bf16 v[64:67], v[28:31], v[132:135], 0
    ds_read_b64_tr_b16 v[26:27], v2 offset:25856
    s_waitcnt lgkmcnt(6)
    v_mfma_f32_16x16x32_bf16 v[36:39], v[32:35], v[136:139], v[36:39]
    s_barrier
    ds_read_b128 v[144:147], v6 offset:32768
    ds_read_b64_tr_b16 v[28:29], v8 offset:49152
    s_lshl_b32 s68, s68, 5
    v_xor_b32 v11, s68, v15
    v_mfma_f32_16x16x32_bf16 v[40:43], v[32:35], v[140:143], v[40:43]
    ds_read_b128 v[148:151], v6 offset:34816
    ds_read_b64_tr_b16 v[30:31], v8 offset:49408
    s_waitcnt lgkmcnt(8)
    v_mfma_f32_16x16x32_bf16 v[44:47], v[16:19], v[136:139], v[44:47]
    ds_read_b64_tr_b16 v[32:33], v2 offset:49152
    v_add_u32 v11, s69, v11
    v_lshrrev_b32 v14, 5, v0
    v_mfma_f32_16x16x32_bf16 v[48:51], v[16:19], v[140:143], v[48:51]
    ds_read_b64_tr_b16 v[34:35], v2 offset:49408
    s_waitcnt lgkmcnt(8)
    v_mfma_f32_16x16x32_bf16 v[52:55], v[20:23], v[136:139], v[52:55]
    ds_read_b128 v[76:79], v3 offset:0
    ds_read_b64_tr_b16 v[16:17], v8 offset:50176
    v_lshlrev_b32 v127, 11, v14
    v_sub_u32 v126, v15, v127
    v_mfma_f32_16x16x32_bf16 v[56:59], v[20:23], v[140:143], v[56:59]
    ds_read_b64_tr_b16 v[18:19], v8 offset:50432
    s_waitcnt lgkmcnt(9)
    v_mfma_f32_16x16x32_bf16 v[60:63], v[24:27], v[136:139], v[60:63]
    ds_read_b64_tr_b16 v[20:21], v2 offset:50176
    s_and_b32 s49, s2, 7
    s_xor_b32 s49, s49, 4
    v_mfma_f32_16x16x32_bf16 v[64:67], v[24:27], v[140:143], v[64:67]
    ds_read_b64_tr_b16 v[22:23], v2 offset:50432
    s_waitcnt lgkmcnt(7)
    v_mfma_f32_16x16x32_bf16 v[36:39], v[28:31], v[144:147], v[36:39]
    ds_read_b128 v[152:155], v7 offset:32768
    ds_read_b64_tr_b16 v[24:25], v8 offset:53248
    s_lshl_b32 s49, s49, 2
    s_lshr_b32 s68, s2, 6
    v_mfma_f32_16x16x32_bf16 v[40:43], v[28:31], v[148:151], v[40:43]
    ds_read_b128 v[156:159], v7 offset:34816
    ds_read_b64_tr_b16 v[26:27], v8 offset:53504
    s_waitcnt lgkmcnt(9)
    v_mfma_f32_16x16x32_bf16 v[44:47], v[32:35], v[144:147], v[44:47]
    ds_read_b64_tr_b16 v[28:29], v2 offset:53248
    s_add_u32 s49, s49, s68
    s_mul_i32 s68, s49, 176128
    v_mfma_f32_16x16x32_bf16 v[48:51], v[32:35], v[148:151], v[48:51]
    ds_read_b64_tr_b16 v[30:31], v2 offset:53504
    s_waitcnt lgkmcnt(8)
    v_mfma_f32_16x16x32_bf16 v[52:55], v[16:19], v[144:147], v[52:55]
    ds_read_b128 v[80:83], v3 offset:64
    ds_read_b64_tr_b16 v[32:33], v8 offset:54272
    s_add_u32 s68, s68, 9437184
    s_add_u32 s20, s20, s68
    s_addc_u32 s21, s21, 0
    v_mfma_f32_16x16x32_bf16 v[56:59], v[16:19], v[148:151], v[56:59]
    ds_read_b64_tr_b16 v[34:35], v8 offset:54528
    v_mfma_f32_16x16x32_bf16 v[68:71], v[76:79], v[128:131], 0
    v_mfma_f32_16x16x32_bf16 v[72:75], v[76:79], v[132:135], 0
    s_waitcnt lgkmcnt(9)
    v_mfma_f32_16x16x32_bf16 v[60:63], v[20:23], v[144:147], v[60:63]
    ds_read_b64_tr_b16 v[16:17], v2 offset:54272
    s_bfe_u32 s50, s2, 0x30003
    s_mov_b32 s66, 0xffff
    v_mfma_f32_16x16x32_bf16 v[64:67], v[20:23], v[148:151], v[64:67]
    ds_read_b64_tr_b16 v[18:19], v2 offset:54528
    s_waitcnt lgkmcnt(7)
    v_mfma_f32_16x16x32_bf16 v[36:39], v[24:27], v[152:155], v[36:39]
    s_barrier
    v_add_u32 v8, 77824, v8
    v_add_u32 v2, 77824, v2
    ds_read_b128 v[160:163], v6 offset:61440
    ds_read_b64_tr_b16 v[20:21], v8 offset:0
    s_mov_b32 s67, 0xffff
    s_mov_b32 s76, 0xbdd2d3e8
    v_mfma_f32_16x16x32_bf16 v[40:43], v[24:27], v[156:159], v[40:43]
    ds_read_b128 v[164:167], v6 offset:63488
    ds_read_b64_tr_b16 v[22:23], v8 offset:256
    s_waitcnt lgkmcnt(9)
    v_mfma_f32_16x16x32_bf16 v[44:47], v[28:31], v[152:155], v[44:47]
    ds_read_b64_tr_b16 v[24:25], v2 offset:0
    s_mov_b32 s77, s76
    v_and_b32 v127, 15, v0
    v_mfma_f32_16x16x32_bf16 v[48:51], v[28:31], v[156:159], v[48:51]
    ds_read_b64_tr_b16 v[26:27], v2 offset:256
    s_waitcnt lgkmcnt(8)
    v_mfma_f32_16x16x32_bf16 v[52:55], v[32:35], v[152:155], v[52:55]
    ds_read_b128 v[76:79], v3 offset:128
    ds_read_b64_tr_b16 v[28:29], v8 offset:1024
    v_lshl_add_u32 v127, v14, 4, v127
    v_lshlrev_b32 v127, 4, v127
    v_mfma_f32_16x16x32_bf16 v[56:59], v[32:35], v[156:159], v[56:59]
    ds_read_b64_tr_b16 v[30:31], v8 offset:1280
    v_mfma_f32_16x16x32_bf16 v[68:71], v[80:83], v[136:139], v[68:71]
    v_mfma_f32_16x16x32_bf16 v[72:75], v[80:83], v[140:143], v[72:75]
    s_waitcnt lgkmcnt(9)
    v_mfma_f32_16x16x32_bf16 v[60:63], v[16:19], v[152:155], v[60:63]
    ds_read_b64_tr_b16 v[32:33], v2 offset:1024
    s_lshl_b32 s68, s48, 2
    s_add_u32 s68, s68, s45
    v_mfma_f32_16x16x32_bf16 v[64:67], v[16:19], v[156:159], v[64:67]
    ds_read_b64_tr_b16 v[34:35], v2 offset:1280
    s_waitcnt lgkmcnt(7)
    v_mfma_f32_16x16x32_bf16 v[36:39], v[20:23], v[160:163], v[36:39]
    ds_read_b128 v[168:171], v7 offset:61440
    ds_read_b64_tr_b16 v[16:17], v8 offset:4096
    s_lshr_b32 s63, s68, 1
    s_mul_i32 s63, s63, 86
    v_mfma_f32_16x16x32_bf16 v[40:43], v[20:23], v[164:167], v[40:43]
    ds_read_b128 v[172:175], v7 offset:63488
    ds_read_b64_tr_b16 v[18:19], v8 offset:4352
    s_waitcnt lgkmcnt(9)
    v_mfma_f32_16x16x32_bf16 v[44:47], v[24:27], v[160:163], v[44:47]
    ds_read_b64_tr_b16 v[20:21], v2 offset:4096
    s_add_u32 s63, s63, s51
    s_lshl_b32 s63, s63, 1
    v_mfma_f32_16x16x32_bf16 v[48:51], v[24:27], v[164:167], v[48:51]
    ds_read_b64_tr_b16 v[22:23], v2 offset:4352
    s_waitcnt lgkmcnt(8)
    v_mfma_f32_16x16x32_bf16 v[52:55], v[28:31], v[160:163], v[52:55]
    ds_read_b128 v[80:83], v3 offset:192
    ds_read_b64_tr_b16 v[24:25], v8 offset:5120
    s_and_b32 s69, s68, 1
    s_add_u32 s63, s63, s69
    v_mfma_f32_16x16x32_bf16 v[56:59], v[28:31], v[164:167], v[56:59]
    ds_read_b64_tr_b16 v[26:27], v8 offset:5376
    v_mfma_f32_16x16x32_bf16 v[68:71], v[76:79], v[144:147], v[68:71]
    v_mfma_f32_16x16x32_bf16 v[72:75], v[76:79], v[148:151], v[72:75]
    s_waitcnt lgkmcnt(9)
    v_mfma_f32_16x16x32_bf16 v[60:63], v[32:35], v[160:163], v[60:63]
    ds_read_b64_tr_b16 v[28:29], v2 offset:5120
    s_lshl_b32 s63, s63, 10
    s_add_u32 s63, s63, 9443328
    v_mfma_f32_16x16x32_bf16 v[64:67], v[32:35], v[164:167], v[64:67]
    ds_read_b64_tr_b16 v[30:31], v2 offset:5376
    s_waitcnt lgkmcnt(7)
    v_mfma_f32_16x16x32_bf16 v[36:39], v[16:19], v[168:171], v[36:39]
    s_barrier
    v_add_u32 v6, 90112, v6
    v_add_u32 v7, 90112, v7
    ds_read_b128 v[176:179], v6 offset:0
    ds_read_b64_tr_b16 v[32:33], v8 offset:28672
    s_lshl_b32 s85, s68, 4
    s_add_u32 s85, s85, s47
    v_mfma_f32_16x16x32_bf16 v[40:43], v[16:19], v[172:175], v[40:43]
    ds_read_b128 v[180:183], v6 offset:2048
    ds_read_b64_tr_b16 v[34:35], v8 offset:28928
    s_waitcnt lgkmcnt(9)
    v_mfma_f32_16x16x32_bf16 v[44:47], v[20:23], v[168:171], v[44:47]
    ds_read_b64_tr_b16 v[16:17], v2 offset:28672
    s_lshl_b32 s85, s85, 11
    s_add_u32 s85, s85, 6291456
    v_mfma_f32_16x16x32_bf16 v[48:51], v[20:23], v[172:175], v[48:51]
    ds_read_b64_tr_b16 v[18:19], v2 offset:28928
    s_waitcnt lgkmcnt(8)
    v_mfma_f32_16x16x32_bf16 v[52:55], v[24:27], v[168:171], v[52:55]
    ds_read_b128 v[76:79], v3 offset:256
    ds_read_b64_tr_b16 v[20:21], v8 offset:29696
    s_lshr_b32 s4, s47, 1
    s_lshl_b32 s4, s4, 8
    v_mfma_f32_16x16x32_bf16 v[56:59], v[24:27], v[172:175], v[56:59]
    ds_read_b64_tr_b16 v[22:23], v8 offset:29952
    v_mfma_f32_16x16x32_bf16 v[68:71], v[80:83], v[152:155], v[68:71]
    v_mfma_f32_16x16x32_bf16 v[72:75], v[80:83], v[156:159], v[72:75]
    s_waitcnt lgkmcnt(9)
    v_mfma_f32_16x16x32_bf16 v[60:63], v[28:31], v[168:171], v[60:63]
    ds_read_b64_tr_b16 v[24:25], v2 offset:29696
    s_add_u32 s4, s4, s68
    s_lshl_b32 s4, s4, 11
    v_mfma_f32_16x16x32_bf16 v[64:67], v[28:31], v[172:175], v[64:67]
    ds_read_b64_tr_b16 v[26:27], v2 offset:29952
    s_waitcnt lgkmcnt(7)
    v_mfma_f32_16x16x32_bf16 v[36:39], v[32:35], v[176:179], v[36:39]
    ds_read_b128 v[184:187], v7 offset:0
    ds_read_b64_tr_b16 v[28:29], v8 offset:32768
    s_add_u32 s4, s4, 2097152
    s_add_u32 s5, s4, 131072
    v_mfma_f32_16x16x32_bf16 v[40:43], v[32:35], v[180:183], v[40:43]
    ds_read_b128 v[188:191], v7 offset:2048
    ds_read_b64_tr_b16 v[30:31], v8 offset:33024
    s_waitcnt lgkmcnt(9)
    v_mfma_f32_16x16x32_bf16 v[44:47], v[16:19], v[176:179], v[44:47]
    ds_read_b64_tr_b16 v[32:33], v2 offset:32768
    s_add_u32 s6, s4, 262144
    s_add_u32 s7, s4, 393216
    v_mfma_f32_16x16x32_bf16 v[48:51], v[16:19], v[180:183], v[48:51]
    ds_read_b64_tr_b16 v[34:35], v2 offset:33024
    s_waitcnt lgkmcnt(8)
    v_mfma_f32_16x16x32_bf16 v[52:55], v[20:23], v[176:179], v[52:55]
    ds_read_b128 v[80:83], v3 offset:320
    ds_read_b64_tr_b16 v[16:17], v8 offset:33792
    v_mov_b32 v4, v1
    s_lshl_b32 s61, s47, 3
    v_mfma_f32_16x16x32_bf16 v[56:59], v[20:23], v[180:183], v[56:59]
    ds_read_b64_tr_b16 v[18:19], v8 offset:34048
    v_mfma_f32_16x16x32_bf16 v[68:71], v[76:79], v[160:163], v[68:71]
    v_mfma_f32_16x16x32_bf16 v[72:75], v[76:79], v[164:167], v[72:75]
    s_waitcnt lgkmcnt(9)
    v_mfma_f32_16x16x32_bf16 v[60:63], v[24:27], v[176:179], v[60:63]
    ds_read_b64_tr_b16 v[20:21], v2 offset:33792
    s_add_u32 s61, s61, s44
    s_lshl_b32 s61, s61, 15
    v_mfma_f32_16x16x32_bf16 v[64:67], v[24:27], v[180:183], v[64:67]
    ds_read_b64_tr_b16 v[22:23], v2 offset:34048
    s_waitcnt lgkmcnt(7)
    v_mfma_f32_16x16x32_bf16 v[36:39], v[28:31], v[184:187], v[36:39]
    s_barrier
    v_add_u32 v8, 57344, v8
    v_add_u32 v2, 57344, v2
    ds_read_b128 v[192:195], v6 offset:28672
    ds_read_b64_tr_b16 v[24:25], v8 offset:0
    s_add_u32 s61, s61, 2097152
    s_and_b32 s62, s48, 7
    v_mfma_f32_16x16x32_bf16 v[40:43], v[28:31], v[188:191], v[40:43]
    ds_read_b128 v[196:199], v6 offset:30720
    ds_read_b64_tr_b16 v[26:27], v8 offset:256
    s_waitcnt lgkmcnt(9)
    v_mfma_f32_16x16x32_bf16 v[44:47], v[32:35], v[184:187], v[44:47]
    ds_read_b64_tr_b16 v[28:29], v2 offset:0
    s_lshl_b32 s62, s62, 12
    s_and_b32 s60, s47, 14
    v_mfma_f32_16x16x32_bf16 v[48:51], v[32:35], v[188:191], v[48:51]
    ds_read_b64_tr_b16 v[30:31], v2 offset:256
    s_waitcnt lgkmcnt(8)
    v_mfma_f32_16x16x32_bf16 v[52:55], v[16:19], v[184:187], v[52:55]
    ds_read_b128 v[76:79], v3 offset:384
    ds_read_b64_tr_b16 v[32:33], v8 offset:1024
    s_lshl_b32 s60, s60, 2
    s_add_u32 s60, s60, s45
    v_mfma_f32_16x16x32_bf16 v[56:59], v[16:19], v[188:191], v[56:59]
    ds_read_b64_tr_b16 v[34:35], v8 offset:1280
    v_mfma_f32_16x16x32_bf16 v[68:71], v[80:83], v[168:171], v[68:71]
    v_mfma_f32_16x16x32_bf16 v[72:75], v[80:83], v[172:175], v[72:75]
    s_waitcnt lgkmcnt(9)
    v_mfma_f32_16x16x32_bf16 v[60:63], v[20:23], v[184:187], v[60:63]
    ds_read_b64_tr_b16 v[16:17], v2 offset:1024
    s_lshl_b32 s60, s60, 9
    s_add_u32 s60, s60, 8388608
    v_mfma_f32_16x16x32_bf16 v[64:67], v[20:23], v[188:191], v[64:67]
    ds_read_b64_tr_b16 v[18:19], v2 offset:1280
    s_waitcnt lgkmcnt(7)
    v_mfma_f32_16x16x32_bf16 v[36:39], v[24:27], v[192:195], v[36:39]
    ds_read_b128 v[200:203], v7 offset:28672
    ds_read_b64_tr_b16 v[20:21], v8 offset:4096
    s_add_u32 s40, s45, 1
    s_and_b32 s40, s40, 3
    v_mfma_f32_16x16x32_bf16 v[40:43], v[24:27], v[196:199], v[40:43]
    ds_read_b128 v[204:207], v7 offset:30720
    ds_read_b64_tr_b16 v[22:23], v8 offset:4352
    s_waitcnt lgkmcnt(9)
    v_mfma_f32_16x16x32_bf16 v[44:47], v[28:31], v[192:195], v[44:47]
    ds_read_b64_tr_b16 v[24:25], v2 offset:4096
    s_lshl_b32 s40, s40, 10
    s_add_u32 s40, s40, 147456
    v_mfma_f32_16x16x32_bf16 v[48:51], v[28:31], v[196:199], v[48:51]
    ds_read_b64_tr_b16 v[26:27], v2 offset:4352
    s_waitcnt lgkmcnt(8)
    v_mfma_f32_16x16x32_bf16 v[52:55], v[32:35], v[192:195], v[52:55]
    ds_read_b128 v[80:83], v3 offset:448
    ds_read_b64_tr_b16 v[28:29], v8 offset:5120
    s_add_u32 s41, s45, 2
    s_and_b32 s41, s41, 3
    v_mfma_f32_16x16x32_bf16 v[56:59], v[32:35], v[196:199], v[56:59]
    ds_read_b64_tr_b16 v[30:31], v8 offset:5376
    v_mfma_f32_16x16x32_bf16 v[68:71], v[76:79], v[176:179], v[68:71]
    v_mfma_f32_16x16x32_bf16 v[72:75], v[76:79], v[180:183], v[72:75]
    s_waitcnt lgkmcnt(9)
    v_mfma_f32_16x16x32_bf16 v[60:63], v[16:19], v[192:195], v[60:63]
    ds_read_b64_tr_b16 v[32:33], v2 offset:5120
    s_lshl_b32 s41, s41, 10
    s_add_u32 s41, s41, 147456
    v_mfma_f32_16x16x32_bf16 v[64:67], v[16:19], v[196:199], v[64:67]
    ds_read_b64_tr_b16 v[34:35], v2 offset:5376
    s_waitcnt lgkmcnt(7)
    v_mfma_f32_16x16x32_bf16 v[36:39], v[20:23], v[200:203], v[36:39]
    s_barrier
    v_subrev_u32 v6, 86016, v6
    v_subrev_u32 v7, 86016, v7
    v_subrev_u32 v8, 114688, v8
    v_subrev_u32 v2, 114688, v2
    ds_read_b128 v[208:211], v6 offset:0
    ds_read_b64_tr_b16 v[16:17], v8 offset:0
    s_add_u32 s42, s45, 3
    s_and_b32 s42, s42, 3
    v_mfma_f32_16x16x32_bf16 v[40:43], v[20:23], v[204:207], v[40:43]
    ds_read_b128 v[212:215], v6 offset:2048
    ds_read_b64_tr_b16 v[18:19], v8 offset:256
    s_waitcnt lgkmcnt(9)
    v_mfma_f32_16x16x32_bf16 v[44:47], v[24:27], v[200:203], v[44:47]
    ds_read_b64_tr_b16 v[20:21], v2 offset:0
    s_lshl_b32 s42, s42, 10
    s_add_u32 s42, s42, 147456
    v_mfma_f32_16x16x32_bf16 v[48:51], v[24:27], v[204:207], v[48:51]
    ds_read_b64_tr_b16 v[22:23], v2 offset:256
    s_waitcnt lgkmcnt(8)
    v_mfma_f32_16x16x32_bf16 v[52:55], v[28:31], v[200:203], v[52:55]
    ds_read_b128 v[76:79], v3 offset:512
    ds_read_b64_tr_b16 v[24:25], v8 offset:1024
    s_add_u32 s43, s45, 4
    s_and_b32 s43, s43, 3
    v_mfma_f32_16x16x32_bf16 v[56:59], v[28:31], v[204:207], v[56:59]
    ds_read_b64_tr_b16 v[26:27], v8 offset:1280
    v_mfma_f32_16x16x32_bf16 v[68:71], v[80:83], v[184:187], v[68:71]
    v_mfma_f32_16x16x32_bf16 v[72:75], v[80:83], v[188:191], v[72:75]
    s_waitcnt lgkmcnt(9)
    v_mfma_f32_16x16x32_bf16 v[60:63], v[32:35], v[200:203], v[60:63]
    ds_read_b64_tr_b16 v[28:29], v2 offset:1024
    s_lshl_b32 s43, s43, 10
    s_add_u32 s43, s43, 147456
    v_mfma_f32_16x16x32_bf16 v[64:67], v[32:35], v[204:207], v[64:67]
    ds_read_b64_tr_b16 v[30:31], v2 offset:1280
    s_waitcnt lgkmcnt(7)
    v_mfma_f32_16x16x32_bf16 v[36:39], v[16:19], v[208:211], v[36:39]
    ds_read_b128 v[216:219], v7 offset:0
    ds_read_b64_tr_b16 v[32:33], v8 offset:4096
    s_mul_i32 s65, s44, 7168
    s_mul_i32 s64, s44, 180224
    v_mfma_f32_16x16x32_bf16 v[40:43], v[16:19], v[212:215], v[40:43]
    ds_read_b128 v[220:223], v7 offset:2048
    ds_read_b64_tr_b16 v[34:35], v8 offset:4352
    s_waitcnt lgkmcnt(9)
    v_mfma_f32_16x16x32_bf16 v[44:47], v[20:23], v[208:211], v[44:47]
    ds_read_b64_tr_b16 v[16:17], v2 offset:4096
    s_lshl_b32 s68, s50, 7
    s_add_u32 s64, s64, s68
    v_mfma_f32_16x16x32_bf16 v[48:51], v[20:23], v[212:215], v[48:51]
    ds_read_b64_tr_b16 v[18:19], v2 offset:4352
    s_waitcnt lgkmcnt(8)
    v_mfma_f32_16x16x32_bf16 v[52:55], v[24:27], v[208:211], v[52:55]
    ds_read_b128 v[80:83], v3 offset:576
    ds_read_b64_tr_b16 v[20:21], v8 offset:5120
    v_bfe_u32 v12, v0, 2, 2
    v_lshl_add_u32 v12, v14, 3, v12
    v_mfma_f32_16x16x32_bf16 v[56:59], v[24:27], v[212:215], v[56:59]
    ds_read_b64_tr_b16 v[22:23], v8 offset:5376
    v_mfma_f32_16x16x32_bf16 v[68:71], v[76:79], v[192:195], v[68:71]
    v_mfma_f32_16x16x32_bf16 v[72:75], v[76:79], v[196:199], v[72:75]
    s_waitcnt lgkmcnt(9)
    v_mfma_f32_16x16x32_bf16 v[60:63], v[28:31], v[208:211], v[60:63]
    ds_read_b64_tr_b16 v[24:25], v2 offset:5120
    v_lshlrev_b32 v12, 7, v12
    v_bfe_u32 v14, v0, 4, 1
    v_mfma_f32_16x16x32_bf16 v[64:67], v[28:31], v[212:215], v[64:67]
    ds_read_b64_tr_b16 v[26:27], v2 offset:5376
    s_waitcnt lgkmcnt(7)
    v_mfma_f32_16x16x32_bf16 v[36:39], v[32:35], v[216:219], v[36:39]
    s_barrier
    ds_read_b128 v[224:227], v6 offset:28672
    ds_read_b64_tr_b16 v[28:29], v8 offset:28672
    v_lshl_add_u32 v12, v14, 5, v12
    v_bfe_u32 v14, v0, 3, 1
    v_mfma_f32_16x16x32_bf16 v[40:43], v[32:35], v[220:223], v[40:43]
    ds_read_b128 v[228:231], v6 offset:30720
    ds_read_b64_tr_b16 v[30:31], v8 offset:28928
    s_waitcnt lgkmcnt(9)
    v_mfma_f32_16x16x32_bf16 v[44:47], v[16:19], v[216:219], v[44:47]
    ds_read_b64_tr_b16 v[32:33], v2 offset:28672
    v_lshl_add_u32 v12, v14, 6, v12
    v_and_b32 v14, 3, v0
    v_mfma_f32_16x16x32_bf16 v[48:51], v[16:19], v[220:223], v[48:51]
    ds_read_b64_tr_b16 v[34:35], v2 offset:28928
    s_waitcnt lgkmcnt(8)
    v_mfma_f32_16x16x32_bf16 v[52:55], v[20:23], v[216:219], v[52:55]
    ds_read_b128 v[76:79], v3 offset:640
    ds_read_b64_tr_b16 v[16:17], v8 offset:29696
    v_lshl_add_u32 v12, v14, 3, v12
    v_add_u32 v12, s65, v12
    v_mfma_f32_16x16x32_bf16 v[56:59], v[20:23], v[220:223], v[56:59]
    ds_read_b64_tr_b16 v[18:19], v8 offset:29952
    v_mfma_f32_16x16x32_bf16 v[68:71], v[80:83], v[200:203], v[68:71]
    v_mfma_f32_16x16x32_bf16 v[72:75], v[80:83], v[204:207], v[72:75]
    s_waitcnt lgkmcnt(9)
    v_mfma_f32_16x16x32_bf16 v[60:63], v[24:27], v[216:219], v[60:63]
    ds_read_b64_tr_b16 v[20:21], v2 offset:29696
    v_xor_b32 v13, 64, v12
    v_mfma_f32_16x16x32_bf16 v[64:67], v[24:27], v[220:223], v[64:67]
    ds_read_b64_tr_b16 v[22:23], v2 offset:29952
    s_waitcnt lgkmcnt(7)
    v_mfma_f32_16x16x32_bf16 v[36:39], v[28:31], v[224:227], v[36:39]
    ds_read_b128 v[232:235], v7 offset:28672
    ds_read_b64_tr_b16 v[24:25], v8 offset:32768
    v_mfma_f32_16x16x32_bf16 v[40:43], v[28:31], v[228:231], v[40:43]
    ds_read_b128 v[236:239], v7 offset:30720
    ds_read_b64_tr_b16 v[26:27], v8 offset:33024
    s_waitcnt lgkmcnt(9)
    v_mfma_f32_16x16x32_bf16 v[44:47], v[32:35], v[224:227], v[44:47]
    ds_read_b64_tr_b16 v[28:29], v2 offset:32768
    v_mfma_f32_16x16x32_bf16 v[48:51], v[32:35], v[228:231], v[48:51]
    ds_read_b64_tr_b16 v[30:31], v2 offset:33024
    s_waitcnt lgkmcnt(8)
    v_mfma_f32_16x16x32_bf16 v[52:55], v[16:19], v[224:227], v[52:55]
    ds_read_b128 v[80:83], v3 offset:704
    ds_read_b64_tr_b16 v[32:33], v8 offset:33792
    v_mfma_f32_16x16x32_bf16 v[56:59], v[16:19], v[228:231], v[56:59]
    ds_read_b64_tr_b16 v[34:35], v8 offset:34048
    v_mfma_f32_16x16x32_bf16 v[68:71], v[76:79], v[208:211], v[68:71]
    v_mfma_f32_16x16x32_bf16 v[72:75], v[76:79], v[212:215], v[72:75]
    s_waitcnt lgkmcnt(9)
    v_mfma_f32_16x16x32_bf16 v[60:63], v[20:23], v[224:227], v[60:63]
    ds_read_b64_tr_b16 v[16:17], v2 offset:33792
    v_mfma_f32_16x16x32_bf16 v[64:67], v[20:23], v[228:231], v[64:67]
    ds_read_b64_tr_b16 v[18:19], v2 offset:34048
    s_waitcnt lgkmcnt(7)
    v_mfma_f32_16x16x32_bf16 v[36:39], v[24:27], v[232:235], v[36:39]
    s_barrier
    v_add_u32 v8, 57344, v8
    v_add_u32 v2, 57344, v2
    ds_read_b128 v[240:243], v6 offset:57344
    ds_read_b64_tr_b16 v[20:21], v8 offset:0
    v_mfma_f32_16x16x32_bf16 v[40:43], v[24:27], v[236:239], v[40:43]
    ds_read_b128 v[244:247], v6 offset:59392
    ds_read_b64_tr_b16 v[22:23], v8 offset:256
    s_waitcnt lgkmcnt(9)
    v_mfma_f32_16x16x32_bf16 v[44:47], v[28:31], v[232:235], v[44:47]
    ds_read_b64_tr_b16 v[24:25], v2 offset:0
    v_mfma_f32_16x16x32_bf16 v[48:51], v[28:31], v[236:239], v[48:51]
    ds_read_b64_tr_b16 v[26:27], v2 offset:256
    s_waitcnt lgkmcnt(8)
    v_mfma_f32_16x16x32_bf16 v[52:55], v[32:35], v[232:235], v[52:55]
    ds_read_b128 v[76:79], v3 offset:768
    ds_read_b64_tr_b16 v[28:29], v8 offset:1024
    v_mfma_f32_16x16x32_bf16 v[56:59], v[32:35], v[236:239], v[56:59]
    ds_read_b64_tr_b16 v[30:31], v8 offset:1280
    v_mfma_f32_16x16x32_bf16 v[68:71], v[80:83], v[216:219], v[68:71]
    v_mfma_f32_16x16x32_bf16 v[72:75], v[80:83], v[220:223], v[72:75]
    s_waitcnt lgkmcnt(9)
    v_mfma_f32_16x16x32_bf16 v[60:63], v[16:19], v[232:235], v[60:63]
    ds_read_b64_tr_b16 v[32:33], v2 offset:1024
    v_mfma_f32_16x16x32_bf16 v[64:67], v[16:19], v[236:239], v[64:67]
    ds_read_b64_tr_b16 v[34:35], v2 offset:1280
    s_waitcnt lgkmcnt(7)
    v_mfma_f32_16x16x32_bf16 v[36:39], v[20:23], v[240:243], v[36:39]
    ds_read_b128 v[248:251], v7 offset:57344
    ds_read_b64_tr_b16 v[16:17], v8 offset:4096
    v_mfma_f32_16x16x32_bf16 v[40:43], v[20:23], v[244:247], v[40:43]
    ds_read_b128 v[252:255], v7 offset:59392
    ds_read_b64_tr_b16 v[18:19], v8 offset:4352
    s_waitcnt lgkmcnt(9)
    v_mfma_f32_16x16x32_bf16 v[44:47], v[24:27], v[240:243], v[44:47]
    ds_read_b64_tr_b16 v[20:21], v2 offset:4096
    v_mfma_f32_16x16x32_bf16 v[48:51], v[24:27], v[244:247], v[48:51]
    ds_read_b64_tr_b16 v[22:23], v2 offset:4352
    s_waitcnt lgkmcnt(8)
    v_mfma_f32_16x16x32_bf16 v[52:55], v[28:31], v[240:243], v[52:55]
    ds_read_b128 v[80:83], v3 offset:832
    ds_read_b64_tr_b16 v[24:25], v8 offset:5120
    v_mfma_f32_16x16x32_bf16 v[56:59], v[28:31], v[244:247], v[56:59]
    ds_read_b64_tr_b16 v[26:27], v8 offset:5376
    v_mfma_f32_16x16x32_bf16 v[68:71], v[76:79], v[224:227], v[68:71]
    v_mfma_f32_16x16x32_bf16 v[72:75], v[76:79], v[228:231], v[72:75]
    s_waitcnt lgkmcnt(9)
    v_mfma_f32_16x16x32_bf16 v[60:63], v[32:35], v[240:243], v[60:63]
    ds_read_b64_tr_b16 v[28:29], v2 offset:5120
    v_mfma_f32_16x16x32_bf16 v[64:67], v[32:35], v[244:247], v[64:67]
    ds_read_b64_tr_b16 v[30:31], v2 offset:5376
    ds_read_b128 v[84:87], v3 offset:896
    ds_read_b128 v[88:91], v3 offset:960
    s_waitcnt lgkmcnt(9)
    v_mfma_f32_16x16x32_bf16 v[36:39], v[16:19], v[248:251], v[36:39]
    v_mfma_f32_16x16x32_bf16 v[40:43], v[16:19], v[252:255], v[40:43]
    s_waitcnt lgkmcnt(7)
    v_mfma_f32_16x16x32_bf16 v[44:47], v[20:23], v[248:251], v[44:47]
    v_mfma_f32_16x16x32_bf16 v[48:51], v[20:23], v[252:255], v[48:51]
    s_waitcnt lgkmcnt(4)
    v_mfma_f32_16x16x32_bf16 v[52:55], v[24:27], v[248:251], v[52:55]
    v_mfma_f32_16x16x32_bf16 v[56:59], v[24:27], v[252:255], v[56:59]
    v_mfma_f32_16x16x32_bf16 v[68:71], v[80:83], v[232:235], v[68:71]
    v_mfma_f32_16x16x32_bf16 v[72:75], v[80:83], v[236:239], v[72:75]
    s_waitcnt lgkmcnt(2)
    v_mfma_f32_16x16x32_bf16 v[60:63], v[28:31], v[248:251], v[60:63]
    v_mfma_f32_16x16x32_bf16 v[64:67], v[28:31], v[252:255], v[64:67]
    s_waitcnt lgkmcnt(0)
    v_mfma_f32_16x16x32_bf16 v[68:71], v[84:87], v[240:243], v[68:71]
    v_mfma_f32_16x16x32_bf16 v[72:75], v[84:87], v[244:247], v[72:75]
    v_mfma_f32_16x16x32_bf16 v[68:71], v[88:91], v[248:251], v[68:71]
    v_mfma_f32_16x16x32_bf16 v[72:75], v[88:91], v[252:255], v[72:75]
    s_branch Lpack
Lcomp1:
    s_load_dwordx2 s[36:37], s[0:1], 72
    s_load_dwordx2 s[16:17], s[0:1], 80
    s_load_dwordx2 s[20:21], s[0:1], 80
    s_load_dwordx2 s[24:25], s[0:1], 48
    s_load_dwordx2 s[28:29], s[0:1], 16
    s_load_dwordx2 s[32:33], s[0:1], 64
    v_lshlrev_b32 v1, 4, v0
    s_and_b32 s48, s2, 4
    s_lshl_b32 s48, s48, 1
    s_lshr_b32 s74, s2, 5
    s_add_u32 s48, s48, s74
    s_mul_i32 s73, s2, 1
    s_add_u32 s73, s73, s48
    s_and_b32 s73, s73, 3
    s_mul_i32 s73, s73, 2
    s_and_b32 s47, s2, 3
    s_lshl_b32 s47, s47, 2
    s_bfe_u32 s74, s2, 0x20003
    s_add_u32 s47, s47, s74
    v_mov_b32 v16, 0
    v_mov_b32 v17, 2048
    ds_write2_b32 v17, v16, v16 offset0:0 offset1:1
    s_mov_b32 s38, 256
    s_mov_b32 s39, 0x20000
    v_and_b32 v3, 48, v0
    v_and_b32 v16, 15, v0
    s_lshl_b32 s74, s45, 12
    v_lshrrev_b32 v17, 4, v0
    v_lshrrev_b32 v18, 1, v16
    v_xor_b32 v18, v18, v17
    v_lshlrev_b32 v18, 4, v18
    v_lshl_add_u32 v18, v16, 7, v18
    v_add_u32 v6, s74, v18
    v_xor_b32 v7, 64, v6
    v_lshrrev_b32 v8, 5, v0
    v_mul_u32_u24 v8, 2048, v8
    v_bfe_u32 v16, v0, 4, 1
    v_mul_u32_u24 v16, 544, v16
    v_add_u32 v8, v8, v16
    v_bfe_u32 v16, v0, 2, 2
    v_lshl_add_u32 v8, v16, 6, v8
    v_and_b32 v16, 3, v0
    v_lshl_add_u32 v8, v16, 3, v8
    v_xor_b32 v2, 32, v8
    s_waitcnt lgkmcnt(0)
    s_mov_b32 s18, 15728640
    s_mov_b32 s19, 0x20000
    s_mov_b32 s22, 176128
    s_mov_b32 s23, 0x20000
    s_mov_b32 s26, 1409024
    s_mov_b32 s27, 0x20000
    s_mov_b32 s30, 524288
    s_mov_b32 s31, 0x20000
    s_mov_b32 s34, 2097152
    s_mov_b32 s35, 0x20000
    s_and_b32 s68, s47, 12
    s_lshr_b32 s68, 49284, s68
    s_and_b32 s68, s68, 12
    s_and_b32 s87, s47, 3
    s_add_u32 s87, s87, s68
    s_min_u32 s68, s87, 6
    s_mul_i32 s51, s87, 5
    s_add_u32 s51, s51, s68
    v_lshrrev_b32 v15, 5, v0
    v_mul_u32_u24 v15, 3072, v15
    v_bfe_u32 v14, v0, 4, 1
    v_mul_u32_u24 v14, 544, v14
    v_add_u32 v15, v15, v14
    v_bfe_u32 v14, v0, 2, 2
    v_lshl_add_u32 v15, v14, 6, v15
    v_and_b32 v14, 3, v0
    v_lshl_add_u32 v15, v14, 3, v15
    s_and_b32 s68, s51, 1
    s_add_u32 s68, s68, 3
    s_lshr_b32 s69, s68, 1
    s_lshl_b32 s69, s69, 10
    s_and_b32 s68, s68, 1
    s_lshl_b32 s68, s68, 5
    v_xor_b32 v9, s68, v15
    v_add_u32 v9, s69, v9
    s_and_b32 s68, s51, 1
    s_add_u32 s68, s68, 4
    s_lshr_b32 s69, s68, 1
    s_lshl_b32 s69, s69, 10
    s_and_b32 s68, s68, 1
    s_barrier
    ds_read_b128 v[128:131], v6 offset:4096
    ds_read_b64_tr_b16 v[16:17], v8 offset:20480
    ds_read_b128 v[132:135], v6 offset:6144
    ds_read_b64_tr_b16 v[18:19], v8 offset:20736
    ds_read_b64_tr_b16 v[20:21], v2 offset:20480
    ds_read_b64_tr_b16 v[22:23], v2 offset:20736
    ds_read_b64_tr_b16 v[24:25], v8 offset:21504
    ds_read_b64_tr_b16 v[26:27], v8 offset:21760
    ds_read_b64_tr_b16 v[28:29], v2 offset:21504
    ds_read_b64_tr_b16 v[30:31], v2 offset:21760
    s_waitcnt lgkmcnt(6)
    v_mfma_f32_16x16x32_bf16 v[36:39], v[128:131], v[16:19], 0
    ds_read_b128 v[136:139], v7 offset:4096
    ds_read_b64_tr_b16 v[32:33], v8 offset:24576
    s_lshl_b32 s68, s68, 5
    v_xor_b32 v10, s68, v15
    v_mfma_f32_16x16x32_bf16 v[44:47], v[132:135], v[16:19], 0
    ds_read_b128 v[140:143], v7 offset:6144
    ds_read_b64_tr_b16 v[34:35], v8 offset:24832
    s_waitcnt lgkmcnt(8)
    v_mfma_f32_16x16x32_bf16 v[40:43], v[128:131], v[20:23], 0
    ds_read_b64_tr_b16 v[16:17], v2 offset:24576
    v_add_u32 v10, s69, v10
    s_and_b32 s68, s51, 1
    v_mfma_f32_16x16x32_bf16 v[48:51], v[132:135], v[20:23], 0
    ds_read_b64_tr_b16 v[18:19], v2 offset:24832
    s_waitcnt lgkmcnt(8)
    v_mfma_f32_16x16x32_bf16 v[52:55], v[128:131], v[24:27], 0
    ds_read_b64_tr_b16 v[20:21], v8 offset:25600
    s_add_u32 s68, s68, 5
    s_lshr_b32 s69, s68, 1
    v_mfma_f32_16x16x32_bf16 v[60:63], v[132:135], v[24:27], 0
    ds_read_b64_tr_b16 v[22:23], v8 offset:25856
    s_waitcnt lgkmcnt(8)
    v_mfma_f32_16x16x32_bf16 v[56:59], v[128:131], v[28:31], 0
    ds_read_b64_tr_b16 v[24:25], v2 offset:25600
    s_lshl_b32 s69, s69, 10
    s_and_b32 s68, s68, 1
    v_mfma_f32_16x16x32_bf16 v[64:67], v[132:135], v[28:31], 0
    ds_read_b64_tr_b16 v[26:27], v2 offset:25856
    s_waitcnt lgkmcnt(6)
    v_mfma_f32_16x16x32_bf16 v[36:39], v[136:139], v[32:35], v[36:39]
    s_barrier
    ds_read_b128 v[144:147], v6 offset:32768
    ds_read_b64_tr_b16 v[28:29], v8 offset:49152
    s_lshl_b32 s68, s68, 5
    v_xor_b32 v11, s68, v15
    v_mfma_f32_16x16x32_bf16 v[44:47], v[140:143], v[32:35], v[44:47]
    ds_read_b128 v[148:151], v6 offset:34816
    ds_read_b64_tr_b16 v[30:31], v8 offset:49408
    s_waitcnt lgkmcnt(8)
    v_mfma_f32_16x16x32_bf16 v[40:43], v[136:139], v[16:19], v[40:43]
    ds_read_b64_tr_b16 v[32:33], v2 offset:49152
    v_add_u32 v11, s69, v11
    v_lshrrev_b32 v14, 5, v0
    v_mfma_f32_16x16x32_bf16 v[48:51], v[140:143], v[16:19], v[48:51]
    ds_read_b64_tr_b16 v[34:35], v2 offset:49408
    s_waitcnt lgkmcnt(8)
    v_mfma_f32_16x16x32_bf16 v[52:55], v[136:139], v[20:23], v[52:55]
    ds_read_b128 v[76:79], v3 offset:0
    ds_read_b64_tr_b16 v[16:17], v8 offset:50176
    v_lshlrev_b32 v127, 11, v14
    v_sub_u32 v126, v15, v127
    v_mfma_f32_16x16x32_bf16 v[60:63], v[140:143], v[20:23], v[60:63]
    ds_read_b64_tr_b16 v[18:19], v8 offset:50432
    s_waitcnt lgkmcnt(9)
    v_mfma_f32_16x16x32_bf16 v[56:59], v[136:139], v[24:27], v[56:59]
    ds_read_b64_tr_b16 v[20:21], v2 offset:50176
    s_and_b32 s49, s2, 7
    s_xor_b32 s49, s49, 4
    v_mfma_f32_16x16x32_bf16 v[64:67], v[140:143], v[24:27], v[64:67]
    ds_read_b64_tr_b16 v[22:23], v2 offset:50432
    s_waitcnt lgkmcnt(7)
    v_mfma_f32_16x16x32_bf16 v[36:39], v[144:147], v[28:31], v[36:39]
    ds_read_b128 v[152:155], v7 offset:32768
    ds_read_b64_tr_b16 v[24:25], v8 offset:53248
    s_lshl_b32 s49, s49, 2
    s_lshr_b32 s68, s2, 6
    v_mfma_f32_16x16x32_bf16 v[44:47], v[148:151], v[28:31], v[44:47]
    ds_read_b128 v[156:159], v7 offset:34816
    ds_read_b64_tr_b16 v[26:27], v8 offset:53504
    s_waitcnt lgkmcnt(9)
    v_mfma_f32_16x16x32_bf16 v[40:43], v[144:147], v[32:35], v[40:43]
    ds_read_b64_tr_b16 v[28:29], v2 offset:53248
    s_add_u32 s49, s49, s68
    s_mul_i32 s68, s49, 176128
    v_mfma_f32_16x16x32_bf16 v[48:51], v[148:151], v[32:35], v[48:51]
    ds_read_b64_tr_b16 v[30:31], v2 offset:53504
    s_waitcnt lgkmcnt(8)
    v_mfma_f32_16x16x32_bf16 v[52:55], v[144:147], v[16:19], v[52:55]
    ds_read_b128 v[80:83], v3 offset:64
    ds_read_b64_tr_b16 v[32:33], v8 offset:54272
    s_add_u32 s68, s68, 9437184
    s_add_u32 s20, s20, s68
    s_addc_u32 s21, s21, 0
    v_mfma_f32_16x16x32_bf16 v[60:63], v[148:151], v[16:19], v[60:63]
    ds_read_b64_tr_b16 v[34:35], v8 offset:54528
    v_mfma_f32_16x16x32_bf16 v[68:71], v[76:79], v[128:131], 0
    v_mfma_f32_16x16x32_bf16 v[72:75], v[76:79], v[132:135], 0
    s_waitcnt lgkmcnt(9)
    v_mfma_f32_16x16x32_bf16 v[56:59], v[144:147], v[20:23], v[56:59]
    ds_read_b64_tr_b16 v[16:17], v2 offset:54272
    s_bfe_u32 s50, s2, 0x30003
    s_mov_b32 s66, 0xffff
    v_mfma_f32_16x16x32_bf16 v[64:67], v[148:151], v[20:23], v[64:67]
    ds_read_b64_tr_b16 v[18:19], v2 offset:54528
    s_waitcnt lgkmcnt(7)
    v_mfma_f32_16x16x32_bf16 v[36:39], v[152:155], v[24:27], v[36:39]
    s_barrier
    v_add_u32 v8, 77824, v8
    v_add_u32 v2, 77824, v2
    ds_read_b128 v[160:163], v6 offset:61440
    ds_read_b64_tr_b16 v[20:21], v8 offset:0
    s_mov_b32 s67, 0xffff
    s_mov_b32 s76, 0xbdd2d3e8
    v_mfma_f32_16x16x32_bf16 v[44:47], v[156:159], v[24:27], v[44:47]
    ds_read_b128 v[164:167], v6 offset:63488
    ds_read_b64_tr_b16 v[22:23], v8 offset:256
    s_waitcnt lgkmcnt(9)
    v_mfma_f32_16x16x32_bf16 v[40:43], v[152:155], v[28:31], v[40:43]
    ds_read_b64_tr_b16 v[24:25], v2 offset:0
    s_mov_b32 s77, s76
    v_and_b32 v127, 15, v0
    v_mfma_f32_16x16x32_bf16 v[48:51], v[156:159], v[28:31], v[48:51]
    ds_read_b64_tr_b16 v[26:27], v2 offset:256
    s_waitcnt lgkmcnt(8)
    v_mfma_f32_16x16x32_bf16 v[52:55], v[152:155], v[32:35], v[52:55]
    ds_read_b128 v[76:79], v3 offset:128
    ds_read_b64_tr_b16 v[28:29], v8 offset:1024
    v_lshl_add_u32 v127, v14, 4, v127
    v_lshlrev_b32 v127, 4, v127
    v_mfma_f32_16x16x32_bf16 v[60:63], v[156:159], v[32:35], v[60:63]
    ds_read_b64_tr_b16 v[30:31], v8 offset:1280
    v_mfma_f32_16x16x32_bf16 v[68:71], v[80:83], v[136:139], v[68:71]
    v_mfma_f32_16x16x32_bf16 v[72:75], v[80:83], v[140:143], v[72:75]
    s_waitcnt lgkmcnt(9)
    v_mfma_f32_16x16x32_bf16 v[56:59], v[152:155], v[16:19], v[56:59]
    ds_read_b64_tr_b16 v[32:33], v2 offset:1024
    s_lshl_b32 s68, s48, 2
    s_add_u32 s68, s68, s45
    v_mfma_f32_16x16x32_bf16 v[64:67], v[156:159], v[16:19], v[64:67]
    ds_read_b64_tr_b16 v[34:35], v2 offset:1280
    s_waitcnt lgkmcnt(7)
    v_mfma_f32_16x16x32_bf16 v[36:39], v[160:163], v[20:23], v[36:39]
    ds_read_b128 v[168:171], v7 offset:61440
    ds_read_b64_tr_b16 v[16:17], v8 offset:4096
    s_lshr_b32 s63, s68, 1
    s_mul_i32 s63, s63, 86
    v_mfma_f32_16x16x32_bf16 v[44:47], v[164:167], v[20:23], v[44:47]
    ds_read_b128 v[172:175], v7 offset:63488
    ds_read_b64_tr_b16 v[18:19], v8 offset:4352
    s_waitcnt lgkmcnt(9)
    v_mfma_f32_16x16x32_bf16 v[40:43], v[160:163], v[24:27], v[40:43]
    ds_read_b64_tr_b16 v[20:21], v2 offset:4096
    s_add_u32 s63, s63, s51
    s_lshl_b32 s63, s63, 1
    v_mfma_f32_16x16x32_bf16 v[48:51], v[164:167], v[24:27], v[48:51]
    ds_read_b64_tr_b16 v[22:23], v2 offset:4352
    s_waitcnt lgkmcnt(8)
    v_mfma_f32_16x16x32_bf16 v[52:55], v[160:163], v[28:31], v[52:55]
    ds_read_b128 v[80:83], v3 offset:192
    ds_read_b64_tr_b16 v[24:25], v8 offset:5120
    s_and_b32 s69, s68, 1
    s_add_u32 s63, s63, s69
    v_mfma_f32_16x16x32_bf16 v[60:63], v[164:167], v[28:31], v[60:63]
    ds_read_b64_tr_b16 v[26:27], v8 offset:5376
    v_mfma_f32_16x16x32_bf16 v[68:71], v[76:79], v[144:147], v[68:71]
    v_mfma_f32_16x16x32_bf16 v[72:75], v[76:79], v[148:151], v[72:75]
    s_waitcnt lgkmcnt(9)
    v_mfma_f32_16x16x32_bf16 v[56:59], v[160:163], v[32:35], v[56:59]
    ds_read_b64_tr_b16 v[28:29], v2 offset:5120
    s_lshl_b32 s63, s63, 10
    s_add_u32 s63, s63, 9443328
    v_mfma_f32_16x16x32_bf16 v[64:67], v[164:167], v[32:35], v[64:67]
    ds_read_b64_tr_b16 v[30:31], v2 offset:5376
    s_waitcnt lgkmcnt(7)
    v_mfma_f32_16x16x32_bf16 v[36:39], v[168:171], v[16:19], v[36:39]
    s_barrier
    v_add_u32 v6, 90112, v6
    v_add_u32 v7, 90112, v7
    ds_read_b128 v[176:179], v6 offset:0
    ds_read_b64_tr_b16 v[32:33], v8 offset:28672
    s_lshl_b32 s85, s68, 4
    s_add_u32 s85, s85, s47
    v_mfma_f32_16x16x32_bf16 v[44:47], v[172:175], v[16:19], v[44:47]
    ds_read_b128 v[180:183], v6 offset:2048
    ds_read_b64_tr_b16 v[34:35], v8 offset:28928
    s_waitcnt lgkmcnt(9)
    v_mfma_f32_16x16x32_bf16 v[40:43], v[168:171], v[20:23], v[40:43]
    ds_read_b64_tr_b16 v[16:17], v2 offset:28672
    s_lshl_b32 s85, s85, 11
    s_add_u32 s85, s85, 6291456
    v_mfma_f32_16x16x32_bf16 v[48:51], v[172:175], v[20:23], v[48:51]
    ds_read_b64_tr_b16 v[18:19], v2 offset:28928
    s_waitcnt lgkmcnt(8)
    v_mfma_f32_16x16x32_bf16 v[52:55], v[168:171], v[24:27], v[52:55]
    ds_read_b128 v[76:79], v3 offset:256
    ds_read_b64_tr_b16 v[20:21], v8 offset:29696
    s_lshr_b32 s4, s47, 1
    s_lshl_b32 s4, s4, 8
    v_mfma_f32_16x16x32_bf16 v[60:63], v[172:175], v[24:27], v[60:63]
    ds_read_b64_tr_b16 v[22:23], v8 offset:29952
    v_mfma_f32_16x16x32_bf16 v[68:71], v[80:83], v[152:155], v[68:71]
    v_mfma_f32_16x16x32_bf16 v[72:75], v[80:83], v[156:159], v[72:75]
    s_waitcnt lgkmcnt(9)
    v_mfma_f32_16x16x32_bf16 v[56:59], v[168:171], v[28:31], v[56:59]
    ds_read_b64_tr_b16 v[24:25], v2 offset:29696
    s_add_u32 s4, s4, s68
    s_lshl_b32 s4, s4, 11
    v_mfma_f32_16x16x32_bf16 v[64:67], v[172:175], v[28:31], v[64:67]
    ds_read_b64_tr_b16 v[26:27], v2 offset:29952
    s_waitcnt lgkmcnt(7)
    v_mfma_f32_16x16x32_bf16 v[36:39], v[176:179], v[32:35], v[36:39]
    ds_read_b128 v[184:187], v7 offset:0
    ds_read_b64_tr_b16 v[28:29], v8 offset:32768
    s_add_u32 s4, s4, 2098176
    s_add_u32 s5, s4, 512
    v_mfma_f32_16x16x32_bf16 v[44:47], v[180:183], v[32:35], v[44:47]
    ds_read_b128 v[188:191], v7 offset:2048
    ds_read_b64_tr_b16 v[30:31], v8 offset:33024
    s_waitcnt lgkmcnt(9)
    v_mfma_f32_16x16x32_bf16 v[40:43], v[176:179], v[16:19], v[40:43]
    ds_read_b64_tr_b16 v[32:33], v2 offset:32768
    s_add_u32 s6, s4, 262144
    s_add_u32 s7, s4, 262656
    v_mfma_f32_16x16x32_bf16 v[48:51], v[180:183], v[16:19], v[48:51]
    ds_read_b64_tr_b16 v[34:35], v2 offset:33024
    s_waitcnt lgkmcnt(8)
    v_mfma_f32_16x16x32_bf16 v[52:55], v[176:179], v[20:23], v[52:55]
    ds_read_b128 v[80:83], v3 offset:320
    ds_read_b64_tr_b16 v[16:17], v8 offset:33792
    v_bfe_u32 v4, v0, 4, 1
    v_lshl_add_u32 v4, v4, 17, v127
    v_mfma_f32_16x16x32_bf16 v[60:63], v[180:183], v[20:23], v[60:63]
    ds_read_b64_tr_b16 v[18:19], v8 offset:34048
    v_mfma_f32_16x16x32_bf16 v[68:71], v[76:79], v[160:163], v[68:71]
    v_mfma_f32_16x16x32_bf16 v[72:75], v[76:79], v[164:167], v[72:75]
    s_waitcnt lgkmcnt(9)
    v_mfma_f32_16x16x32_bf16 v[56:59], v[176:179], v[24:27], v[56:59]
    ds_read_b64_tr_b16 v[20:21], v2 offset:33792
    s_lshl_b32 s61, s47, 3
    s_add_u32 s61, s61, s44
    v_mfma_f32_16x16x32_bf16 v[64:67], v[180:183], v[24:27], v[64:67]
    ds_read_b64_tr_b16 v[22:23], v2 offset:34048
    s_waitcnt lgkmcnt(7)
    v_mfma_f32_16x16x32_bf16 v[36:39], v[184:187], v[28:31], v[36:39]
    s_barrier
    v_add_u32 v8, 57344, v8
    v_add_u32 v2, 57344, v2
    ds_read_b128 v[192:195], v6 offset:28672
    ds_read_b64_tr_b16 v[24:25], v8 offset:0
    s_lshl_b32 s61, s61, 15
    s_add_u32 s61, s61, 2097152
    v_mfma_f32_16x16x32_bf16 v[44:47], v[188:191], v[28:31], v[44:47]
    ds_read_b128 v[196:199], v6 offset:30720
    ds_read_b64_tr_b16 v[26:27], v8 offset:256
    s_waitcnt lgkmcnt(9)
    v_mfma_f32_16x16x32_bf16 v[40:43], v[184:187], v[32:35], v[40:43]
    ds_read_b64_tr_b16 v[28:29], v2 offset:0
    s_and_b32 s62, s48, 7
    s_lshl_b32 s62, s62, 12
    v_mfma_f32_16x16x32_bf16 v[48:51], v[188:191], v[32:35], v[48:51]
    ds_read_b64_tr_b16 v[30:31], v2 offset:256
    s_waitcnt lgkmcnt(8)
    v_mfma_f32_16x16x32_bf16 v[52:55], v[184:187], v[16:19], v[52:55]
    ds_read_b128 v[76:79], v3 offset:384
    ds_read_b64_tr_b16 v[32:33], v8 offset:1024
    s_and_b32 s60, s47, 14
    s_lshl_b32 s60, s60, 2
    v_mfma_f32_16x16x32_bf16 v[60:63], v[188:191], v[16:19], v[60:63]
    ds_read_b64_tr_b16 v[34:35], v8 offset:1280
    v_mfma_f32_16x16x32_bf16 v[68:71], v[80:83], v[168:171], v[68:71]
    v_mfma_f32_16x16x32_bf16 v[72:75], v[80:83], v[172:175], v[72:75]
    s_waitcnt lgkmcnt(9)
    v_mfma_f32_16x16x32_bf16 v[56:59], v[184:187], v[20:23], v[56:59]
    ds_read_b64_tr_b16 v[16:17], v2 offset:1024
    s_add_u32 s60, s60, s45
    s_lshl_b32 s60, s60, 9
    v_mfma_f32_16x16x32_bf16 v[64:67], v[188:191], v[20:23], v[64:67]
    ds_read_b64_tr_b16 v[18:19], v2 offset:1280
    s_waitcnt lgkmcnt(7)
    v_mfma_f32_16x16x32_bf16 v[36:39], v[192:195], v[24:27], v[36:39]
    ds_read_b128 v[200:203], v7 offset:28672
    ds_read_b64_tr_b16 v[20:21], v8 offset:4096
    s_add_u32 s60, s60, 8388608
    s_add_u32 s40, s45, 1
    v_mfma_f32_16x16x32_bf16 v[44:47], v[196:199], v[24:27], v[44:47]
    ds_read_b128 v[204:207], v7 offset:30720
    ds_read_b64_tr_b16 v[22:23], v8 offset:4352
    s_waitcnt lgkmcnt(9)
    v_mfma_f32_16x16x32_bf16 v[40:43], v[192:195], v[28:31], v[40:43]
    ds_read_b64_tr_b16 v[24:25], v2 offset:4096
    s_and_b32 s40, s40, 3
    s_lshl_b32 s40, s40, 10
    v_mfma_f32_16x16x32_bf16 v[48:51], v[196:199], v[28:31], v[48:51]
    ds_read_b64_tr_b16 v[26:27], v2 offset:4352
    s_waitcnt lgkmcnt(8)
    v_mfma_f32_16x16x32_bf16 v[52:55], v[192:195], v[32:35], v[52:55]
    ds_read_b128 v[80:83], v3 offset:448
    ds_read_b64_tr_b16 v[28:29], v8 offset:5120
    s_add_u32 s40, s40, 147456
    s_add_u32 s41, s45, 2
    v_mfma_f32_16x16x32_bf16 v[60:63], v[196:199], v[32:35], v[60:63]
    ds_read_b64_tr_b16 v[30:31], v8 offset:5376
    v_mfma_f32_16x16x32_bf16 v[68:71], v[76:79], v[176:179], v[68:71]
    v_mfma_f32_16x16x32_bf16 v[72:75], v[76:79], v[180:183], v[72:75]
    s_waitcnt lgkmcnt(9)
    v_mfma_f32_16x16x32_bf16 v[56:59], v[192:195], v[16:19], v[56:59]
    ds_read_b64_tr_b16 v[32:33], v2 offset:5120
    s_and_b32 s41, s41, 3
    s_lshl_b32 s41, s41, 10
    v_mfma_f32_16x16x32_bf16 v[64:67], v[196:199], v[16:19], v[64:67]
    ds_read_b64_tr_b16 v[34:35], v2 offset:5376
    s_waitcnt lgkmcnt(7)
    v_mfma_f32_16x16x32_bf16 v[36:39], v[200:203], v[20:23], v[36:39]
    s_barrier
    v_subrev_u32 v6, 86016, v6
    v_subrev_u32 v7, 86016, v7
    v_subrev_u32 v8, 114688, v8
    v_subrev_u32 v2, 114688, v2
    ds_read_b128 v[208:211], v6 offset:0
    ds_read_b64_tr_b16 v[16:17], v8 offset:0
    s_add_u32 s41, s41, 147456
    s_add_u32 s42, s45, 3
    v_mfma_f32_16x16x32_bf16 v[44:47], v[204:207], v[20:23], v[44:47]
    ds_read_b128 v[212:215], v6 offset:2048
    ds_read_b64_tr_b16 v[18:19], v8 offset:256
    s_waitcnt lgkmcnt(9)
    v_mfma_f32_16x16x32_bf16 v[40:43], v[200:203], v[24:27], v[40:43]
    ds_read_b64_tr_b16 v[20:21], v2 offset:0
    s_and_b32 s42, s42, 3
    s_lshl_b32 s42, s42, 10
    v_mfma_f32_16x16x32_bf16 v[48:51], v[204:207], v[24:27], v[48:51]
    ds_read_b64_tr_b16 v[22:23], v2 offset:256
    s_waitcnt lgkmcnt(8)
    v_mfma_f32_16x16x32_bf16 v[52:55], v[200:203], v[28:31], v[52:55]
    ds_read_b128 v[76:79], v3 offset:512
    ds_read_b64_tr_b16 v[24:25], v8 offset:1024
    s_add_u32 s42, s42, 147456
    s_add_u32 s43, s45, 4
    v_mfma_f32_16x16x32_bf16 v[60:63], v[204:207], v[28:31], v[60:63]
    ds_read_b64_tr_b16 v[26:27], v8 offset:1280
    v_mfma_f32_16x16x32_bf16 v[68:71], v[80:83], v[184:187], v[68:71]
    v_mfma_f32_16x16x32_bf16 v[72:75], v[80:83], v[188:191], v[72:75]
    s_waitcnt lgkmcnt(9)
    v_mfma_f32_16x16x32_bf16 v[56:59], v[200:203], v[32:35], v[56:59]
    ds_read_b64_tr_b16 v[28:29], v2 offset:1024
    s_and_b32 s43, s43, 3
    s_lshl_b32 s43, s43, 10
    v_mfma_f32_16x16x32_bf16 v[64:67], v[204:207], v[32:35], v[64:67]
    ds_read_b64_tr_b16 v[30:31], v2 offset:1280
    s_waitcnt lgkmcnt(7)
    v_mfma_f32_16x16x32_bf16 v[36:39], v[208:211], v[16:19], v[36:39]
    ds_read_b128 v[216:219], v7 offset:0
    ds_read_b64_tr_b16 v[32:33], v8 offset:4096
    s_add_u32 s43, s43, 147456
    s_mul_i32 s65, s44, 7168
    v_mfma_f32_16x16x32_bf16 v[44:47], v[212:215], v[16:19], v[44:47]
    ds_read_b128 v[220:223], v7 offset:2048
    ds_read_b64_tr_b16 v[34:35], v8 offset:4352
    s_waitcnt lgkmcnt(9)
    v_mfma_f32_16x16x32_bf16 v[40:43], v[208:211], v[20:23], v[40:43]
    ds_read_b64_tr_b16 v[16:17], v2 offset:4096
    s_mul_i32 s64, s44, 180224
    s_lshl_b32 s68, s50, 7
    v_mfma_f32_16x16x32_bf16 v[48:51], v[212:215], v[20:23], v[48:51]
    ds_read_b64_tr_b16 v[18:19], v2 offset:4352
    s_waitcnt lgkmcnt(8)
    v_mfma_f32_16x16x32_bf16 v[52:55], v[208:211], v[24:27], v[52:55]
    ds_read_b128 v[80:83], v3 offset:576
    ds_read_b64_tr_b16 v[20:21], v8 offset:5120
    s_add_u32 s64, s64, s68
    v_bfe_u32 v12, v0, 2, 2
    v_mfma_f32_16x16x32_bf16 v[60:63], v[212:215], v[24:27], v[60:63]
    ds_read_b64_tr_b16 v[22:23], v8 offset:5376
    v_mfma_f32_16x16x32_bf16 v[68:71], v[76:79], v[192:195], v[68:71]
    v_mfma_f32_16x16x32_bf16 v[72:75], v[76:79], v[196:199], v[72:75]
    s_waitcnt lgkmcnt(9)
    v_mfma_f32_16x16x32_bf16 v[56:59], v[208:211], v[28:31], v[56:59]
    ds_read_b64_tr_b16 v[24:25], v2 offset:5120
    v_lshl_add_u32 v12, v14, 3, v12
    v_lshlrev_b32 v12, 7, v12
    v_mfma_f32_16x16x32_bf16 v[64:67], v[212:215], v[28:31], v[64:67]
    ds_read_b64_tr_b16 v[26:27], v2 offset:5376
    s_waitcnt lgkmcnt(7)
    v_mfma_f32_16x16x32_bf16 v[36:39], v[216:219], v[32:35], v[36:39]
    s_barrier
    ds_read_b128 v[224:227], v6 offset:28672
    ds_read_b64_tr_b16 v[28:29], v8 offset:28672
    v_bfe_u32 v14, v0, 4, 1
    v_lshl_add_u32 v12, v14, 5, v12
    v_mfma_f32_16x16x32_bf16 v[44:47], v[220:223], v[32:35], v[44:47]
    ds_read_b128 v[228:231], v6 offset:30720
    ds_read_b64_tr_b16 v[30:31], v8 offset:28928
    s_waitcnt lgkmcnt(9)
    v_mfma_f32_16x16x32_bf16 v[40:43], v[216:219], v[16:19], v[40:43]
    ds_read_b64_tr_b16 v[32:33], v2 offset:28672
    v_bfe_u32 v14, v0, 3, 1
    v_lshl_add_u32 v12, v14, 6, v12
    v_mfma_f32_16x16x32_bf16 v[48:51], v[220:223], v[16:19], v[48:51]
    ds_read_b64_tr_b16 v[34:35], v2 offset:28928
    s_waitcnt lgkmcnt(8)
    v_mfma_f32_16x16x32_bf16 v[52:55], v[216:219], v[20:23], v[52:55]
    ds_read_b128 v[76:79], v3 offset:640
    ds_read_b64_tr_b16 v[16:17], v8 offset:29696
    v_and_b32 v14, 3, v0
    v_lshl_add_u32 v12, v14, 3, v12
    v_mfma_f32_16x16x32_bf16 v[60:63], v[220:223], v[20:23], v[60:63]
    ds_read_b64_tr_b16 v[18:19], v8 offset:29952
    v_mfma_f32_16x16x32_bf16 v[68:71], v[80:83], v[200:203], v[68:71]
    v_mfma_f32_16x16x32_bf16 v[72:75], v[80:83], v[204:207], v[72:75]
    s_waitcnt lgkmcnt(9)
    v_mfma_f32_16x16x32_bf16 v[56:59], v[216:219], v[24:27], v[56:59]
    ds_read_b64_tr_b16 v[20:21], v2 offset:29696
    v_add_u32 v12, s65, v12
    v_xor_b32 v13, 64, v12
    v_mfma_f32_16x16x32_bf16 v[64:67], v[220:223], v[24:27], v[64:67]
    ds_read_b64_tr_b16 v[22:23], v2 offset:29952
    s_waitcnt lgkmcnt(7)
    v_mfma_f32_16x16x32_bf16 v[36:39], v[224:227], v[28:31], v[36:39]
    ds_read_b128 v[232:235], v7 offset:28672
    ds_read_b64_tr_b16 v[24:25], v8 offset:32768
    v_mfma_f32_16x16x32_bf16 v[44:47], v[228:231], v[28:31], v[44:47]
    ds_read_b128 v[236:239], v7 offset:30720
    ds_read_b64_tr_b16 v[26:27], v8 offset:33024
    s_waitcnt lgkmcnt(9)
    v_mfma_f32_16x16x32_bf16 v[40:43], v[224:227], v[32:35], v[40:43]
    ds_read_b64_tr_b16 v[28:29], v2 offset:32768
    v_mfma_f32_16x16x32_bf16 v[48:51], v[228:231], v[32:35], v[48:51]
    ds_read_b64_tr_b16 v[30:31], v2 offset:33024
    s_waitcnt lgkmcnt(8)
    v_mfma_f32_16x16x32_bf16 v[52:55], v[224:227], v[16:19], v[52:55]
    ds_read_b128 v[80:83], v3 offset:704
    ds_read_b64_tr_b16 v[32:33], v8 offset:33792
    v_mfma_f32_16x16x32_bf16 v[60:63], v[228:231], v[16:19], v[60:63]
    ds_read_b64_tr_b16 v[34:35], v8 offset:34048
    v_mfma_f32_16x16x32_bf16 v[68:71], v[76:79], v[208:211], v[68:71]
    v_mfma_f32_16x16x32_bf16 v[72:75], v[76:79], v[212:215], v[72:75]
    s_waitcnt lgkmcnt(9)
    v_mfma_f32_16x16x32_bf16 v[56:59], v[224:227], v[20:23], v[56:59]
    ds_read_b64_tr_b16 v[16:17], v2 offset:33792
    v_mfma_f32_16x16x32_bf16 v[64:67], v[228:231], v[20:23], v[64:67]
    ds_read_b64_tr_b16 v[18:19], v2 offset:34048
    s_waitcnt lgkmcnt(7)
    v_mfma_f32_16x16x32_bf16 v[36:39], v[232:235], v[24:27], v[36:39]
    s_barrier
    v_add_u32 v8, 57344, v8
    v_add_u32 v2, 57344, v2
    ds_read_b128 v[240:243], v6 offset:57344
    ds_read_b64_tr_b16 v[20:21], v8 offset:0
    v_mfma_f32_16x16x32_bf16 v[44:47], v[236:239], v[24:27], v[44:47]
    ds_read_b128 v[244:247], v6 offset:59392
    ds_read_b64_tr_b16 v[22:23], v8 offset:256
    s_waitcnt lgkmcnt(9)
    v_mfma_f32_16x16x32_bf16 v[40:43], v[232:235], v[28:31], v[40:43]
    ds_read_b64_tr_b16 v[24:25], v2 offset:0
    v_mfma_f32_16x16x32_bf16 v[48:51], v[236:239], v[28:31], v[48:51]
    ds_read_b64_tr_b16 v[26:27], v2 offset:256
    s_waitcnt lgkmcnt(8)
    v_mfma_f32_16x16x32_bf16 v[52:55], v[232:235], v[32:35], v[52:55]
    ds_read_b128 v[76:79], v3 offset:768
    ds_read_b64_tr_b16 v[28:29], v8 offset:1024
    v_mfma_f32_16x16x32_bf16 v[60:63], v[236:239], v[32:35], v[60:63]
    ds_read_b64_tr_b16 v[30:31], v8 offset:1280
    v_mfma_f32_16x16x32_bf16 v[68:71], v[80:83], v[216:219], v[68:71]
    v_mfma_f32_16x16x32_bf16 v[72:75], v[80:83], v[220:223], v[72:75]
    s_waitcnt lgkmcnt(9)
    v_mfma_f32_16x16x32_bf16 v[56:59], v[232:235], v[16:19], v[56:59]
    ds_read_b64_tr_b16 v[32:33], v2 offset:1024
    v_mfma_f32_16x16x32_bf16 v[64:67], v[236:239], v[16:19], v[64:67]
    ds_read_b64_tr_b16 v[34:35], v2 offset:1280
    s_waitcnt lgkmcnt(7)
    v_mfma_f32_16x16x32_bf16 v[36:39], v[240:243], v[20:23], v[36:39]
    ds_read_b128 v[248:251], v7 offset:57344
    ds_read_b64_tr_b16 v[16:17], v8 offset:4096
    v_mfma_f32_16x16x32_bf16 v[44:47], v[244:247], v[20:23], v[44:47]
    ds_read_b128 v[252:255], v7 offset:59392
    ds_read_b64_tr_b16 v[18:19], v8 offset:4352
    s_waitcnt lgkmcnt(9)
    v_mfma_f32_16x16x32_bf16 v[40:43], v[240:243], v[24:27], v[40:43]
    ds_read_b64_tr_b16 v[20:21], v2 offset:4096
    v_mfma_f32_16x16x32_bf16 v[48:51], v[244:247], v[24:27], v[48:51]
    ds_read_b64_tr_b16 v[22:23], v2 offset:4352
    s_waitcnt lgkmcnt(8)
    v_mfma_f32_16x16x32_bf16 v[52:55], v[240:243], v[28:31], v[52:55]
    ds_read_b128 v[80:83], v3 offset:832
    ds_read_b64_tr_b16 v[24:25], v8 offset:5120
    v_mfma_f32_16x16x32_bf16 v[60:63], v[244:247], v[28:31], v[60:63]
    ds_read_b64_tr_b16 v[26:27], v8 offset:5376
    v_mfma_f32_16x16x32_bf16 v[68:71], v[76:79], v[224:227], v[68:71]
    v_mfma_f32_16x16x32_bf16 v[72:75], v[76:79], v[228:231], v[72:75]
    s_waitcnt lgkmcnt(9)
    v_mfma_f32_16x16x32_bf16 v[56:59], v[240:243], v[32:35], v[56:59]
    ds_read_b64_tr_b16 v[28:29], v2 offset:5120
    v_mfma_f32_16x16x32_bf16 v[64:67], v[244:247], v[32:35], v[64:67]
    ds_read_b64_tr_b16 v[30:31], v2 offset:5376
    ds_read_b128 v[84:87], v3 offset:896
    ds_read_b128 v[88:91], v3 offset:960
    s_waitcnt lgkmcnt(9)
    v_mfma_f32_16x16x32_bf16 v[36:39], v[248:251], v[16:19], v[36:39]
    v_mfma_f32_16x16x32_bf16 v[44:47], v[252:255], v[16:19], v[44:47]
    s_waitcnt lgkmcnt(7)
    v_mfma_f32_16x16x32_bf16 v[40:43], v[248:251], v[20:23], v[40:43]
    v_mfma_f32_16x16x32_bf16 v[48:51], v[252:255], v[20:23], v[48:51]
    s_waitcnt lgkmcnt(4)
    v_mfma_f32_16x16x32_bf16 v[52:55], v[248:251], v[24:27], v[52:55]
    v_mfma_f32_16x16x32_bf16 v[60:63], v[252:255], v[24:27], v[60:63]
    v_mfma_f32_16x16x32_bf16 v[68:71], v[80:83], v[232:235], v[68:71]
    v_mfma_f32_16x16x32_bf16 v[72:75], v[80:83], v[236:239], v[72:75]
    s_waitcnt lgkmcnt(2)
    v_mfma_f32_16x16x32_bf16 v[56:59], v[248:251], v[28:31], v[56:59]
    v_mfma_f32_16x16x32_bf16 v[64:67], v[252:255], v[28:31], v[64:67]
    s_waitcnt lgkmcnt(0)
    v_mfma_f32_16x16x32_bf16 v[68:71], v[84:87], v[240:243], v[68:71]
    v_mfma_f32_16x16x32_bf16 v[72:75], v[84:87], v[244:247], v[72:75]
    v_mfma_f32_16x16x32_bf16 v[68:71], v[88:91], v[248:251], v[68:71]
    v_mfma_f32_16x16x32_bf16 v[72:75], v[88:91], v[252:255], v[72:75]
Lpack:
    s_mul_i32 s68, s47, 43691
    s_lshr_b32 s68, s68, 17
    s_mul_i32 s68, s68, 3
    v_cvt_pk_bf16_f32 v36, v36, v37
    v_cvt_pk_bf16_f32 v37, v38, v39
    v_cvt_pk_bf16_f32 v38, v40, v41
    v_cvt_pk_bf16_f32 v39, v42, v43
    s_nop 0
    v_permlane16_swap_b32 v36, v38
    v_permlane16_swap_b32 v37, v39
    v_cvt_pk_bf16_f32 v40, v44, v45
    v_cvt_pk_bf16_f32 v41, v46, v47
    v_cvt_pk_bf16_f32 v42, v48, v49
    v_cvt_pk_bf16_f32 v43, v50, v51
    s_nop 0
    v_permlane16_swap_b32 v40, v42
    v_permlane16_swap_b32 v41, v43
    v_cvt_pk_bf16_f32 v44, v52, v53
    v_cvt_pk_bf16_f32 v45, v54, v55
    v_cvt_pk_bf16_f32 v46, v56, v57
    v_cvt_pk_bf16_f32 v47, v58, v59
    s_nop 0
    v_permlane16_swap_b32 v44, v46
    v_permlane16_swap_b32 v45, v47
    v_cvt_pk_bf16_f32 v48, v60, v61
    v_cvt_pk_bf16_f32 v49, v62, v63
    v_cvt_pk_bf16_f32 v50, v64, v65
    v_cvt_pk_bf16_f32 v51, v66, v67
    s_nop 0
    v_permlane16_swap_b32 v48, v50
    v_permlane16_swap_b32 v49, v51
    v_and_b32 v14, 16, v0
    v_cmp_eq_u32 vcc, 0, v14
    s_lshl_b32 s69, s45, 8
    v_lshl_add_u32 v14, v0, 2, s69
    v_cndmask_b32 v15, v72, v68, vcc
    ds_write_b32 v14, v15 offset:1024
    s_cmp_lt_u32 s87, 6
    s_cbranch_scc1 Lsix
    s_barrier
    v_add_u32 v9, 90112, v9
    v_add_u32 v10, 90112, v10
    v_add_u32 v126, 90112, v126
    ds_read_b64_tr_b16 v[16:17], v126 offset:24576
    ds_read_b64_tr_b16 v[18:19], v126 offset:24832
    ds_read_b64_tr_b16 v[20:21], v9 offset:0
    ds_read_b64_tr_b16 v[22:23], v9 offset:256
    ds_read_b64_tr_b16 v[24:25], v10 offset:0
    ds_read_b64_tr_b16 v[26:27], v10 offset:256
    ds_read_b64_tr_b16 v[28:29], v9 offset:6144
    ds_read_b64_tr_b16 v[30:31], v9 offset:6400
    s_waitcnt lgkmcnt(6)
    v_mfma_f32_16x16x32_bf16 v[52:55], v[16:19], v[128:131], 0
    ds_read_b64_tr_b16 v[32:33], v10 offset:6144
    v_mfma_f32_16x16x32_bf16 v[56:59], v[16:19], v[132:135], 0
    ds_read_b64_tr_b16 v[34:35], v10 offset:6400
    buffer_store_dwordx4 v[36:39], v4, s[16:19], s4 offen sc1
    s_waitcnt lgkmcnt(6)
    v_mfma_f32_16x16x32_bf16 v[68:71], v[20:23], v[128:131], 0
    ds_read_b64_tr_b16 v[16:17], v126 offset:26624
    v_mfma_f32_16x16x32_bf16 v[72:75], v[20:23], v[132:135], 0
    ds_read_b64_tr_b16 v[18:19], v126 offset:26880
    s_waitcnt lgkmcnt(6)
    v_mfma_f32_16x16x32_bf16 v[84:87], v[24:27], v[128:131], 0
    ds_read_b64_tr_b16 v[20:21], v9 offset:12288
    v_mfma_f32_16x16x32_bf16 v[88:91], v[24:27], v[132:135], 0
    ds_read_b64_tr_b16 v[22:23], v9 offset:12544
    s_waitcnt lgkmcnt(6)
    v_mfma_f32_16x16x32_bf16 v[68:71], v[28:31], v[136:139], v[68:71]
    ds_read_b64_tr_b16 v[24:25], v10 offset:12288
    v_mfma_f32_16x16x32_bf16 v[72:75], v[28:31], v[140:143], v[72:75]
    ds_read_b64_tr_b16 v[26:27], v10 offset:12544
    buffer_load_dwordx2 v[116:117], off, s[36:39], 0 sc1
    s_waitcnt lgkmcnt(6)
    v_mfma_f32_16x16x32_bf16 v[84:87], v[32:35], v[136:139], v[84:87]
    ds_read_b64_tr_b16 v[28:29], v9 offset:18432
    v_mfma_f32_16x16x32_bf16 v[88:91], v[32:35], v[140:143], v[88:91]
    ds_read_b64_tr_b16 v[30:31], v9 offset:18688
    s_waitcnt lgkmcnt(6)
    v_mfma_f32_16x16x32_bf16 v[52:55], v[16:19], v[136:139], v[52:55]
    ds_read_b64_tr_b16 v[32:33], v10 offset:18432
    v_mfma_f32_16x16x32_bf16 v[56:59], v[16:19], v[140:143], v[56:59]
    ds_read_b64_tr_b16 v[34:35], v10 offset:18688
    buffer_store_dwordx4 v[40:43], v4, s[16:19], s5 offen sc1
    s_waitcnt lgkmcnt(6)
    v_mfma_f32_16x16x32_bf16 v[68:71], v[20:23], v[144:147], v[68:71]
    s_barrier
    ds_read_b64_tr_b16 v[16:17], v126 offset:53248
    s_lshl_b32 s68, s45, 8
    v_and_b32 v124, 15, v0
    v_mfma_f32_16x16x32_bf16 v[72:75], v[20:23], v[148:151], v[72:75]
    ds_read_b64_tr_b16 v[18:19], v126 offset:53504
    s_waitcnt lgkmcnt(6)
    v_mfma_f32_16x16x32_bf16 v[84:87], v[24:27], v[144:147], v[84:87]
    ds_read_b64_tr_b16 v[20:21], v9 offset:28672
    v_lshl_add_u32 v124, v124, 2, s68
    v_add_u32 v124, 1024, v124
    v_mfma_f32_16x16x32_bf16 v[88:91], v[24:27], v[148:151], v[88:91]
    ds_read_b64_tr_b16 v[22:23], v9 offset:28928
    s_waitcnt lgkmcnt(6)
    v_mfma_f32_16x16x32_bf16 v[68:71], v[28:31], v[152:155], v[68:71]
    ds_read_b64_tr_b16 v[24:25], v10 offset:28672
    ds_read2_b32 v[124:125], v124 offset0:0 offset1:16
    v_and_b32 v6, 4, v0
    v_mfma_f32_16x16x32_bf16 v[72:75], v[28:31], v[156:159], v[72:75]
    ds_read_b64_tr_b16 v[26:27], v10 offset:28928
    s_waitcnt lgkmcnt(7)
    v_mfma_f32_16x16x32_bf16 v[84:87], v[32:35], v[152:155], v[84:87]
    ds_read_b64_tr_b16 v[28:29], v9 offset:34816
    v_mul_u32_u24 v6, 3, v6
    v_mfma_f32_16x16x32_bf16 v[88:91], v[32:35], v[156:159], v[88:91]
    ds_read_b64_tr_b16 v[30:31], v9 offset:35072
    buffer_store_dwordx4 v[44:47], v4, s[16:19], s6 offen sc1
    s_waitcnt lgkmcnt(7)
    v_mfma_f32_16x16x32_bf16 v[52:55], v[16:19], v[144:147], v[52:55]
    ds_read_b64_tr_b16 v[32:33], v10 offset:34816
    v_add_u32 v6, v6, v0
    v_lshl_add_u32 v6, v6, 7, s60
    v_mfma_f32_16x16x32_bf16 v[56:59], v[16:19], v[148:151], v[56:59]
    ds_read_b64_tr_b16 v[34:35], v10 offset:35072
    s_waitcnt lgkmcnt(7)
    v_mfma_f32_16x16x32_bf16 v[68:71], v[20:23], v[160:163], v[68:71]
    ds_read_b64_tr_b16 v[16:17], v126 offset:55296
    v_lshrrev_b32 v2, 3, v0
    v_lshrrev_b32 v14, 2, v0
    v_mfma_f32_16x16x32_bf16 v[72:75], v[20:23], v[164:167], v[72:75]
    ds_read_b64_tr_b16 v[18:19], v126 offset:55552
    s_waitcnt lgkmcnt(6)
    v_mfma_f32_16x16x32_bf16 v[84:87], v[24:27], v[160:163], v[84:87]
    ds_read_b64_tr_b16 v[20:21], v9 offset:40960
    v_and_b32 v14, 4, v14
    v_xor_b32 v14, v14, v0
    v_mfma_f32_16x16x32_bf16 v[88:91], v[24:27], v[164:167], v[88:91]
    ds_read_b64_tr_b16 v[22:23], v9 offset:41216
    s_waitcnt lgkmcnt(6)
    v_mfma_f32_16x16x32_bf16 v[68:71], v[28:31], v[168:171], v[68:71]
    ds_read_b64_tr_b16 v[24:25], v10 offset:40960
    v_and_b32 v14, 7, v14
    v_mfma_f32_16x16x32_bf16 v[72:75], v[28:31], v[172:175], v[72:75]
    ds_read_b64_tr_b16 v[26:27], v10 offset:41216
    buffer_store_dwordx4 v[48:51], v4, s[16:19], s7 offen sc1
    s_waitcnt lgkmcnt(6)
    v_mfma_f32_16x16x32_bf16 v[84:87], v[32:35], v[168:171], v[84:87]
    ds_read_b64_tr_b16 v[28:29], v9 offset:47104
    v_lshlrev_b32 v14, 4, v14
    v_lshl_add_u32 v2, v2, 10, v14
    v_mfma_f32_16x16x32_bf16 v[88:91], v[32:35], v[172:175], v[88:91]
    ds_read_b64_tr_b16 v[30:31], v9 offset:47360
    s_waitcnt lgkmcnt(6)
    v_mfma_f32_16x16x32_bf16 v[52:55], v[16:19], v[152:155], v[52:55]
    ds_read_b64_tr_b16 v[32:33], v10 offset:47104
    v_add_u32 v3, 7168, v2
    v_add_u32 v7, s65, v1
    v_mfma_f32_16x16x32_bf16 v[56:59], v[16:19], v[156:159], v[56:59]
    ds_read_b64_tr_b16 v[34:35], v10 offset:47360
    s_waitcnt lgkmcnt(6)
    v_mfma_f32_16x16x32_bf16 v[68:71], v[20:23], v[176:179], v[68:71]
    s_barrier
    v_subrev_u32 v9, 86016, v9
    v_subrev_u32 v10, 86016, v10
    v_subrev_u32 v126, 86016, v126
    ds_read_b64_tr_b16 v[16:17], v126 offset:24576
    s_waitcnt vmcnt(3)
    v_cmp_eq_u32 vcc, 0, v117
    s_cbranch_vccnz Lnonr_8
Lnonc_9:
    v_readfirstlane_b32 s58, v116
    v_readfirstlane_b32 s59, v117
    v_lshl_add_u32 v8, v0, 2, s65
    v_mfma_f32_16x16x32_bf16 v[72:75], v[20:23], v[180:183], v[72:75]
    ds_read_b64_tr_b16 v[18:19], v126 offset:24832
    s_waitcnt lgkmcnt(6)
    v_mfma_f32_16x16x32_bf16 v[84:87], v[24:27], v[176:179], v[84:87]
    ds_read_b64_tr_b16 v[20:21], v9 offset:0
    v_mul_f32 v124, 0x3fb8aa3b, v124
    v_mul_f32 v125, 0x3fb8aa3b, v125
    v_mfma_f32_16x16x32_bf16 v[88:91], v[24:27], v[180:183], v[88:91]
    ds_read_b64_tr_b16 v[22:23], v9 offset:256
    s_waitcnt lgkmcnt(6)
    v_mfma_f32_16x16x32_bf16 v[68:71], v[28:31], v[184:187], v[68:71]
    ds_read_b64_tr_b16 v[24:25], v10 offset:0
    v_exp_f32 v124, v124
    v_exp_f32 v125, v125
    v_mfma_f32_16x16x32_bf16 v[72:75], v[28:31], v[188:191], v[72:75]
    ds_read_b64_tr_b16 v[26:27], v10 offset:256
    s_waitcnt lgkmcnt(6)
    v_mfma_f32_16x16x32_bf16 v[84:87], v[32:35], v[184:187], v[84:87]
    ds_read_b64_tr_b16 v[28:29], v9 offset:6144
    v_add_f32 v124, 1.0, v124
    v_add_f32 v125, 1.0, v125
    v_mfma_f32_16x16x32_bf16 v[88:91], v[32:35], v[188:191], v[88:91]
    ds_read_b64_tr_b16 v[30:31], v9 offset:6400
    s_waitcnt lgkmcnt(6)
    v_mfma_f32_16x16x32_bf16 v[52:55], v[16:19], v[160:163], v[52:55]
    ds_read_b64_tr_b16 v[32:33], v10 offset:6144
    v_mov_b32 v60, 0xc0135761
    v_mov_b32 v61, v60
    v_mfma_f32_16x16x32_bf16 v[56:59], v[16:19], v[164:167], v[56:59]
    ds_read_b64_tr_b16 v[34:35], v10 offset:6400
    s_waitcnt lgkmcnt(6)
    v_mfma_f32_16x16x32_bf16 v[68:71], v[20:23], v[192:195], v[68:71]
    ds_read_b64_tr_b16 v[16:17], v126 offset:26624
    v_min_f32 v62, 0x71800000, v124
    v_min_f32 v63, 0x71800000, v124
    v_mfma_f32_16x16x32_bf16 v[72:75], v[20:23], v[196:199], v[72:75]
    ds_read_b64_tr_b16 v[18:19], v126 offset:26880
    s_waitcnt lgkmcnt(6)
    v_mfma_f32_16x16x32_bf16 v[84:87], v[24:27], v[192:195], v[84:87]
    ds_read_b64_tr_b16 v[20:21], v9 offset:12288
    v_min_f32 v64, 0x71800000, v125
    v_min_f32 v65, 0x71800000, v125
    v_mfma_f32_16x16x32_bf16 v[88:91], v[24:27], v[196:199], v[88:91]
    ds_read_b64_tr_b16 v[22:23], v9 offset:12544
    s_waitcnt lgkmcnt(6)
    v_mfma_f32_16x16x32_bf16 v[68:71], v[28:31], v[200:203], v[68:71]
    ds_read_b64_tr_b16 v[24:25], v10 offset:12288
    v_add_u32 v124, s61, v1
    v_add_u32 v125, s61, v127
    v_mfma_f32_16x16x32_bf16 v[72:75], v[28:31], v[204:207], v[72:75]
    ds_read_b64_tr_b16 v[26:27], v10 offset:12544
    s_waitcnt lgkmcnt(6)
    v_mfma_f32_16x16x32_bf16 v[84:87], v[32:35], v[200:203], v[84:87]
    ds_read_b64_tr_b16 v[28:29], v9 offset:18432
    v_and_b32 v37, 27, v0
    v_cmp_eq_u32 vcc, 16, v37
    v_mfma_f32_16x16x32_bf16 v[88:91], v[32:35], v[204:207], v[88:91]
    ds_read_b64_tr_b16 v[30:31], v9 offset:18688
    s_waitcnt lgkmcnt(6)
    v_mfma_f32_16x16x32_bf16 v[52:55], v[16:19], v[168:171], v[52:55]
    ds_read_b64_tr_b16 v[32:33], v10 offset:18432
    v_mov_b32 v37, 0x3f803f80
    v_cndmask_b32 v36, 0, v37, vcc
    v_mfma_f32_16x16x32_bf16 v[56:59], v[16:19], v[172:175], v[56:59]
    ds_read_b64_tr_b16 v[34:35], v10 offset:18688
    s_waitcnt lgkmcnt(6)
    v_mfma_f32_16x16x32_bf16 v[68:71], v[20:23], v[208:211], v[68:71]
    s_waitcnt vmcnt(0)
    s_barrier
    ds_read_b64_tr_b16 v[16:17], v126 offset:53248
    s_cmp_lg_u32 s44, 0
    s_cbranch_scc1 Lf1_10
    s_lshl_b32 s75, s47, 4
    s_add_u32 s75, s75, s48
    s_lshl_b32 s75, s75, 7
    s_add_u32 s75, s75, 8388608
    v_mov_b32 v116, s58
    v_mov_b32 v117, s59
    s_mov_b64 exec, 1
    buffer_store_dwordx2 v[116:117], off, s[16:19], s75 sc1
    s_mov_b64 exec, -1
Lf1_10:
    v_mov_b32 v37, v36
    v_mfma_f32_16x16x32_bf16 v[72:75], v[20:23], v[212:215], v[72:75]
    ds_read_b64_tr_b16 v[18:19], v126 offset:53504
    s_waitcnt lgkmcnt(6)
    v_mfma_f32_16x16x32_bf16 v[84:87], v[24:27], v[208:211], v[84:87]
    ds_read_b64_tr_b16 v[20:21], v9 offset:28672
    v_mov_b32 v38, v36
    v_mov_b32 v39, v36
    v_mfma_f32_16x16x32_bf16 v[88:91], v[24:27], v[212:215], v[88:91]
    ds_read_b64_tr_b16 v[22:23], v9 offset:28928
    s_waitcnt lgkmcnt(6)
    v_mfma_f32_16x16x32_bf16 v[68:71], v[28:31], v[216:219], v[68:71]
    ds_read_b64_tr_b16 v[24:25], v10 offset:28672
    v_mov_b32 v40, v36
    v_mov_b32 v41, v36
    v_mfma_f32_16x16x32_bf16 v[72:75], v[28:31], v[220:223], v[72:75]
    ds_read_b64_tr_b16 v[26:27], v10 offset:28928
    s_waitcnt lgkmcnt(6)
    v_mfma_f32_16x16x32_bf16 v[84:87], v[32:35], v[216:219], v[84:87]
    ds_read_b64_tr_b16 v[28:29], v9 offset:34816
    v_mov_b32 v42, v36
    v_mov_b32 v43, v36
    v_mfma_f32_16x16x32_bf16 v[88:91], v[32:35], v[220:223], v[88:91]
    ds_read_b64_tr_b16 v[30:31], v9 offset:35072
    s_waitcnt lgkmcnt(6)
    v_mfma_f32_16x16x32_bf16 v[52:55], v[16:19], v[176:179], v[52:55]
    ds_read_b64_tr_b16 v[32:33], v10 offset:34816
    v_mov_b32 v44, v36
    v_mov_b32 v45, v36
    v_mfma_f32_16x16x32_bf16 v[56:59], v[16:19], v[180:183], v[56:59]
    ds_read_b64_tr_b16 v[34:35], v10 offset:35072
    s_waitcnt lgkmcnt(6)
    v_mfma_f32_16x16x32_bf16 v[68:71], v[20:23], v[224:227], v[68:71]
    ds_read_b64_tr_b16 v[16:17], v126 offset:55296
    v_mov_b32 v46, v36
    v_mov_b32 v47, v36
    v_mfma_f32_16x16x32_bf16 v[72:75], v[20:23], v[228:231], v[72:75]
    ds_read_b64_tr_b16 v[18:19], v126 offset:55552
    s_waitcnt lgkmcnt(6)
    v_mfma_f32_16x16x32_bf16 v[84:87], v[24:27], v[224:227], v[84:87]
    ds_read_b64_tr_b16 v[20:21], v9 offset:40960
    v_mov_b32 v48, v36
    v_mov_b32 v49, v36
    v_mfma_f32_16x16x32_bf16 v[88:91], v[24:27], v[228:231], v[88:91]
    ds_read_b64_tr_b16 v[22:23], v9 offset:41216
    s_waitcnt lgkmcnt(6)
    v_mfma_f32_16x16x32_bf16 v[68:71], v[28:31], v[232:235], v[68:71]
    ds_read_b64_tr_b16 v[24:25], v10 offset:40960
    v_mov_b32 v50, v36
    v_mov_b32 v51, v36
    v_mfma_f32_16x16x32_bf16 v[72:75], v[28:31], v[236:239], v[72:75]
    ds_read_b64_tr_b16 v[26:27], v10 offset:41216
    s_waitcnt lgkmcnt(6)
    v_mfma_f32_16x16x32_bf16 v[84:87], v[32:35], v[232:235], v[84:87]
    ds_read_b64_tr_b16 v[28:29], v9 offset:47104
    v_mfma_f32_16x16x32_bf16 v[88:91], v[32:35], v[236:239], v[88:91]
    ds_read_b64_tr_b16 v[30:31], v9 offset:47360
    s_waitcnt lgkmcnt(6)
    v_mfma_f32_16x16x32_bf16 v[52:55], v[16:19], v[184:187], v[52:55]
    ds_read_b64_tr_b16 v[32:33], v10 offset:47104
    v_mfma_f32_16x16x32_bf16 v[56:59], v[16:19], v[188:191], v[56:59]
    ds_read_b64_tr_b16 v[34:35], v10 offset:47360
    s_waitcnt lgkmcnt(6)
    v_mfma_f32_16x16x32_bf16 v[68:71], v[20:23], v[240:243], v[68:71]
    s_barrier
    v_add_u32 v9, 57344, v9
    v_add_u32 v10, 57344, v10
    v_add_u32 v126, 57344, v126
    ds_read_b64_tr_b16 v[16:17], v126 offset:24576
    v_mfma_f32_16x16x32_bf16 v[72:75], v[20:23], v[244:247], v[72:75]
    ds_read_b64_tr_b16 v[18:19], v126 offset:24832
    s_waitcnt lgkmcnt(6)
    v_mfma_f32_16x16x32_bf16 v[84:87], v[24:27], v[240:243], v[84:87]
    ds_read_b64_tr_b16 v[20:21], v9 offset:0
    v_mfma_f32_16x16x32_bf16 v[88:91], v[24:27], v[244:247], v[88:91]
    ds_read_b64_tr_b16 v[22:23], v9 offset:256
    s_waitcnt lgkmcnt(6)
    v_mfma_f32_16x16x32_bf16 v[68:71], v[28:31], v[248:251], v[68:71]
    ds_read_b64_tr_b16 v[24:25], v10 offset:0
    v_mfma_f32_16x16x32_bf16 v[72:75], v[28:31], v[252:255], v[72:75]
    ds_read_b64_tr_b16 v[26:27], v10 offset:256
    s_waitcnt lgkmcnt(6)
    v_mfma_f32_16x16x32_bf16 v[84:87], v[32:35], v[248:251], v[84:87]
    ds_read_b64_tr_b16 v[28:29], v9 offset:6144
    v_mfma_f32_16x16x32_bf16 v[88:91], v[32:35], v[252:255], v[88:91]
    ds_read_b64_tr_b16 v[30:31], v9 offset:6400
    s_waitcnt lgkmcnt(6)
    v_mfma_f32_16x16x32_bf16 v[52:55], v[16:19], v[192:195], v[52:55]
    ds_read_b64_tr_b16 v[32:33], v10 offset:6144
    v_mfma_f32_16x16x32_bf16 v[56:59], v[16:19], v[196:199], v[56:59]
    ds_read_b64_tr_b16 v[34:35], v10 offset:6400
    s_waitcnt lgkmcnt(6)
    v_mfma_f32_16x16x32_bf16 v[76:79], v[20:23], v[128:131], 0
    ds_read_b64_tr_b16 v[16:17], v126 offset:26624
    v_mfma_f32_16x16x32_bf16 v[80:83], v[20:23], v[132:135], 0
    ds_read_b64_tr_b16 v[18:19], v126 offset:26880
    s_setprio 3
    s_waitcnt lgkmcnt(6)
    v_mfma_f32_16x16x32_bf16 v[92:95], v[24:27], v[128:131], 0
    ds_read_b64_tr_b16 v[20:21], v9 offset:12288
    v_mfma_f32_16x16x32_bf16 v[96:99], v[24:27], v[132:135], 0
    ds_read_b64_tr_b16 v[22:23], v9 offset:12544
    s_waitcnt lgkmcnt(6)
    v_mfma_f32_16x16x32_bf16 v[76:79], v[28:31], v[136:139], v[76:79]
    ds_read_b64_tr_b16 v[24:25], v10 offset:12288
    v_mfma_f32_16x16x32_bf16 v[80:83], v[28:31], v[140:143], v[80:83]
    ds_read_b64_tr_b16 v[26:27], v10 offset:12544
    s_waitcnt lgkmcnt(6)
    v_mfma_f32_16x16x32_bf16 v[92:95], v[32:35], v[136:139], v[92:95]
    ds_read_b64_tr_b16 v[28:29], v9 offset:18432
    v_mfma_f32_16x16x32_bf16 v[96:99], v[32:35], v[140:143], v[96:99]
    ds_read_b64_tr_b16 v[30:31], v9 offset:18688
    s_waitcnt lgkmcnt(6)
    v_mfma_f32_16x16x32_bf16 v[52:55], v[16:19], v[200:203], v[52:55]
    ds_read_b64_tr_b16 v[32:33], v10 offset:18432
    v_mfma_f32_16x16x32_bf16 v[56:59], v[16:19], v[204:207], v[56:59]
    ds_read_b64_tr_b16 v[34:35], v10 offset:18688
    s_waitcnt lgkmcnt(6)
    v_mfma_f32_16x16x32_bf16 v[76:79], v[20:23], v[144:147], v[76:79]
    s_barrier
    ds_read_b64_tr_b16 v[16:17], v126 offset:53248
    v_mfma_f32_16x16x32_bf16 v[80:83], v[20:23], v[148:151], v[80:83]
    ds_read_b64_tr_b16 v[18:19], v126 offset:53504
    s_waitcnt lgkmcnt(6)
    v_mfma_f32_16x16x32_bf16 v[92:95], v[24:27], v[144:147], v[92:95]
    ds_read_b64_tr_b16 v[20:21], v9 offset:28672
    v_mfma_f32_16x16x32_bf16 v[96:99], v[24:27], v[148:151], v[96:99]
    ds_read_b64_tr_b16 v[22:23], v9 offset:28928
    s_waitcnt lgkmcnt(6)
    v_mfma_f32_16x16x32_bf16 v[76:79], v[28:31], v[152:155], v[76:79]
    ds_read_b64_tr_b16 v[24:25], v10 offset:28672
    v_mfma_f32_16x16x32_bf16 v[80:83], v[28:31], v[156:159], v[80:83]
    ds_read_b64_tr_b16 v[26:27], v10 offset:28928
    s_waitcnt lgkmcnt(6)
    v_mfma_f32_16x16x32_bf16 v[92:95], v[32:35], v[152:155], v[92:95]
    ds_read_b64_tr_b16 v[28:29], v9 offset:34816
    v_mfma_f32_16x16x32_bf16 v[96:99], v[32:35], v[156:159], v[96:99]
    ds_read_b64_tr_b16 v[30:31], v9 offset:35072
    s_waitcnt lgkmcnt(6)
    v_mfma_f32_16x16x32_bf16 v[52:55], v[16:19], v[208:211], v[52:55]
    ds_read_b64_tr_b16 v[32:33], v10 offset:34816
    v_mfma_f32_16x16x32_bf16 v[56:59], v[16:19], v[212:215], v[56:59]
    ds_read_b64_tr_b16 v[34:35], v10 offset:35072
    s_waitcnt lgkmcnt(6)
    v_mfma_f32_16x16x32_bf16 v[76:79], v[20:23], v[160:163], v[76:79]
    ds_read_b64_tr_b16 v[16:17], v126 offset:55296
    v_mfma_f32_16x16x32_bf16 v[80:83], v[20:23], v[164:167], v[80:83]
    ds_read_b64_tr_b16 v[18:19], v126 offset:55552
    s_waitcnt lgkmcnt(6)
    v_mfma_f32_16x16x32_bf16 v[92:95], v[24:27], v[160:163], v[92:95]
    ds_read_b64_tr_b16 v[20:21], v9 offset:40960
    v_mfma_f32_16x16x32_bf16 v[96:99], v[24:27], v[164:167], v[96:99]
    ds_read_b64_tr_b16 v[22:23], v9 offset:41216
    s_waitcnt lgkmcnt(6)
    v_mfma_f32_16x16x32_bf16 v[76:79], v[28:31], v[168:171], v[76:79]
    ds_read_b64_tr_b16 v[24:25], v10 offset:40960
    v_mfma_f32_16x16x32_bf16 v[80:83], v[28:31], v[172:175], v[80:83]
    ds_read_b64_tr_b16 v[26:27], v10 offset:41216
    s_waitcnt lgkmcnt(6)
    v_mfma_f32_16x16x32_bf16 v[92:95], v[32:35], v[168:171], v[92:95]
    ds_read_b64_tr_b16 v[28:29], v9 offset:47104
    v_mfma_f32_16x16x32_bf16 v[96:99], v[32:35], v[172:175], v[96:99]
    ds_read_b64_tr_b16 v[30:31], v9 offset:47360
    s_waitcnt lgkmcnt(6)
    v_mfma_f32_16x16x32_bf16 v[52:55], v[16:19], v[216:219], v[52:55]
    ds_read_b64_tr_b16 v[32:33], v10 offset:47104
    v_mfma_f32_16x16x32_bf16 v[56:59], v[16:19], v[220:223], v[56:59]
    ds_read_b64_tr_b16 v[34:35], v10 offset:47360
    s_waitcnt lgkmcnt(6)
    v_mfma_f32_16x16x32_bf16 v[76:79], v[20:23], v[176:179], v[76:79]
    s_barrier
    v_add_u32 v9, 57344, v9
    v_add_u32 v10, 57344, v10
    v_add_u32 v126, 57344, v126
    ds_read_b64_tr_b16 v[16:17], v126 offset:24576
    v_mfma_f32_16x16x32_bf16 v[80:83], v[20:23], v[180:183], v[80:83]
    ds_read_b64_tr_b16 v[18:19], v126 offset:24832
    s_waitcnt lgkmcnt(6)
    v_mfma_f32_16x16x32_bf16 v[92:95], v[24:27], v[176:179], v[92:95]
    ds_read_b64_tr_b16 v[20:21], v9 offset:0
    v_mfma_f32_16x16x32_bf16 v[96:99], v[24:27], v[180:183], v[96:99]
    ds_read_b64_tr_b16 v[22:23], v9 offset:256
    s_waitcnt lgkmcnt(6)
    v_mfma_f32_16x16x32_bf16 v[76:79], v[28:31], v[184:187], v[76:79]
    ds_read_b64_tr_b16 v[24:25], v10 offset:0
    v_mfma_f32_16x16x32_bf16 v[80:83], v[28:31], v[188:191], v[80:83]
    ds_read_b64_tr_b16 v[26:27], v10 offset:256
    s_waitcnt lgkmcnt(6)
    v_mfma_f32_16x16x32_bf16 v[92:95], v[32:35], v[184:187], v[92:95]
    ds_read_b64_tr_b16 v[28:29], v9 offset:6144
    v_mfma_f32_16x16x32_bf16 v[96:99], v[32:35], v[188:191], v[96:99]
    ds_read_b64_tr_b16 v[30:31], v9 offset:6400
    s_waitcnt lgkmcnt(6)
    v_mfma_f32_16x16x32_bf16 v[52:55], v[16:19], v[224:227], v[52:55]
    ds_read_b64_tr_b16 v[32:33], v10 offset:6144
    v_mfma_f32_16x16x32_bf16 v[56:59], v[16:19], v[228:231], v[56:59]
    ds_read_b64_tr_b16 v[34:35], v10 offset:6400
    s_waitcnt lgkmcnt(6)
    v_mfma_f32_16x16x32_bf16 v[76:79], v[20:23], v[192:195], v[76:79]
    ds_read_b64_tr_b16 v[16:17], v126 offset:26624
    v_mfma_f32_16x16x32_bf16 v[80:83], v[20:23], v[196:199], v[80:83]
    ds_read_b64_tr_b16 v[18:19], v126 offset:26880
    s_waitcnt lgkmcnt(6)
    v_mfma_f32_16x16x32_bf16 v[92:95], v[24:27], v[192:195], v[92:95]
    ds_read_b64_tr_b16 v[20:21], v9 offset:12288
    s_mov_b64 exec, 0xff
    buffer_load_dwordx2 v[14:15], v6, s[16:19], 0 offen sc1
    s_mov_b64 exec, -1
    v_mfma_f32_16x16x32_bf16 v[96:99], v[24:27], v[196:199], v[96:99]
    ds_read_b64_tr_b16 v[22:23], v9 offset:12544
    s_waitcnt lgkmcnt(6)
    v_mfma_f32_16x16x32_bf16 v[76:79], v[28:31], v[200:203], v[76:79]
    ds_read_b64_tr_b16 v[24:25], v10 offset:12288
    v_mfma_f32_16x16x32_bf16 v[80:83], v[28:31], v[204:207], v[80:83]
    ds_read_b64_tr_b16 v[26:27], v10 offset:12544
    s_waitcnt lgkmcnt(6)
    v_mfma_f32_16x16x32_bf16 v[92:95], v[32:35], v[200:203], v[92:95]
    ds_read_b64_tr_b16 v[28:29], v9 offset:18432
    v_mfma_f32_16x16x32_bf16 v[96:99], v[32:35], v[204:207], v[96:99]
    ds_read_b64_tr_b16 v[30:31], v9 offset:18688
    s_waitcnt lgkmcnt(6)
    v_mfma_f32_16x16x32_bf16 v[52:55], v[16:19], v[232:235], v[52:55]
    ds_read_b64_tr_b16 v[32:33], v10 offset:18432
    v_mfma_f32_16x16x32_bf16 v[56:59], v[16:19], v[236:239], v[56:59]
    ds_read_b64_tr_b16 v[34:35], v10 offset:18688
    s_waitcnt lgkmcnt(6)
    v_mfma_f32_16x16x32_bf16 v[76:79], v[20:23], v[208:211], v[76:79]
    s_barrier
    v_subrev_u32 v9, 114688, v9
    v_subrev_u32 v10, 114688, v10
    v_subrev_u32 v126, 114688, v126
    ds_read_b64_tr_b16 v[16:17], v126 offset:24576
    v_mfma_f32_16x16x32_bf16 v[80:83], v[20:23], v[212:215], v[80:83]
    ds_read_b64_tr_b16 v[18:19], v126 offset:24832
    s_waitcnt lgkmcnt(6)
    v_mfma_f32_16x16x32_bf16 v[92:95], v[24:27], v[208:211], v[92:95]
    ds_read_b64_tr_b16 v[20:21], v126 offset:26624
    v_mfma_f32_16x16x32_bf16 v[96:99], v[24:27], v[212:215], v[96:99]
    ds_read_b64_tr_b16 v[22:23], v126 offset:26880
    s_waitcnt lgkmcnt(6)
    v_mfma_f32_16x16x32_bf16 v[76:79], v[28:31], v[216:219], v[76:79]
    ds_read_b64_tr_b16 v[24:25], v9 offset:0
    v_mfma_f32_16x16x32_bf16 v[80:83], v[28:31], v[220:223], v[80:83]
    ds_read_b64_tr_b16 v[26:27], v9 offset:256
    s_waitcnt lgkmcnt(6)
    v_mfma_f32_16x16x32_bf16 v[92:95], v[32:35], v[216:219], v[92:95]
    ds_read_b64_tr_b16 v[28:29], v10 offset:0
    v_mfma_f32_16x16x32_bf16 v[96:99], v[32:35], v[220:223], v[96:99]
    ds_read_b64_tr_b16 v[30:31], v10 offset:256
    s_waitcnt lgkmcnt(6)
    v_mfma_f32_16x16x32_bf16 v[52:55], v[16:19], v[240:243], v[52:55]
    ds_read_b64_tr_b16 v[32:33], v9 offset:6144
    s_waitcnt vmcnt(0)
    s_mov_b64 exec, 0xff
    v_cmp_ne_u64 vcc, s[58:59], v[14:15]
    s_mov_b64 exec, -1
    s_cbranch_vccnz Lal_11
    buffer_load_dwordx4 v[116:119], v124, s[16:19], s62 offen sc1
Lal_11:
    v_mfma_f32_16x16x32_bf16 v[56:59], v[16:19], v[244:247], v[56:59]
    ds_read_b64_tr_b16 v[34:35], v9 offset:6400
    s_waitcnt lgkmcnt(6)
    v_mfma_f32_16x16x32_bf16 v[52:55], v[20:23], v[248:251], v[52:55]
    ds_read_b64_tr_b16 v[16:17], v10 offset:6144
    v_add_u32 v192, s40, v1
    v_add_u32 v196, s41, v1
    v_mfma_f32_16x16x32_bf16 v[56:59], v[20:23], v[252:255], v[56:59]
    ds_read_b64_tr_b16 v[18:19], v10 offset:6400
    s_waitcnt lgkmcnt(6)
    v_mfma_f32_16x16x32_bf16 v[76:79], v[24:27], v[224:227], v[76:79]
    ds_read_b64_tr_b16 v[20:21], v9 offset:12288
    v_add_u32 v200, s42, v1
    v_add_u32 v193, s43, v1
    v_mfma_f32_16x16x32_bf16 v[80:83], v[24:27], v[228:231], v[80:83]
    ds_read_b64_tr_b16 v[22:23], v9 offset:12544
    s_waitcnt lgkmcnt(6)
    v_mfma_f32_16x16x32_bf16 v[92:95], v[28:31], v[224:227], v[92:95]
    ds_read_b64_tr_b16 v[24:25], v10 offset:12288
    v_mfma_f32_16x16x32_bf16 v[96:99], v[28:31], v[228:231], v[96:99]
    ds_read_b64_tr_b16 v[26:27], v10 offset:12544
    s_waitcnt lgkmcnt(6)
    v_mfma_f32_16x16x32_bf16 v[76:79], v[32:35], v[232:235], v[76:79]
    ds_read_b64_tr_b16 v[28:29], v9 offset:18432
    v_mul_f32 v52, 0x3eb8aa3b, v52
    v_mul_f32 v53, 0x3eb8aa3b, v53
    v_mfma_f32_16x16x32_bf16 v[80:83], v[32:35], v[236:239], v[80:83]
    ds_read_b64_tr_b16 v[30:31], v9 offset:18688
    v_mul_f32 v54, 0x3eb8aa3b, v54
    s_waitcnt lgkmcnt(6)
    v_mfma_f32_16x16x32_bf16 v[92:95], v[16:19], v[232:235], v[92:95]
    ds_read_b64_tr_b16 v[32:33], v10 offset:18432
    v_mul_f32 v55, 0x3eb8aa3b, v55
    v_mul_f32 v56, 0x3eb8aa3b, v56
    v_mfma_f32_16x16x32_bf16 v[96:99], v[16:19], v[236:239], v[96:99]
    ds_read_b64_tr_b16 v[34:35], v10 offset:18688
    v_mul_f32 v57, 0x3eb8aa3b, v57
    s_waitcnt lgkmcnt(6)
    v_mfma_f32_16x16x32_bf16 v[76:79], v[20:23], v[240:243], v[76:79]
    v_mul_f32 v58, 0x3eb8aa3b, v58
    v_mul_f32 v59, 0x3eb8aa3b, v59
    v_mfma_f32_16x16x32_bf16 v[80:83], v[20:23], v[244:247], v[80:83]
    v_cvt_pk_bf16_f32 v204, v52, v53
    s_waitcnt lgkmcnt(4)
    v_mfma_f32_16x16x32_bf16 v[92:95], v[24:27], v[240:243], v[92:95]
    v_cvt_pk_bf16_f32 v205, v54, v55
    v_cvt_pk_bf16_f32 v206, v56, v57
    v_mfma_f32_16x16x32_bf16 v[96:99], v[24:27], v[244:247], v[96:99]
    v_cvt_pk_bf16_f32 v207, v58, v59
    s_waitcnt lgkmcnt(2)
    v_mfma_f32_16x16x32_bf16 v[76:79], v[28:31], v[248:251], v[76:79]
    v_permlane16_swap_b32 v204, v206
    v_permlane16_swap_b32 v205, v207
    v_mfma_f32_16x16x32_bf16 v[80:83], v[28:31], v[252:255], v[80:83]
    ds_write_b128 v193, v[204:207]
    s_waitcnt lgkmcnt(1)
    v_mfma_f32_16x16x32_bf16 v[92:95], v[32:35], v[248:251], v[92:95]
    s_cbranch_vccnz Lal_12
    s_mov_b64 exec, s[66:67]
    buffer_load_dwordx4 v[36:39], v125, s[16:19], s62 offen offset:1024 sc1
    buffer_load_dwordx4 v[40:43], v125, s[16:19], s62 offen offset:1536 sc1
    s_mov_b64 exec, -1
    s_addk_i32 s62, 2048
    s_bitset0_b32 s62, 15
Lal_12:
    v_mfma_f32_16x16x32_bf16 v[96:99], v[32:35], v[252:255], v[96:99]
    s_cbranch_vccnz Lal_13
    buffer_load_dwordx4 v[120:123], v124, s[16:19], s62 offen sc1
Lal_13:
    s_cbranch_vccnz Lal_14
    s_mov_b64 exec, s[66:67]
    buffer_load_dwordx4 v[44:47], v125, s[16:19], s62 offen offset:1024 sc1
    buffer_load_dwordx4 v[48:51], v125, s[16:19], s62 offen offset:1536 sc1
    s_mov_b64 exec, -1
    s_addk_i32 s62, 2048
    s_bitset0_b32 s62, 15
Lal_14:
    s_waitcnt lgkmcnt(0)
    s_barrier
    ds_read_b128 v[192:195], v192
    ds_read_b128 v[196:199], v196
    ds_read_b128 v[200:203], v200
    v_mov_b32 v240, -1
    v_mov_b32 v241, -1
    v_mov_b32 v242, -1
    v_mov_b32 v243, -1
    buffer_store_dwordx4 v[240:243], v1, s[16:19], s85 offen sc1
    v_pk_mul_f32 v[52:53], v[84:85], v[84:85]
    v_pk_mul_f32 v[54:55], v[86:87], v[86:87]
    v_pk_mul_f32 v[56:57], v[88:89], v[88:89]
    v_pk_mul_f32 v[58:59], v[90:91], v[90:91]
    v_pk_fma_f32 v[52:53], v[52:53], s[76:77], v[60:61]
    v_pk_fma_f32 v[54:55], v[54:55], s[76:77], v[60:61]
    v_pk_fma_f32 v[56:57], v[56:57], s[76:77], v[60:61]
    v_pk_fma_f32 v[58:59], v[58:59], s[76:77], v[60:61]
    v_pk_mul_f32 v[52:53], v[52:53], v[84:85]
    v_pk_mul_f32 v[54:55], v[54:55], v[86:87]
    v_pk_mul_f32 v[56:57], v[56:57], v[88:89]
    v_pk_mul_f32 v[58:59], v[58:59], v[90:91]
    v_exp_f32 v52, v52
    v_exp_f32 v53, v53
    v_exp_f32 v54, v54
    v_exp_f32 v55, v55
    v_exp_f32 v56, v56
    v_exp_f32 v57, v57
    v_exp_f32 v58, v58
    v_exp_f32 v59, v59
    v_pk_mul_f32 v[84:85], v[84:85], v[92:93]
    v_pk_mul_f32 v[86:87], v[86:87], v[94:95]
    v_pk_mul_f32 v[88:89], v[88:89], v[96:97]
    v_pk_mul_f32 v[90:91], v[90:91], v[98:99]
    v_pk_fma_f32 v[52:53], v[52:53], v[62:63], v[62:63]
    v_pk_fma_f32 v[54:55], v[54:55], v[62:63], v[62:63]
    v_pk_fma_f32 v[56:57], v[56:57], v[64:65], v[64:65]
    v_pk_fma_f32 v[58:59], v[58:59], v[64:65], v[64:65]
    v_rcp_f32 v52, v52
    v_rcp_f32 v53, v53
    v_rcp_f32 v54, v54
    v_rcp_f32 v55, v55
    v_rcp_f32 v56, v56
    v_rcp_f32 v57, v57
    v_rcp_f32 v58, v58
    v_rcp_f32 v59, v59
    v_pk_mul_f32 v[84:85], v[84:85], v[52:53]
    v_pk_mul_f32 v[86:87], v[86:87], v[54:55]
    v_pk_mul_f32 v[88:89], v[88:89], v[56:57]
    v_pk_mul_f32 v[90:91], v[90:91], v[58:59]
    v_cvt_pk_bf16_f32 v92, v84, v85
    v_cvt_pk_bf16_f32 v94, v88, v89
    v_cvt_pk_bf16_f32 v93, v86, v87
    v_cvt_pk_bf16_f32 v95, v90, v91
    v_permlane16_swap_b32 v92, v94
    s_nop 0
    v_permlane16_swap_b32 v93, v95
    s_add_u32 s68, s63, 2048
    buffer_store_dwordx4 v[92:95], v1, s[16:19], s68 offen sc1
    v_pk_mul_f32 v[52:53], v[68:69], v[68:69]
    v_pk_mul_f32 v[54:55], v[70:71], v[70:71]
    v_pk_mul_f32 v[56:57], v[72:73], v[72:73]
    v_pk_mul_f32 v[58:59], v[74:75], v[74:75]
    v_pk_fma_f32 v[52:53], v[52:53], s[76:77], v[60:61]
    v_pk_fma_f32 v[54:55], v[54:55], s[76:77], v[60:61]
    v_pk_fma_f32 v[56:57], v[56:57], s[76:77], v[60:61]
    v_pk_fma_f32 v[58:59], v[58:59], s[76:77], v[60:61]
    v_pk_mul_f32 v[52:53], v[52:53], v[68:69]
    v_pk_mul_f32 v[54:55], v[54:55], v[70:71]
    v_pk_mul_f32 v[56:57], v[56:57], v[72:73]
    v_pk_mul_f32 v[58:59], v[58:59], v[74:75]
    v_exp_f32 v52, v52
    v_exp_f32 v53, v53
    v_exp_f32 v54, v54
    v_exp_f32 v55, v55
    v_exp_f32 v56, v56
    v_exp_f32 v57, v57
    v_exp_f32 v58, v58
    v_exp_f32 v59, v59
    v_pk_mul_f32 v[68:69], v[68:69], v[76:77]
    v_pk_mul_f32 v[70:71], v[70:71], v[78:79]
    v_pk_mul_f32 v[72:73], v[72:73], v[80:81]
    v_pk_mul_f32 v[74:75], v[74:75], v[82:83]
    v_pk_fma_f32 v[52:53], v[52:53], v[62:63], v[62:63]
    v_pk_fma_f32 v[54:55], v[54:55], v[62:63], v[62:63]
    v_pk_fma_f32 v[56:57], v[56:57], v[64:65], v[64:65]
    v_pk_fma_f32 v[58:59], v[58:59], v[64:65], v[64:65]
    v_rcp_f32 v52, v52
    v_rcp_f32 v53, v53
    v_rcp_f32 v54, v54
    v_rcp_f32 v55, v55
    v_rcp_f32 v56, v56
    v_rcp_f32 v57, v57
    v_rcp_f32 v58, v58
    v_rcp_f32 v59, v59
    v_pk_mul_f32 v[68:69], v[68:69], v[52:53]
    v_pk_mul_f32 v[70:71], v[70:71], v[54:55]
    v_pk_mul_f32 v[72:73], v[72:73], v[56:57]
    v_pk_mul_f32 v[74:75], v[74:75], v[58:59]
    v_cvt_pk_bf16_f32 v76, v68, v69
    v_cvt_pk_bf16_f32 v78, v72, v73
    v_cvt_pk_bf16_f32 v77, v70, v71
    v_cvt_pk_bf16_f32 v79, v74, v75
    v_permlane16_swap_b32 v76, v78
    s_nop 0
    v_permlane16_swap_b32 v77, v79
    s_add_u32 s68, s63, 0
    buffer_store_dwordx4 v[76:79], v1, s[16:19], s68 offen sc1
    s_branch Lffn
Lsix:
    s_barrier
    v_add_u32 v9, 90112, v9
    v_add_u32 v10, 90112, v10
    v_add_u32 v11, 90112, v11
    v_add_u32 v126, 90112, v126
    ds_read_b64_tr_b16 v[16:17], v126 offset:24576
    ds_read_b64_tr_b16 v[18:19], v126 offset:24832
    ds_read_b64_tr_b16 v[20:21], v9 offset:0
    ds_read_b64_tr_b16 v[22:23], v9 offset:256
    ds_read_b64_tr_b16 v[24:25], v10 offset:0
    ds_read_b64_tr_b16 v[26:27], v10 offset:256
    ds_read_b64_tr_b16 v[28:29], v11 offset:0
    ds_read_b64_tr_b16 v[30:31], v11 offset:256
    s_waitcnt lgkmcnt(6)
    v_mfma_f32_16x16x32_bf16 v[52:55], v[16:19], v[128:131], 0
    ds_read_b64_tr_b16 v[32:33], v9 offset:6144
    v_mfma_f32_16x16x32_bf16 v[56:59], v[16:19], v[132:135], 0
    ds_read_b64_tr_b16 v[34:35], v9 offset:6400
    s_waitcnt lgkmcnt(6)
    v_mfma_f32_16x16x32_bf16 v[68:71], v[20:23], v[128:131], 0
    ds_read_b64_tr_b16 v[16:17], v10 offset:6144
    v_mfma_f32_16x16x32_bf16 v[72:75], v[20:23], v[132:135], 0
    ds_read_b64_tr_b16 v[18:19], v10 offset:6400
    buffer_store_dwordx4 v[36:39], v4, s[16:19], s4 offen sc1
    s_waitcnt lgkmcnt(6)
    v_mfma_f32_16x16x32_bf16 v[84:87], v[24:27], v[128:131], 0
    ds_read_b64_tr_b16 v[20:21], v11 offset:6144
    v_mfma_f32_16x16x32_bf16 v[88:91], v[24:27], v[132:135], 0
    ds_read_b64_tr_b16 v[22:23], v11 offset:6400
    s_waitcnt lgkmcnt(6)
    v_mfma_f32_16x16x32_bf16 v[100:103], v[28:31], v[128:131], 0
    ds_read_b64_tr_b16 v[24:25], v126 offset:26624
    v_mfma_f32_16x16x32_bf16 v[104:107], v[28:31], v[132:135], 0
    ds_read_b64_tr_b16 v[26:27], v126 offset:26880
    s_waitcnt lgkmcnt(6)
    v_mfma_f32_16x16x32_bf16 v[68:71], v[32:35], v[136:139], v[68:71]
    ds_read_b64_tr_b16 v[28:29], v9 offset:12288
    v_mfma_f32_16x16x32_bf16 v[72:75], v[32:35], v[140:143], v[72:75]
    ds_read_b64_tr_b16 v[30:31], v9 offset:12544
    buffer_load_dwordx2 v[116:117], off, s[36:39], 0 sc1
    s_waitcnt lgkmcnt(6)
    v_mfma_f32_16x16x32_bf16 v[84:87], v[16:19], v[136:139], v[84:87]
    ds_read_b64_tr_b16 v[32:33], v10 offset:12288
    v_mfma_f32_16x16x32_bf16 v[88:91], v[16:19], v[140:143], v[88:91]
    ds_read_b64_tr_b16 v[34:35], v10 offset:12544
    s_waitcnt lgkmcnt(6)
    v_mfma_f32_16x16x32_bf16 v[100:103], v[20:23], v[136:139], v[100:103]
    ds_read_b64_tr_b16 v[16:17], v11 offset:12288
    v_mfma_f32_16x16x32_bf16 v[104:107], v[20:23], v[140:143], v[104:107]
    ds_read_b64_tr_b16 v[18:19], v11 offset:12544
    s_waitcnt lgkmcnt(6)
    v_mfma_f32_16x16x32_bf16 v[52:55], v[24:27], v[136:139], v[52:55]
    ds_read_b64_tr_b16 v[20:21], v9 offset:18432
    v_mfma_f32_16x16x32_bf16 v[56:59], v[24:27], v[140:143], v[56:59]
    ds_read_b64_tr_b16 v[22:23], v9 offset:18688
    buffer_store_dwordx4 v[40:43], v4, s[16:19], s5 offen sc1
    s_waitcnt lgkmcnt(6)
    v_mfma_f32_16x16x32_bf16 v[68:71], v[28:31], v[144:147], v[68:71]
    ds_read_b64_tr_b16 v[24:25], v10 offset:18432
    v_mfma_f32_16x16x32_bf16 v[72:75], v[28:31], v[148:151], v[72:75]
    ds_read_b64_tr_b16 v[26:27], v10 offset:18688
    s_waitcnt lgkmcnt(6)
    v_mfma_f32_16x16x32_bf16 v[84:87], v[32:35], v[144:147], v[84:87]
    ds_read_b64_tr_b16 v[28:29], v11 offset:18432
    v_mfma_f32_16x16x32_bf16 v[88:91], v[32:35], v[148:151], v[88:91]
    ds_read_b64_tr_b16 v[30:31], v11 offset:18688
    s_waitcnt lgkmcnt(6)
    v_mfma_f32_16x16x32_bf16 v[100:103], v[16:19], v[144:147], v[100:103]
    s_barrier
    ds_read_b64_tr_b16 v[32:33], v126 offset:53248
    s_lshl_b32 s68, s45, 8
    v_and_b32 v124, 15, v0
    v_mfma_f32_16x16x32_bf16 v[104:107], v[16:19], v[148:151], v[104:107]
    ds_read_b64_tr_b16 v[34:35], v126 offset:53504
    s_waitcnt lgkmcnt(6)
    v_mfma_f32_16x16x32_bf16 v[68:71], v[20:23], v[152:155], v[68:71]
    ds_read_b64_tr_b16 v[16:17], v9 offset:28672
    v_lshl_add_u32 v124, v124, 2, s68
    v_add_u32 v124, 1024, v124
    v_mfma_f32_16x16x32_bf16 v[72:75], v[20:23], v[156:159], v[72:75]
    ds_read_b64_tr_b16 v[18:19], v9 offset:28928
    s_waitcnt lgkmcnt(6)
    v_mfma_f32_16x16x32_bf16 v[84:87], v[24:27], v[152:155], v[84:87]
    ds_read_b64_tr_b16 v[20:21], v10 offset:28672
    ds_read2_b32 v[124:125], v124 offset0:0 offset1:16
    v_mfma_f32_16x16x32_bf16 v[88:91], v[24:27], v[156:159], v[88:91]
    ds_read_b64_tr_b16 v[22:23], v10 offset:28928
    buffer_store_dwordx4 v[44:47], v4, s[16:19], s6 offen sc1
    s_waitcnt lgkmcnt(7)
    v_mfma_f32_16x16x32_bf16 v[100:103], v[28:31], v[152:155], v[100:103]
    ds_read_b64_tr_b16 v[24:25], v11 offset:28672
    v_and_b32 v6, 4, v0
    v_mul_u32_u24 v6, 3, v6
    v_mfma_f32_16x16x32_bf16 v[104:107], v[28:31], v[156:159], v[104:107]
    ds_read_b64_tr_b16 v[26:27], v11 offset:28928
    s_waitcnt lgkmcnt(7)
    v_mfma_f32_16x16x32_bf16 v[52:55], v[32:35], v[144:147], v[52:55]
    ds_read_b64_tr_b16 v[28:29], v9 offset:34816
    v_add_u32 v6, v6, v0
    v_lshl_add_u32 v6, v6, 7, s60
    v_mfma_f32_16x16x32_bf16 v[56:59], v[32:35], v[148:151], v[56:59]
    ds_read_b64_tr_b16 v[30:31], v9 offset:35072
    s_waitcnt lgkmcnt(7)
    v_mfma_f32_16x16x32_bf16 v[68:71], v[16:19], v[160:163], v[68:71]
    ds_read_b64_tr_b16 v[32:33], v10 offset:34816
    v_lshrrev_b32 v2, 3, v0
    v_lshrrev_b32 v14, 2, v0
    v_mfma_f32_16x16x32_bf16 v[72:75], v[16:19], v[164:167], v[72:75]
    ds_read_b64_tr_b16 v[34:35], v10 offset:35072
    s_waitcnt lgkmcnt(6)
    v_mfma_f32_16x16x32_bf16 v[84:87], v[20:23], v[160:163], v[84:87]
    ds_read_b64_tr_b16 v[16:17], v11 offset:34816
    v_and_b32 v14, 4, v14
    v_xor_b32 v14, v14, v0
    v_mfma_f32_16x16x32_bf16 v[88:91], v[20:23], v[164:167], v[88:91]
    ds_read_b64_tr_b16 v[18:19], v11 offset:35072
    s_waitcnt lgkmcnt(6)
    v_mfma_f32_16x16x32_bf16 v[100:103], v[24:27], v[160:163], v[100:103]
    ds_read_b64_tr_b16 v[20:21], v126 offset:55296
    v_and_b32 v14, 7, v14
    v_lshlrev_b32 v14, 4, v14
    v_mfma_f32_16x16x32_bf16 v[104:107], v[24:27], v[164:167], v[104:107]
    ds_read_b64_tr_b16 v[22:23], v126 offset:55552
    s_waitcnt lgkmcnt(6)
    v_mfma_f32_16x16x32_bf16 v[68:71], v[28:31], v[168:171], v[68:71]
    ds_read_b64_tr_b16 v[24:25], v9 offset:40960
    v_lshl_add_u32 v2, v2, 10, v14
    v_mfma_f32_16x16x32_bf16 v[72:75], v[28:31], v[172:175], v[72:75]
    ds_read_b64_tr_b16 v[26:27], v9 offset:41216
    buffer_store_dwordx4 v[48:51], v4, s[16:19], s7 offen sc1
    s_waitcnt lgkmcnt(6)
    v_mfma_f32_16x16x32_bf16 v[84:87], v[32:35], v[168:171], v[84:87]
    ds_read_b64_tr_b16 v[28:29], v10 offset:40960
    v_add_u32 v3, 7168, v2
    v_add_u32 v7, s65, v1
    v_mfma_f32_16x16x32_bf16 v[88:91], v[32:35], v[172:175], v[88:91]
    ds_read_b64_tr_b16 v[30:31], v10 offset:41216
    s_waitcnt lgkmcnt(6)
    v_mfma_f32_16x16x32_bf16 v[100:103], v[16:19], v[168:171], v[100:103]
    ds_read_b64_tr_b16 v[32:33], v11 offset:40960
    v_lshl_add_u32 v8, v0, 2, s65
    v_mul_f32 v124, 0x3fb8aa3b, v124
    v_mfma_f32_16x16x32_bf16 v[104:107], v[16:19], v[172:175], v[104:107]
    ds_read_b64_tr_b16 v[34:35], v11 offset:41216
    s_waitcnt lgkmcnt(6)
    v_mfma_f32_16x16x32_bf16 v[52:55], v[20:23], v[152:155], v[52:55]
    ds_read_b64_tr_b16 v[16:17], v9 offset:47104
    v_mul_f32 v125, 0x3fb8aa3b, v125
    v_exp_f32 v124, v124
    v_mfma_f32_16x16x32_bf16 v[56:59], v[20:23], v[156:159], v[56:59]
    ds_read_b64_tr_b16 v[18:19], v9 offset:47360
    s_waitcnt lgkmcnt(6)
    v_mfma_f32_16x16x32_bf16 v[68:71], v[24:27], v[176:179], v[68:71]
    ds_read_b64_tr_b16 v[20:21], v10 offset:47104
    v_exp_f32 v125, v125
    v_add_f32 v124, 1.0, v124
    v_mfma_f32_16x16x32_bf16 v[72:75], v[24:27], v[180:183], v[72:75]
    ds_read_b64_tr_b16 v[22:23], v10 offset:47360
    s_waitcnt lgkmcnt(6)
    v_mfma_f32_16x16x32_bf16 v[84:87], v[28:31], v[176:179], v[84:87]
    ds_read_b64_tr_b16 v[24:25], v11 offset:47104
    v_add_f32 v125, 1.0, v125
    v_mov_b32 v60, 0xc0135761
    v_mfma_f32_16x16x32_bf16 v[88:91], v[28:31], v[180:183], v[88:91]
    ds_read_b64_tr_b16 v[26:27], v11 offset:47360
    s_waitcnt lgkmcnt(6)
    v_mfma_f32_16x16x32_bf16 v[100:103], v[32:35], v[176:179], v[100:103]
    s_barrier
    v_subrev_u32 v9, 86016, v9
    v_subrev_u32 v10, 86016, v10
    v_subrev_u32 v11, 86016, v11
    v_subrev_u32 v126, 86016, v126
    ds_read_b64_tr_b16 v[28:29], v126 offset:24576
    s_waitcnt vmcnt(3)
    v_cmp_eq_u32 vcc, 0, v117
    s_cbranch_vccnz Lnonr_15
Lnonc_16:
    v_readfirstlane_b32 s58, v116
    v_readfirstlane_b32 s59, v117
    v_mov_b32 v61, v60
    v_mfma_f32_16x16x32_bf16 v[104:107], v[32:35], v[180:183], v[104:107]
    ds_read_b64_tr_b16 v[30:31], v126 offset:24832
    s_waitcnt lgkmcnt(6)
    v_mfma_f32_16x16x32_bf16 v[68:71], v[16:19], v[184:187], v[68:71]
    ds_read_b64_tr_b16 v[32:33], v9 offset:0
    v_min_f32 v62, 0x71800000, v124
    v_min_f32 v63, 0x71800000, v124
    v_mfma_f32_16x16x32_bf16 v[72:75], v[16:19], v[188:191], v[72:75]
    ds_read_b64_tr_b16 v[34:35], v9 offset:256
    s_waitcnt lgkmcnt(6)
    v_mfma_f32_16x16x32_bf16 v[84:87], v[20:23], v[184:187], v[84:87]
    ds_read_b64_tr_b16 v[16:17], v10 offset:0
    v_min_f32 v64, 0x71800000, v125
    v_min_f32 v65, 0x71800000, v125
    v_mfma_f32_16x16x32_bf16 v[88:91], v[20:23], v[188:191], v[88:91]
    ds_read_b64_tr_b16 v[18:19], v10 offset:256
    s_waitcnt lgkmcnt(6)
    v_mfma_f32_16x16x32_bf16 v[100:103], v[24:27], v[184:187], v[100:103]
    ds_read_b64_tr_b16 v[20:21], v11 offset:0
    v_add_u32 v124, s61, v1
    v_add_u32 v125, s61, v127
    v_mfma_f32_16x16x32_bf16 v[104:107], v[24:27], v[188:191], v[104:107]
    ds_read_b64_tr_b16 v[22:23], v11 offset:256
    s_waitcnt lgkmcnt(6)
    v_mfma_f32_16x16x32_bf16 v[52:55], v[28:31], v[160:163], v[52:55]
    ds_read_b64_tr_b16 v[24:25], v9 offset:6144
    v_and_b32 v37, 27, v0
    v_cmp_eq_u32 vcc, 16, v37
    v_mfma_f32_16x16x32_bf16 v[56:59], v[28:31], v[164:167], v[56:59]
    ds_read_b64_tr_b16 v[26:27], v9 offset:6400
    s_waitcnt lgkmcnt(6)
    v_mfma_f32_16x16x32_bf16 v[68:71], v[32:35], v[192:195], v[68:71]
    ds_read_b64_tr_b16 v[28:29], v10 offset:6144
    v_mov_b32 v37, 0x3f803f80
    v_cndmask_b32 v36, 0, v37, vcc
    v_mfma_f32_16x16x32_bf16 v[72:75], v[32:35], v[196:199], v[72:75]
    ds_read_b64_tr_b16 v[30:31], v10 offset:6400
    s_waitcnt lgkmcnt(6)
    v_mfma_f32_16x16x32_bf16 v[84:87], v[16:19], v[192:195], v[84:87]
    ds_read_b64_tr_b16 v[32:33], v11 offset:6144
    v_mov_b32 v37, v36
    v_mov_b32 v38, v36
    v_mfma_f32_16x16x32_bf16 v[88:91], v[16:19], v[196:199], v[88:91]
    ds_read_b64_tr_b16 v[34:35], v11 offset:6400
    s_waitcnt lgkmcnt(6)
    v_mfma_f32_16x16x32_bf16 v[100:103], v[20:23], v[192:195], v[100:103]
    ds_read_b64_tr_b16 v[16:17], v126 offset:26624
    v_mov_b32 v39, v36
    v_mov_b32 v40, v36
    v_mfma_f32_16x16x32_bf16 v[104:107], v[20:23], v[196:199], v[104:107]
    ds_read_b64_tr_b16 v[18:19], v126 offset:26880
    s_waitcnt lgkmcnt(6)
    v_mfma_f32_16x16x32_bf16 v[68:71], v[24:27], v[200:203], v[68:71]
    ds_read_b64_tr_b16 v[20:21], v9 offset:12288
    v_mov_b32 v41, v36
    v_mov_b32 v42, v36
    v_mfma_f32_16x16x32_bf16 v[72:75], v[24:27], v[204:207], v[72:75]
    ds_read_b64_tr_b16 v[22:23], v9 offset:12544
    s_waitcnt lgkmcnt(6)
    v_mfma_f32_16x16x32_bf16 v[84:87], v[28:31], v[200:203], v[84:87]
    ds_read_b64_tr_b16 v[24:25], v10 offset:12288
    v_mov_b32 v43, v36
    v_mov_b32 v44, v36
    v_mfma_f32_16x16x32_bf16 v[88:91], v[28:31], v[204:207], v[88:91]
    ds_read_b64_tr_b16 v[26:27], v10 offset:12544
    s_waitcnt lgkmcnt(6)
    v_mfma_f32_16x16x32_bf16 v[100:103], v[32:35], v[200:203], v[100:103]
    ds_read_b64_tr_b16 v[28:29], v11 offset:12288
    v_mov_b32 v45, v36
    v_mov_b32 v46, v36
    v_mfma_f32_16x16x32_bf16 v[104:107], v[32:35], v[204:207], v[104:107]
    ds_read_b64_tr_b16 v[30:31], v11 offset:12544
    s_waitcnt lgkmcnt(6)
    v_mfma_f32_16x16x32_bf16 v[52:55], v[16:19], v[168:171], v[52:55]
    ds_read_b64_tr_b16 v[32:33], v9 offset:18432
    v_mov_b32 v47, v36
    v_mov_b32 v48, v36
    v_mfma_f32_16x16x32_bf16 v[56:59], v[16:19], v[172:175], v[56:59]
    ds_read_b64_tr_b16 v[34:35], v9 offset:18688
    s_waitcnt lgkmcnt(6)
    v_mfma_f32_16x16x32_bf16 v[68:71], v[20:23], v[208:211], v[68:71]
    ds_read_b64_tr_b16 v[16:17], v10 offset:18432
    v_mov_b32 v49, v36
    v_mov_b32 v50, v36
    v_mfma_f32_16x16x32_bf16 v[72:75], v[20:23], v[212:215], v[72:75]
    ds_read_b64_tr_b16 v[18:19], v10 offset:18688
    s_waitcnt lgkmcnt(6)
    v_mfma_f32_16x16x32_bf16 v[84:87], v[24:27], v[208:211], v[84:87]
    ds_read_b64_tr_b16 v[20:21], v11 offset:18432
    v_mov_b32 v51, v36
    v_mfma_f32_16x16x32_bf16 v[88:91], v[24:27], v[212:215], v[88:91]
    ds_read_b64_tr_b16 v[22:23], v11 offset:18688
    s_waitcnt lgkmcnt(6)
    v_mfma_f32_16x16x32_bf16 v[100:103], v[28:31], v[208:211], v[100:103]
    s_waitcnt vmcnt(0)
    s_barrier
    ds_read_b64_tr_b16 v[24:25], v126 offset:53248
    s_cmp_lg_u32 s44, 0
    s_cbranch_scc1 Lf1_17
    s_lshl_b32 s75, s47, 4
    s_add_u32 s75, s75, s48
    s_lshl_b32 s75, s75, 7
    s_add_u32 s75, s75, 8388608
    v_mov_b32 v116, s58
    v_mov_b32 v117, s59
    s_mov_b64 exec, 1
    buffer_store_dwordx2 v[116:117], off, s[16:19], s75 sc1
    s_mov_b64 exec, -1
Lf1_17:
    v_mfma_f32_16x16x32_bf16 v[104:107], v[28:31], v[212:215], v[104:107]
    ds_read_b64_tr_b16 v[26:27], v126 offset:53504
    s_waitcnt lgkmcnt(6)
    v_mfma_f32_16x16x32_bf16 v[68:71], v[32:35], v[216:219], v[68:71]
    ds_read_b64_tr_b16 v[28:29], v9 offset:28672
    v_mfma_f32_16x16x32_bf16 v[72:75], v[32:35], v[220:223], v[72:75]
    ds_read_b64_tr_b16 v[30:31], v9 offset:28928
    s_waitcnt lgkmcnt(6)
    v_mfma_f32_16x16x32_bf16 v[84:87], v[16:19], v[216:219], v[84:87]
    ds_read_b64_tr_b16 v[32:33], v10 offset:28672
    v_mfma_f32_16x16x32_bf16 v[88:91], v[16:19], v[220:223], v[88:91]
    ds_read_b64_tr_b16 v[34:35], v10 offset:28928
    s_waitcnt lgkmcnt(6)
    v_mfma_f32_16x16x32_bf16 v[100:103], v[20:23], v[216:219], v[100:103]
    ds_read_b64_tr_b16 v[16:17], v11 offset:28672
    v_mfma_f32_16x16x32_bf16 v[104:107], v[20:23], v[220:223], v[104:107]
    ds_read_b64_tr_b16 v[18:19], v11 offset:28928
    s_waitcnt lgkmcnt(6)
    v_mfma_f32_16x16x32_bf16 v[52:55], v[24:27], v[176:179], v[52:55]
    ds_read_b64_tr_b16 v[20:21], v9 offset:34816
    v_mfma_f32_16x16x32_bf16 v[56:59], v[24:27], v[180:183], v[56:59]
    ds_read_b64_tr_b16 v[22:23], v9 offset:35072
    s_waitcnt lgkmcnt(6)
    v_mfma_f32_16x16x32_bf16 v[68:71], v[28:31], v[224:227], v[68:71]
    ds_read_b64_tr_b16 v[24:25], v10 offset:34816
    v_mfma_f32_16x16x32_bf16 v[72:75], v[28:31], v[228:231], v[72:75]
    ds_read_b64_tr_b16 v[26:27], v10 offset:35072
    s_waitcnt lgkmcnt(6)
    v_mfma_f32_16x16x32_bf16 v[84:87], v[32:35], v[224:227], v[84:87]
    ds_read_b64_tr_b16 v[28:29], v11 offset:34816
    v_mfma_f32_16x16x32_bf16 v[88:91], v[32:35], v[228:231], v[88:91]
    ds_read_b64_tr_b16 v[30:31], v11 offset:35072
    s_waitcnt lgkmcnt(6)
    v_mfma_f32_16x16x32_bf16 v[100:103], v[16:19], v[224:227], v[100:103]
    ds_read_b64_tr_b16 v[32:33], v126 offset:55296
    v_mfma_f32_16x16x32_bf16 v[104:107], v[16:19], v[228:231], v[104:107]
    ds_read_b64_tr_b16 v[34:35], v126 offset:55552
    s_waitcnt lgkmcnt(6)
    v_mfma_f32_16x16x32_bf16 v[68:71], v[20:23], v[232:235], v[68:71]
    ds_read_b64_tr_b16 v[16:17], v9 offset:40960
    v_mfma_f32_16x16x32_bf16 v[72:75], v[20:23], v[236:239], v[72:75]
    ds_read_b64_tr_b16 v[18:19], v9 offset:41216
    s_waitcnt lgkmcnt(6)
    v_mfma_f32_16x16x32_bf16 v[84:87], v[24:27], v[232:235], v[84:87]
    ds_read_b64_tr_b16 v[20:21], v10 offset:40960
    v_mfma_f32_16x16x32_bf16 v[88:91], v[24:27], v[236:239], v[88:91]
    ds_read_b64_tr_b16 v[22:23], v10 offset:41216
    s_waitcnt lgkmcnt(6)
    v_mfma_f32_16x16x32_bf16 v[100:103], v[28:31], v[232:235], v[100:103]
    ds_read_b64_tr_b16 v[24:25], v11 offset:40960
    v_mfma_f32_16x16x32_bf16 v[104:107], v[28:31], v[236:239], v[104:107]
    ds_read_b64_tr_b16 v[26:27], v11 offset:41216
    s_waitcnt lgkmcnt(6)
    v_mfma_f32_16x16x32_bf16 v[52:55], v[32:35], v[184:187], v[52:55]
    ds_read_b64_tr_b16 v[28:29], v9 offset:47104
    v_mfma_f32_16x16x32_bf16 v[56:59], v[32:35], v[188:191], v[56:59]
    ds_read_b64_tr_b16 v[30:31], v9 offset:47360
    s_waitcnt lgkmcnt(6)
    v_mfma_f32_16x16x32_bf16 v[68:71], v[16:19], v[240:243], v[68:71]
    ds_read_b64_tr_b16 v[32:33], v10 offset:47104
    v_mfma_f32_16x16x32_bf16 v[72:75], v[16:19], v[244:247], v[72:75]
    ds_read_b64_tr_b16 v[34:35], v10 offset:47360
    s_waitcnt lgkmcnt(6)
    v_mfma_f32_16x16x32_bf16 v[84:87], v[20:23], v[240:243], v[84:87]
    ds_read_b64_tr_b16 v[16:17], v11 offset:47104
    v_mfma_f32_16x16x32_bf16 v[88:91], v[20:23], v[244:247], v[88:91]
    ds_read_b64_tr_b16 v[18:19], v11 offset:47360
    s_waitcnt lgkmcnt(6)
    v_mfma_f32_16x16x32_bf16 v[100:103], v[24:27], v[240:243], v[100:103]
    s_barrier
    v_add_u32 v9, 57344, v9
    v_add_u32 v10, 57344, v10
    v_add_u32 v11, 57344, v11
    v_add_u32 v126, 57344, v126
    ds_read_b64_tr_b16 v[20:21], v126 offset:24576
    v_mfma_f32_16x16x32_bf16 v[104:107], v[24:27], v[244:247], v[104:107]
    ds_read_b64_tr_b16 v[22:23], v126 offset:24832
    s_waitcnt lgkmcnt(6)
    v_mfma_f32_16x16x32_bf16 v[68:71], v[28:31], v[248:251], v[68:71]
    ds_read_b64_tr_b16 v[24:25], v9 offset:0
    v_mfma_f32_16x16x32_bf16 v[72:75], v[28:31], v[252:255], v[72:75]
    ds_read_b64_tr_b16 v[26:27], v9 offset:256
    s_waitcnt lgkmcnt(6)
    v_mfma_f32_16x16x32_bf16 v[84:87], v[32:35], v[248:251], v[84:87]
    ds_read_b64_tr_b16 v[28:29], v10 offset:0
    v_mfma_f32_16x16x32_bf16 v[88:91], v[32:35], v[252:255], v[88:91]
    ds_read_b64_tr_b16 v[30:31], v10 offset:256
    s_waitcnt lgkmcnt(6)
    v_mfma_f32_16x16x32_bf16 v[100:103], v[16:19], v[248:251], v[100:103]
    ds_read_b64_tr_b16 v[32:33], v11 offset:0
    v_mfma_f32_16x16x32_bf16 v[104:107], v[16:19], v[252:255], v[104:107]
    ds_read_b64_tr_b16 v[34:35], v11 offset:256
    s_waitcnt lgkmcnt(6)
    v_mfma_f32_16x16x32_bf16 v[52:55], v[20:23], v[192:195], v[52:55]
    ds_read_b64_tr_b16 v[16:17], v9 offset:6144
    v_mfma_f32_16x16x32_bf16 v[56:59], v[20:23], v[196:199], v[56:59]
    ds_read_b64_tr_b16 v[18:19], v9 offset:6400
    s_waitcnt lgkmcnt(6)
    v_mfma_f32_16x16x32_bf16 v[76:79], v[24:27], v[128:131], 0
    ds_read_b64_tr_b16 v[20:21], v10 offset:6144
    v_mfma_f32_16x16x32_bf16 v[80:83], v[24:27], v[132:135], 0
    ds_read_b64_tr_b16 v[22:23], v10 offset:6400
    s_waitcnt lgkmcnt(6)
    v_mfma_f32_16x16x32_bf16 v[92:95], v[28:31], v[128:131], 0
    ds_read_b64_tr_b16 v[24:25], v11 offset:6144
    v_mfma_f32_16x16x32_bf16 v[96:99], v[28:31], v[132:135], 0
    ds_read_b64_tr_b16 v[26:27], v11 offset:6400
    s_setprio 3
    s_waitcnt lgkmcnt(6)
    v_mfma_f32_16x16x32_bf16 v[108:111], v[32:35], v[128:131], 0
    ds_read_b64_tr_b16 v[28:29], v126 offset:26624
    v_mfma_f32_16x16x32_bf16 v[112:115], v[32:35], v[132:135], 0
    ds_read_b64_tr_b16 v[30:31], v126 offset:26880
    s_waitcnt lgkmcnt(6)
    v_mfma_f32_16x16x32_bf16 v[76:79], v[16:19], v[136:139], v[76:79]
    ds_read_b64_tr_b16 v[32:33], v9 offset:12288
    v_mfma_f32_16x16x32_bf16 v[80:83], v[16:19], v[140:143], v[80:83]
    ds_read_b64_tr_b16 v[34:35], v9 offset:12544
    s_waitcnt lgkmcnt(6)
    v_mfma_f32_16x16x32_bf16 v[92:95], v[20:23], v[136:139], v[92:95]
    ds_read_b64_tr_b16 v[16:17], v10 offset:12288
    v_mfma_f32_16x16x32_bf16 v[96:99], v[20:23], v[140:143], v[96:99]
    ds_read_b64_tr_b16 v[18:19], v10 offset:12544
    s_waitcnt lgkmcnt(6)
    v_mfma_f32_16x16x32_bf16 v[108:111], v[24:27], v[136:139], v[108:111]
    ds_read_b64_tr_b16 v[20:21], v11 offset:12288
    v_mfma_f32_16x16x32_bf16 v[112:115], v[24:27], v[140:143], v[112:115]
    ds_read_b64_tr_b16 v[22:23], v11 offset:12544
    s_waitcnt lgkmcnt(6)
    v_mfma_f32_16x16x32_bf16 v[52:55], v[28:31], v[200:203], v[52:55]
    ds_read_b64_tr_b16 v[24:25], v9 offset:18432
    v_mfma_f32_16x16x32_bf16 v[56:59], v[28:31], v[204:207], v[56:59]
    ds_read_b64_tr_b16 v[26:27], v9 offset:18688
    s_waitcnt lgkmcnt(6)
    v_mfma_f32_16x16x32_bf16 v[76:79], v[32:35], v[144:147], v[76:79]
    ds_read_b64_tr_b16 v[28:29], v10 offset:18432
    v_mfma_f32_16x16x32_bf16 v[80:83], v[32:35], v[148:151], v[80:83]
    ds_read_b64_tr_b16 v[30:31], v10 offset:18688
    s_waitcnt lgkmcnt(6)
    v_mfma_f32_16x16x32_bf16 v[92:95], v[16:19], v[144:147], v[92:95]
    ds_read_b64_tr_b16 v[32:33], v11 offset:18432
    v_mfma_f32_16x16x32_bf16 v[96:99], v[16:19], v[148:151], v[96:99]
    ds_read_b64_tr_b16 v[34:35], v11 offset:18688
    s_waitcnt lgkmcnt(6)
    v_mfma_f32_16x16x32_bf16 v[108:111], v[20:23], v[144:147], v[108:111]
    s_barrier
    ds_read_b64_tr_b16 v[16:17], v126 offset:53248
    v_mfma_f32_16x16x32_bf16 v[112:115], v[20:23], v[148:151], v[112:115]
    ds_read_b64_tr_b16 v[18:19], v126 offset:53504
    s_waitcnt lgkmcnt(6)
    v_mfma_f32_16x16x32_bf16 v[76:79], v[24:27], v[152:155], v[76:79]
    ds_read_b64_tr_b16 v[20:21], v9 offset:28672
    v_mfma_f32_16x16x32_bf16 v[80:83], v[24:27], v[156:159], v[80:83]
    ds_read_b64_tr_b16 v[22:23], v9 offset:28928
    s_waitcnt lgkmcnt(6)
    v_mfma_f32_16x16x32_bf16 v[92:95], v[28:31], v[152:155], v[92:95]
    ds_read_b64_tr_b16 v[24:25], v10 offset:28672
    v_mfma_f32_16x16x32_bf16 v[96:99], v[28:31], v[156:159], v[96:99]
    ds_read_b64_tr_b16 v[26:27], v10 offset:28928
    s_waitcnt lgkmcnt(6)
    v_mfma_f32_16x16x32_bf16 v[108:111], v[32:35], v[152:155], v[108:111]
    ds_read_b64_tr_b16 v[28:29], v11 offset:28672
    v_mfma_f32_16x16x32_bf16 v[112:115], v[32:35], v[156:159], v[112:115]
    ds_read_b64_tr_b16 v[30:31], v11 offset:28928
    s_waitcnt lgkmcnt(6)
    v_mfma_f32_16x16x32_bf16 v[52:55], v[16:19], v[208:211], v[52:55]
    ds_read_b64_tr_b16 v[32:33], v9 offset:34816
    v_mfma_f32_16x16x32_bf16 v[56:59], v[16:19], v[212:215], v[56:59]
    ds_read_b64_tr_b16 v[34:35], v9 offset:35072
    s_waitcnt lgkmcnt(6)
    v_mfma_f32_16x16x32_bf16 v[76:79], v[20:23], v[160:163], v[76:79]
    ds_read_b64_tr_b16 v[16:17], v10 offset:34816
    v_mfma_f32_16x16x32_bf16 v[80:83], v[20:23], v[164:167], v[80:83]
    ds_read_b64_tr_b16 v[18:19], v10 offset:35072
    s_waitcnt lgkmcnt(6)
    v_mfma_f32_16x16x32_bf16 v[92:95], v[24:27], v[160:163], v[92:95]
    ds_read_b64_tr_b16 v[20:21], v11 offset:34816
    v_mfma_f32_16x16x32_bf16 v[96:99], v[24:27], v[164:167], v[96:99]
    ds_read_b64_tr_b16 v[22:23], v11 offset:35072
    s_waitcnt lgkmcnt(6)
    v_mfma_f32_16x16x32_bf16 v[108:111], v[28:31], v[160:163], v[108:111]
    ds_read_b64_tr_b16 v[24:25], v126 offset:55296
    v_mfma_f32_16x16x32_bf16 v[112:115], v[28:31], v[164:167], v[112:115]
    ds_read_b64_tr_b16 v[26:27], v126 offset:55552
    s_waitcnt lgkmcnt(6)
    v_mfma_f32_16x16x32_bf16 v[76:79], v[32:35], v[168:171], v[76:79]
    ds_read_b64_tr_b16 v[28:29], v9 offset:40960
    v_mfma_f32_16x16x32_bf16 v[80:83], v[32:35], v[172:175], v[80:83]
    ds_read_b64_tr_b16 v[30:31], v9 offset:41216
    s_waitcnt lgkmcnt(6)
    v_mfma_f32_16x16x32_bf16 v[92:95], v[16:19], v[168:171], v[92:95]
    ds_read_b64_tr_b16 v[32:33], v10 offset:40960
    v_mfma_f32_16x16x32_bf16 v[96:99], v[16:19], v[172:175], v[96:99]
    ds_read_b64_tr_b16 v[34:35], v10 offset:41216
    s_waitcnt lgkmcnt(6)
    v_mfma_f32_16x16x32_bf16 v[108:111], v[20:23], v[168:171], v[108:111]
    ds_read_b64_tr_b16 v[16:17], v11 offset:40960
    v_mfma_f32_16x16x32_bf16 v[112:115], v[20:23], v[172:175], v[112:115]
    ds_read_b64_tr_b16 v[18:19], v11 offset:41216
    s_waitcnt lgkmcnt(6)
    v_mfma_f32_16x16x32_bf16 v[52:55], v[24:27], v[216:219], v[52:55]
    ds_read_b64_tr_b16 v[20:21], v9 offset:47104
    v_mfma_f32_16x16x32_bf16 v[56:59], v[24:27], v[220:223], v[56:59]
    ds_read_b64_tr_b16 v[22:23], v9 offset:47360
    s_waitcnt lgkmcnt(6)
    v_mfma_f32_16x16x32_bf16 v[76:79], v[28:31], v[176:179], v[76:79]
    ds_read_b64_tr_b16 v[24:25], v10 offset:47104
    v_mfma_f32_16x16x32_bf16 v[80:83], v[28:31], v[180:183], v[80:83]
    ds_read_b64_tr_b16 v[26:27], v10 offset:47360
    s_waitcnt lgkmcnt(6)
    v_mfma_f32_16x16x32_bf16 v[92:95], v[32:35], v[176:179], v[92:95]
    ds_read_b64_tr_b16 v[28:29], v11 offset:47104
    v_mfma_f32_16x16x32_bf16 v[96:99], v[32:35], v[180:183], v[96:99]
    ds_read_b64_tr_b16 v[30:31], v11 offset:47360
    s_waitcnt lgkmcnt(6)
    v_mfma_f32_16x16x32_bf16 v[108:111], v[16:19], v[176:179], v[108:111]
    s_barrier
    v_add_u32 v9, 57344, v9
    v_add_u32 v10, 57344, v10
    v_add_u32 v11, 57344, v11
    v_add_u32 v126, 57344, v126
    ds_read_b64_tr_b16 v[32:33], v126 offset:24576
    v_mfma_f32_16x16x32_bf16 v[112:115], v[16:19], v[180:183], v[112:115]
    ds_read_b64_tr_b16 v[34:35], v126 offset:24832
    s_waitcnt lgkmcnt(6)
    v_mfma_f32_16x16x32_bf16 v[76:79], v[20:23], v[184:187], v[76:79]
    ds_read_b64_tr_b16 v[16:17], v9 offset:0
    v_mfma_f32_16x16x32_bf16 v[80:83], v[20:23], v[188:191], v[80:83]
    ds_read_b64_tr_b16 v[18:19], v9 offset:256
    s_waitcnt lgkmcnt(6)
    v_mfma_f32_16x16x32_bf16 v[92:95], v[24:27], v[184:187], v[92:95]
    ds_read_b64_tr_b16 v[20:21], v10 offset:0
    v_mfma_f32_16x16x32_bf16 v[96:99], v[24:27], v[188:191], v[96:99]
    ds_read_b64_tr_b16 v[22:23], v10 offset:256
    s_waitcnt lgkmcnt(6)
    v_mfma_f32_16x16x32_bf16 v[108:111], v[28:31], v[184:187], v[108:111]
    ds_read_b64_tr_b16 v[24:25], v11 offset:0
    v_mfma_f32_16x16x32_bf16 v[112:115], v[28:31], v[188:191], v[112:115]
    ds_read_b64_tr_b16 v[26:27], v11 offset:256
    s_waitcnt lgkmcnt(6)
    v_mfma_f32_16x16x32_bf16 v[52:55], v[32:35], v[224:227], v[52:55]
    ds_read_b64_tr_b16 v[28:29], v9 offset:6144
    v_mfma_f32_16x16x32_bf16 v[56:59], v[32:35], v[228:231], v[56:59]
    ds_read_b64_tr_b16 v[30:31], v9 offset:6400
    s_waitcnt lgkmcnt(6)
    v_mfma_f32_16x16x32_bf16 v[76:79], v[16:19], v[192:195], v[76:79]
    ds_read_b64_tr_b16 v[32:33], v10 offset:6144
    v_mfma_f32_16x16x32_bf16 v[80:83], v[16:19], v[196:199], v[80:83]
    ds_read_b64_tr_b16 v[34:35], v10 offset:6400
    s_waitcnt lgkmcnt(6)
    v_mfma_f32_16x16x32_bf16 v[92:95], v[20:23], v[192:195], v[92:95]
    ds_read_b64_tr_b16 v[16:17], v11 offset:6144
    v_mfma_f32_16x16x32_bf16 v[96:99], v[20:23], v[196:199], v[96:99]
    ds_read_b64_tr_b16 v[18:19], v11 offset:6400
    s_waitcnt lgkmcnt(6)
    v_mfma_f32_16x16x32_bf16 v[108:111], v[24:27], v[192:195], v[108:111]
    ds_read_b64_tr_b16 v[20:21], v126 offset:26624
    s_mov_b64 exec, 0xff
    buffer_load_dwordx2 v[14:15], v6, s[16:19], 0 offen sc1
    s_mov_b64 exec, -1
    v_mfma_f32_16x16x32_bf16 v[112:115], v[24:27], v[196:199], v[112:115]
    ds_read_b64_tr_b16 v[22:23], v126 offset:26880
    s_waitcnt lgkmcnt(6)
    v_mfma_f32_16x16x32_bf16 v[76:79], v[28:31], v[200:203], v[76:79]
    ds_read_b64_tr_b16 v[24:25], v9 offset:12288
    v_mfma_f32_16x16x32_bf16 v[80:83], v[28:31], v[204:207], v[80:83]
    ds_read_b64_tr_b16 v[26:27], v9 offset:12544
    s_waitcnt lgkmcnt(6)
    v_mfma_f32_16x16x32_bf16 v[92:95], v[32:35], v[200:203], v[92:95]
    ds_read_b64_tr_b16 v[28:29], v10 offset:12288
    v_mfma_f32_16x16x32_bf16 v[96:99], v[32:35], v[204:207], v[96:99]
    ds_read_b64_tr_b16 v[30:31], v10 offset:12544
    s_waitcnt lgkmcnt(6)
    v_mfma_f32_16x16x32_bf16 v[108:111], v[16:19], v[200:203], v[108:111]
    ds_read_b64_tr_b16 v[32:33], v11 offset:12288
    v_mfma_f32_16x16x32_bf16 v[112:115], v[16:19], v[204:207], v[112:115]
    ds_read_b64_tr_b16 v[34:35], v11 offset:12544
    s_waitcnt lgkmcnt(6)
    v_mfma_f32_16x16x32_bf16 v[52:55], v[20:23], v[232:235], v[52:55]
    ds_read_b64_tr_b16 v[16:17], v9 offset:18432
    v_mfma_f32_16x16x32_bf16 v[56:59], v[20:23], v[236:239], v[56:59]
    ds_read_b64_tr_b16 v[18:19], v9 offset:18688
    s_waitcnt lgkmcnt(6)
    v_mfma_f32_16x16x32_bf16 v[76:79], v[24:27], v[208:211], v[76:79]
    ds_read_b64_tr_b16 v[20:21], v10 offset:18432
    v_mfma_f32_16x16x32_bf16 v[80:83], v[24:27], v[212:215], v[80:83]
    ds_read_b64_tr_b16 v[22:23], v10 offset:18688
    s_waitcnt lgkmcnt(6)
    v_mfma_f32_16x16x32_bf16 v[92:95], v[28:31], v[208:211], v[92:95]
    ds_read_b64_tr_b16 v[24:25], v11 offset:18432
    v_mfma_f32_16x16x32_bf16 v[96:99], v[28:31], v[212:215], v[96:99]
    ds_read_b64_tr_b16 v[26:27], v11 offset:18688
    s_waitcnt lgkmcnt(6)
    v_mfma_f32_16x16x32_bf16 v[108:111], v[32:35], v[208:211], v[108:111]
    s_barrier
    v_subrev_u32 v9, 114688, v9
    v_subrev_u32 v10, 114688, v10
    v_subrev_u32 v11, 114688, v11
    v_subrev_u32 v126, 114688, v126
    ds_read_b64_tr_b16 v[28:29], v126 offset:24576
    v_mfma_f32_16x16x32_bf16 v[112:115], v[32:35], v[212:215], v[112:115]
    ds_read_b64_tr_b16 v[30:31], v126 offset:24832
    s_waitcnt lgkmcnt(6)
    v_mfma_f32_16x16x32_bf16 v[76:79], v[16:19], v[216:219], v[76:79]
    ds_read_b64_tr_b16 v[32:33], v126 offset:26624
    v_mfma_f32_16x16x32_bf16 v[80:83], v[16:19], v[220:223], v[80:83]
    ds_read_b64_tr_b16 v[34:35], v126 offset:26880
    s_waitcnt lgkmcnt(6)
    v_mfma_f32_16x16x32_bf16 v[92:95], v[20:23], v[216:219], v[92:95]
    ds_read_b64_tr_b16 v[16:17], v9 offset:0
    v_mfma_f32_16x16x32_bf16 v[96:99], v[20:23], v[220:223], v[96:99]
    ds_read_b64_tr_b16 v[18:19], v9 offset:256
    s_waitcnt lgkmcnt(6)
    v_mfma_f32_16x16x32_bf16 v[108:111], v[24:27], v[216:219], v[108:111]
    ds_read_b64_tr_b16 v[20:21], v10 offset:0
    s_waitcnt vmcnt(0)
    s_mov_b64 exec, 0xff
    v_cmp_ne_u64 vcc, s[58:59], v[14:15]
    s_mov_b64 exec, -1
    s_cbranch_vccnz Lal_18
    buffer_load_dwordx4 v[116:119], v124, s[16:19], s62 offen sc1
Lal_18:
    v_mfma_f32_16x16x32_bf16 v[112:115], v[24:27], v[220:223], v[112:115]
    ds_read_b64_tr_b16 v[22:23], v10 offset:256
    s_waitcnt lgkmcnt(6)
    v_mfma_f32_16x16x32_bf16 v[52:55], v[28:31], v[240:243], v[52:55]
    ds_read_b64_tr_b16 v[24:25], v11 offset:0
    v_mfma_f32_16x16x32_bf16 v[56:59], v[28:31], v[244:247], v[56:59]
    ds_read_b64_tr_b16 v[26:27], v11 offset:256
    s_waitcnt lgkmcnt(6)
    v_mfma_f32_16x16x32_bf16 v[52:55], v[32:35], v[248:251], v[52:55]
    ds_read_b64_tr_b16 v[28:29], v9 offset:6144
    v_add_u32 v192, s40, v1
    v_add_u32 v196, s41, v1
    v_mfma_f32_16x16x32_bf16 v[56:59], v[32:35], v[252:255], v[56:59]
    ds_read_b64_tr_b16 v[30:31], v9 offset:6400
    s_waitcnt lgkmcnt(6)
    v_mfma_f32_16x16x32_bf16 v[76:79], v[16:19], v[224:227], v[76:79]
    ds_read_b64_tr_b16 v[32:33], v10 offset:6144
    v_add_u32 v200, s42, v1
    v_add_u32 v193, s43, v1
    v_mfma_f32_16x16x32_bf16 v[80:83], v[16:19], v[228:231], v[80:83]
    ds_read_b64_tr_b16 v[34:35], v10 offset:6400
    s_waitcnt lgkmcnt(6)
    v_mfma_f32_16x16x32_bf16 v[92:95], v[20:23], v[224:227], v[92:95]
    ds_read_b64_tr_b16 v[16:17], v11 offset:6144
    s_cbranch_vccnz Lal_19
    s_mov_b64 exec, s[66:67]
    buffer_load_dwordx4 v[36:39], v125, s[16:19], s62 offen offset:1024 sc1
    buffer_load_dwordx4 v[40:43], v125, s[16:19], s62 offen offset:1536 sc1
    s_mov_b64 exec, -1
    s_addk_i32 s62, 2048
    s_bitset0_b32 s62, 15
Lal_19:
    v_mfma_f32_16x16x32_bf16 v[96:99], v[20:23], v[228:231], v[96:99]
    ds_read_b64_tr_b16 v[18:19], v11 offset:6400
    s_waitcnt lgkmcnt(6)
    v_mfma_f32_16x16x32_bf16 v[108:111], v[24:27], v[224:227], v[108:111]
    ds_read_b64_tr_b16 v[20:21], v9 offset:12288
    v_mul_f32 v52, 0x3eb8aa3b, v52
    v_mul_f32 v53, 0x3eb8aa3b, v53
    v_mfma_f32_16x16x32_bf16 v[112:115], v[24:27], v[228:231], v[112:115]
    ds_read_b64_tr_b16 v[22:23], v9 offset:12544
    v_mul_f32 v54, 0x3eb8aa3b, v54
    s_waitcnt lgkmcnt(6)
    v_mfma_f32_16x16x32_bf16 v[76:79], v[28:31], v[232:235], v[76:79]
    ds_read_b64_tr_b16 v[24:25], v10 offset:12288
    v_mul_f32 v55, 0x3eb8aa3b, v55
    v_mul_f32 v56, 0x3eb8aa3b, v56
    v_mfma_f32_16x16x32_bf16 v[80:83], v[28:31], v[236:239], v[80:83]
    ds_read_b64_tr_b16 v[26:27], v10 offset:12544
    v_mul_f32 v57, 0x3eb8aa3b, v57
    s_waitcnt lgkmcnt(6)
    v_mfma_f32_16x16x32_bf16 v[92:95], v[32:35], v[232:235], v[92:95]
    ds_read_b64_tr_b16 v[28:29], v11 offset:12288
    v_mul_f32 v58, 0x3eb8aa3b, v58
    v_mul_f32 v59, 0x3eb8aa3b, v59
    v_mfma_f32_16x16x32_bf16 v[96:99], v[32:35], v[236:239], v[96:99]
    ds_read_b64_tr_b16 v[30:31], v11 offset:12544
    v_cvt_pk_bf16_f32 v204, v52, v53
    s_waitcnt lgkmcnt(6)
    v_mfma_f32_16x16x32_bf16 v[108:111], v[16:19], v[232:235], v[108:111]
    ds_read_b64_tr_b16 v[32:33], v9 offset:18432
    v_cvt_pk_bf16_f32 v205, v54, v55
    v_cvt_pk_bf16_f32 v206, v56, v57
    v_mfma_f32_16x16x32_bf16 v[112:115], v[16:19], v[236:239], v[112:115]
    ds_read_b64_tr_b16 v[34:35], v9 offset:18688
    v_cvt_pk_bf16_f32 v207, v58, v59
    s_waitcnt lgkmcnt(6)
    v_mfma_f32_16x16x32_bf16 v[76:79], v[20:23], v[240:243], v[76:79]
    ds_read_b64_tr_b16 v[16:17], v10 offset:18432
    v_permlane16_swap_b32 v204, v206
    v_permlane16_swap_b32 v205, v207
    v_mfma_f32_16x16x32_bf16 v[80:83], v[20:23], v[244:247], v[80:83]
    ds_read_b64_tr_b16 v[18:19], v10 offset:18688
    ds_write_b128 v193, v[204:207]
    s_waitcnt lgkmcnt(7)
    v_mfma_f32_16x16x32_bf16 v[92:95], v[24:27], v[240:243], v[92:95]
    ds_read_b64_tr_b16 v[20:21], v11 offset:18432
    v_mfma_f32_16x16x32_bf16 v[96:99], v[24:27], v[244:247], v[96:99]
    ds_read_b64_tr_b16 v[22:23], v11 offset:18688
    s_waitcnt lgkmcnt(7)
    v_mfma_f32_16x16x32_bf16 v[108:111], v[28:31], v[240:243], v[108:111]
    s_cbranch_vccnz Lal_20
    buffer_load_dwordx4 v[120:123], v124, s[16:19], s62 offen sc1
Lal_20:
    v_mfma_f32_16x16x32_bf16 v[112:115], v[28:31], v[244:247], v[112:115]
    s_waitcnt lgkmcnt(5)
    v_mfma_f32_16x16x32_bf16 v[76:79], v[32:35], v[248:251], v[76:79]
    s_cbranch_vccnz Lal_21
    s_mov_b64 exec, s[66:67]
    buffer_load_dwordx4 v[44:47], v125, s[16:19], s62 offen offset:1024 sc1
    buffer_load_dwordx4 v[48:51], v125, s[16:19], s62 offen offset:1536 sc1
    s_mov_b64 exec, -1
    s_addk_i32 s62, 2048
    s_bitset0_b32 s62, 15
Lal_21:
    v_mfma_f32_16x16x32_bf16 v[80:83], v[32:35], v[252:255], v[80:83]
    s_waitcnt lgkmcnt(3)
    v_mfma_f32_16x16x32_bf16 v[92:95], v[16:19], v[248:251], v[92:95]
    v_mfma_f32_16x16x32_bf16 v[96:99], v[16:19], v[252:255], v[96:99]
    s_waitcnt lgkmcnt(0)
    v_mfma_f32_16x16x32_bf16 v[108:111], v[20:23], v[248:251], v[108:111]
    v_mfma_f32_16x16x32_bf16 v[112:115], v[20:23], v[252:255], v[112:115]
    s_barrier
    ds_read_b128 v[192:195], v192
    ds_read_b128 v[196:199], v196
    ds_read_b128 v[200:203], v200
    v_mov_b32 v240, -1
    v_mov_b32 v241, -1
    v_mov_b32 v242, -1
    v_mov_b32 v243, -1
    buffer_store_dwordx4 v[240:243], v1, s[16:19], s85 offen sc1
    v_pk_mul_f32 v[52:53], v[100:101], v[100:101]
    v_pk_mul_f32 v[54:55], v[102:103], v[102:103]
    v_pk_mul_f32 v[56:57], v[104:105], v[104:105]
    v_pk_mul_f32 v[58:59], v[106:107], v[106:107]
    v_pk_fma_f32 v[52:53], v[52:53], s[76:77], v[60:61]
    v_pk_fma_f32 v[54:55], v[54:55], s[76:77], v[60:61]
    v_pk_fma_f32 v[56:57], v[56:57], s[76:77], v[60:61]
    v_pk_fma_f32 v[58:59], v[58:59], s[76:77], v[60:61]
    v_pk_mul_f32 v[52:53], v[52:53], v[100:101]
    v_pk_mul_f32 v[54:55], v[54:55], v[102:103]
    v_pk_mul_f32 v[56:57], v[56:57], v[104:105]
    v_pk_mul_f32 v[58:59], v[58:59], v[106:107]
    v_exp_f32 v52, v52
    v_exp_f32 v53, v53
    v_exp_f32 v54, v54
    v_exp_f32 v55, v55
    v_exp_f32 v56, v56
    v_exp_f32 v57, v57
    v_exp_f32 v58, v58
    v_exp_f32 v59, v59
    v_pk_mul_f32 v[100:101], v[100:101], v[108:109]
    v_pk_mul_f32 v[102:103], v[102:103], v[110:111]
    v_pk_mul_f32 v[104:105], v[104:105], v[112:113]
    v_pk_mul_f32 v[106:107], v[106:107], v[114:115]
    v_pk_fma_f32 v[52:53], v[52:53], v[62:63], v[62:63]
    v_pk_fma_f32 v[54:55], v[54:55], v[62:63], v[62:63]
    v_pk_fma_f32 v[56:57], v[56:57], v[64:65], v[64:65]
    v_pk_fma_f32 v[58:59], v[58:59], v[64:65], v[64:65]
    v_rcp_f32 v52, v52
    v_rcp_f32 v53, v53
    v_rcp_f32 v54, v54
    v_rcp_f32 v55, v55
    v_rcp_f32 v56, v56
    v_rcp_f32 v57, v57
    v_rcp_f32 v58, v58
    v_rcp_f32 v59, v59
    v_pk_mul_f32 v[100:101], v[100:101], v[52:53]
    v_pk_mul_f32 v[102:103], v[102:103], v[54:55]
    v_pk_mul_f32 v[104:105], v[104:105], v[56:57]
    v_pk_mul_f32 v[106:107], v[106:107], v[58:59]
    v_cvt_pk_bf16_f32 v108, v100, v101
    v_cvt_pk_bf16_f32 v110, v104, v105
    v_cvt_pk_bf16_f32 v109, v102, v103
    v_cvt_pk_bf16_f32 v111, v106, v107
    v_permlane16_swap_b32 v108, v110
    s_nop 0
    v_permlane16_swap_b32 v109, v111
    s_add_u32 s68, s63, 4096
    buffer_store_dwordx4 v[108:111], v1, s[16:19], s68 offen sc1
    v_pk_mul_f32 v[52:53], v[84:85], v[84:85]
    v_pk_mul_f32 v[54:55], v[86:87], v[86:87]
    v_pk_mul_f32 v[56:57], v[88:89], v[88:89]
    v_pk_mul_f32 v[58:59], v[90:91], v[90:91]
    v_pk_fma_f32 v[52:53], v[52:53], s[76:77], v[60:61]
    v_pk_fma_f32 v[54:55], v[54:55], s[76:77], v[60:61]
    v_pk_fma_f32 v[56:57], v[56:57], s[76:77], v[60:61]
    v_pk_fma_f32 v[58:59], v[58:59], s[76:77], v[60:61]
    v_pk_mul_f32 v[52:53], v[52:53], v[84:85]
    v_pk_mul_f32 v[54:55], v[54:55], v[86:87]
    v_pk_mul_f32 v[56:57], v[56:57], v[88:89]
    v_pk_mul_f32 v[58:59], v[58:59], v[90:91]
    v_exp_f32 v52, v52
    v_exp_f32 v53, v53
    v_exp_f32 v54, v54
    v_exp_f32 v55, v55
    v_exp_f32 v56, v56
    v_exp_f32 v57, v57
    v_exp_f32 v58, v58
    v_exp_f32 v59, v59
    v_pk_mul_f32 v[84:85], v[84:85], v[92:93]
    v_pk_mul_f32 v[86:87], v[86:87], v[94:95]
    v_pk_mul_f32 v[88:89], v[88:89], v[96:97]
    v_pk_mul_f32 v[90:91], v[90:91], v[98:99]
    v_pk_fma_f32 v[52:53], v[52:53], v[62:63], v[62:63]
    v_pk_fma_f32 v[54:55], v[54:55], v[62:63], v[62:63]
    v_pk_fma_f32 v[56:57], v[56:57], v[64:65], v[64:65]
    v_pk_fma_f32 v[58:59], v[58:59], v[64:65], v[64:65]
    v_rcp_f32 v52, v52
    v_rcp_f32 v53, v53
    v_rcp_f32 v54, v54
    v_rcp_f32 v55, v55
    v_rcp_f32 v56, v56
    v_rcp_f32 v57, v57
    v_rcp_f32 v58, v58
    v_rcp_f32 v59, v59
    v_pk_mul_f32 v[84:85], v[84:85], v[52:53]
    v_pk_mul_f32 v[86:87], v[86:87], v[54:55]
    v_pk_mul_f32 v[88:89], v[88:89], v[56:57]
    v_pk_mul_f32 v[90:91], v[90:91], v[58:59]
    v_cvt_pk_bf16_f32 v92, v84, v85
    v_cvt_pk_bf16_f32 v94, v88, v89
    v_cvt_pk_bf16_f32 v93, v86, v87
    v_cvt_pk_bf16_f32 v95, v90, v91
    v_permlane16_swap_b32 v92, v94
    s_nop 0
    v_permlane16_swap_b32 v93, v95
    s_add_u32 s68, s63, 2048
    buffer_store_dwordx4 v[92:95], v1, s[16:19], s68 offen sc1
    v_pk_mul_f32 v[52:53], v[68:69], v[68:69]
    v_pk_mul_f32 v[54:55], v[70:71], v[70:71]
    v_pk_mul_f32 v[56:57], v[72:73], v[72:73]
    v_pk_mul_f32 v[58:59], v[74:75], v[74:75]
    v_pk_fma_f32 v[52:53], v[52:53], s[76:77], v[60:61]
    v_pk_fma_f32 v[54:55], v[54:55], s[76:77], v[60:61]
    v_pk_fma_f32 v[56:57], v[56:57], s[76:77], v[60:61]
    v_pk_fma_f32 v[58:59], v[58:59], s[76:77], v[60:61]
    v_pk_mul_f32 v[52:53], v[52:53], v[68:69]
    v_pk_mul_f32 v[54:55], v[54:55], v[70:71]
    v_pk_mul_f32 v[56:57], v[56:57], v[72:73]
    v_pk_mul_f32 v[58:59], v[58:59], v[74:75]
    v_exp_f32 v52, v52
    v_exp_f32 v53, v53
    v_exp_f32 v54, v54
    v_exp_f32 v55, v55
    v_exp_f32 v56, v56
    v_exp_f32 v57, v57
    v_exp_f32 v58, v58
    v_exp_f32 v59, v59
    v_pk_mul_f32 v[68:69], v[68:69], v[76:77]
    v_pk_mul_f32 v[70:71], v[70:71], v[78:79]
    v_pk_mul_f32 v[72:73], v[72:73], v[80:81]
    v_pk_mul_f32 v[74:75], v[74:75], v[82:83]
    v_pk_fma_f32 v[52:53], v[52:53], v[62:63], v[62:63]
    v_pk_fma_f32 v[54:55], v[54:55], v[62:63], v[62:63]
    v_pk_fma_f32 v[56:57], v[56:57], v[64:65], v[64:65]
    v_pk_fma_f32 v[58:59], v[58:59], v[64:65], v[64:65]
    v_rcp_f32 v52, v52
    v_rcp_f32 v53, v53
    v_rcp_f32 v54, v54
    v_rcp_f32 v55, v55
    v_rcp_f32 v56, v56
    v_rcp_f32 v57, v57
    v_rcp_f32 v58, v58
    v_rcp_f32 v59, v59
    v_pk_mul_f32 v[68:69], v[68:69], v[52:53]
    v_pk_mul_f32 v[70:71], v[70:71], v[54:55]
    v_pk_mul_f32 v[72:73], v[72:73], v[56:57]
    v_pk_mul_f32 v[74:75], v[74:75], v[58:59]
    v_cvt_pk_bf16_f32 v76, v68, v69
    v_cvt_pk_bf16_f32 v78, v72, v73
    v_cvt_pk_bf16_f32 v77, v70, v71
    v_cvt_pk_bf16_f32 v79, v74, v75
    v_permlane16_swap_b32 v76, v78
    s_nop 0
    v_permlane16_swap_b32 v77, v79
    s_add_u32 s68, s63, 0
    buffer_store_dwordx4 v[76:79], v1, s[16:19], s68 offen sc1
Lffn:
    s_cbranch_vccnz Llate
Llate_done:
    v_mov_b32 v126, 0xdddddddd
    v_mov_b32 v16, 0
    v_mov_b32 v17, 0
    v_mov_b32 v18, 0
    v_mov_b32 v19, 0
    s_waitcnt vmcnt(8)
    s_waitcnt lgkmcnt(2)
    v_mfma_f32_32x32x16_bf16 v[52:67], v[116:119], v[192:195], 0
    v_mfma_f32_32x32x16_bf16 v[128:143], v[16:19], v[16:19], 0
    s_nop 10
    v_exp_f32 v52, v52
    v_exp_f32 v53, v53
    v_exp_f32 v54, v54
    v_exp_f32 v55, v55
    v_exp_f32 v56, v56
    s_waitcnt lgkmcnt(1)
    v_mfma_f32_32x32x16_bf16 v[208:223], v[116:119], v[196:199], 0
    s_waitcnt vmcnt(6)
    v_exp_f32 v57, v57
    v_exp_f32 v58, v58
    v_exp_f32 v59, v59
    v_exp_f32 v60, v60
    v_exp_f32 v61, v61
    v_smfmac_f32_32x32x32_bf16 v[128:143], v[36:39], v[52:59], v126
    v_exp_f32 v62, v62
    v_exp_f32 v63, v63
    v_exp_f32 v64, v64
    v_mfma_f32_32x32x16_bf16 v[144:159], v[16:19], v[16:19], 0
    v_exp_f32 v65, v65
    v_exp_f32 v66, v66
    v_exp_f32 v67, v67
    v_exp_f32 v208, v208
    v_exp_f32 v209, v209
    v_smfmac_f32_32x32x32_bf16 v[128:143], v[40:43], v[60:67], v126
    v_exp_f32 v210, v210
    v_exp_f32 v211, v211
    v_exp_f32 v212, v212
    s_waitcnt lgkmcnt(0)
    v_mfma_f32_32x32x16_bf16 v[52:67], v[116:119], v[200:203], 0
    v_exp_f32 v213, v213
    v_exp_f32 v214, v214
    v_exp_f32 v215, v215
    v_exp_f32 v216, v216
    v_exp_f32 v217, v217
    v_smfmac_f32_32x32x32_bf16 v[144:159], v[36:39], v[208:215], v126
    v_exp_f32 v218, v218
    v_exp_f32 v219, v219
    v_exp_f32 v220, v220
    v_mfma_f32_32x32x16_bf16 v[160:175], v[16:19], v[16:19], 0
    v_exp_f32 v221, v221
    v_exp_f32 v222, v222
    v_exp_f32 v223, v223
    v_exp_f32 v52, v52
    v_exp_f32 v53, v53
    v_smfmac_f32_32x32x32_bf16 v[144:159], v[40:43], v[216:223], v126
    v_exp_f32 v54, v54
    v_exp_f32 v55, v55
    v_exp_f32 v56, v56
    v_mfma_f32_32x32x16_bf16 v[208:223], v[116:119], v[204:207], 0
    buffer_load_dwordx4 v[116:119], v124, s[16:19], s62 offen sc1
    v_exp_f32 v57, v57
    v_exp_f32 v58, v58
    v_exp_f32 v59, v59
    v_exp_f32 v60, v60
    v_exp_f32 v61, v61
    v_smfmac_f32_32x32x32_bf16 v[160:175], v[36:39], v[52:59], v126
    s_waitcnt vmcnt(6)
    s_lshl_b32 s68, s45, 8
    v_lshl_add_u32 v24, v0, 2, s68
    ds_read_b32 v24, v24 offset:1024
    v_exp_f32 v62, v62
    v_exp_f32 v63, v63
    v_exp_f32 v64, v64
    v_mfma_f32_32x32x16_bf16 v[176:191], v[16:19], v[16:19], 0
    v_exp_f32 v65, v65
    v_exp_f32 v66, v66
    v_exp_f32 v67, v67
    v_exp_f32 v208, v208
    v_exp_f32 v209, v209
    v_smfmac_f32_32x32x32_bf16 v[160:175], v[40:43], v[60:67], v126
    v_exp_f32 v210, v210
    v_exp_f32 v211, v211
    v_exp_f32 v212, v212
    v_mfma_f32_32x32x16_bf16 v[52:67], v[120:123], v[192:195], 0
    v_exp_f32 v213, v213
    v_exp_f32 v214, v214
    v_exp_f32 v215, v215
    v_exp_f32 v216, v216
    v_exp_f32 v217, v217
    v_smfmac_f32_32x32x32_bf16 v[176:191], v[36:39], v[208:215], v126
    s_waitcnt lgkmcnt(0)
    v_mul_f32 v24, 0xbfb8aa3b, v24
    v_exp_f32 v24, v24
    s_waitcnt vmcnt(1)
    v_mov_b32 v14, 2048
    v_mov_b32 v15, 1
    s_mov_b64 exec, 1
    ds_add_rtn_u32 v14, v14, v15
    s_mov_b64 exec, -1
    v_exp_f32 v218, v218
    v_exp_f32 v219, v219
    v_exp_f32 v220, v220
    v_exp_f32 v221, v221
    v_exp_f32 v222, v222
    v_exp_f32 v223, v223
    v_exp_f32 v52, v52
    v_exp_f32 v53, v53
    v_smfmac_f32_32x32x32_bf16 v[176:191], v[40:43], v[216:223], v126
    s_mov_b64 exec, s[66:67]
    buffer_load_dwordx4 v[36:39], v125, s[16:19], s62 offen offset:1024 sc1
    buffer_load_dwordx4 v[40:43], v125, s[16:19], s62 offen offset:1536 sc1
    s_mov_b64 exec, -1
    v_exp_f32 v54, v54
    v_exp_f32 v55, v55
    v_exp_f32 v56, v56
    v_mfma_f32_32x32x16_bf16 v[208:223], v[120:123], v[196:199], 0
    v_exp_f32 v57, v57
    v_exp_f32 v58, v58
    v_exp_f32 v59, v59
    v_exp_f32 v60, v60
    v_exp_f32 v61, v61
    v_smfmac_f32_32x32x32_bf16 v[128:143], v[44:47], v[52:59], v126
    s_addk_i32 s62, 2048
    s_bitset0_b32 s62, 15
    s_waitcnt lgkmcnt(0)
    v_readfirstlane_b32 s68, v14
    s_cmp_lg_u32 s68, 7
    s_cbranch_scc1 Lf2_22
    s_lshl_b32 s68, s48, 4
    s_add_u32 s68, s68, s47
    s_lshl_b32 s68, s68, 7
    s_add_u32 s68, s68, 8421376
    v_mov_b32 v14, s58
    v_mov_b32 v15, s59
    s_mov_b64 exec, 1
    buffer_store_dwordx2 v[14:15], off, s[16:19], s68 sc1
    s_mov_b64 exec, -1
Lf2_22:
    s_setprio 2
    v_exp_f32 v62, v62
    v_exp_f32 v63, v63
    v_exp_f32 v64, v64
    v_exp_f32 v65, v65
    v_exp_f32 v66, v66
    v_exp_f32 v67, v67
    v_exp_f32 v208, v208
    v_exp_f32 v209, v209
    v_smfmac_f32_32x32x32_bf16 v[128:143], v[48:51], v[60:67], v126
    v_exp_f32 v210, v210
    v_exp_f32 v211, v211
    v_exp_f32 v212, v212
    v_mfma_f32_32x32x16_bf16 v[52:67], v[120:123], v[200:203], 0
    v_exp_f32 v213, v213
    v_exp_f32 v214, v214
    v_exp_f32 v215, v215
    v_exp_f32 v216, v216
    v_exp_f32 v217, v217
    v_smfmac_f32_32x32x32_bf16 v[144:159], v[44:47], v[208:215], v126
    s_and_b32 s68, s44, 1
    s_lshl_b32 s68, s68, 10
    v_add_u32 v9, s68, v1
    v_xor_b32 v10, 1024, v9
    s_mul_i32 s63, s44, 22528
    v_exp_f32 v218, v218
    v_exp_f32 v219, v219
    v_exp_f32 v220, v220
    v_exp_f32 v221, v221
    v_exp_f32 v222, v222
    v_exp_f32 v223, v223
    v_exp_f32 v52, v52
    v_exp_f32 v53, v53
    v_smfmac_f32_32x32x32_bf16 v[144:159], v[48:51], v[216:223], v126
    v_exp_f32 v54, v54
    v_exp_f32 v55, v55
    v_exp_f32 v56, v56
    v_mfma_f32_32x32x16_bf16 v[208:223], v[120:123], v[204:207], 0
    buffer_load_dwordx4 v[120:123], v124, s[16:19], s62 offen sc1
    v_exp_f32 v57, v57
    v_exp_f32 v58, v58
    v_exp_f32 v59, v59
    v_exp_f32 v60, v60
    v_exp_f32 v61, v61
    v_smfmac_f32_32x32x32_bf16 v[160:175], v[44:47], v[52:59], v126
    s_waitcnt vmcnt(3)
    v_exp_f32 v62, v62
    v_exp_f32 v63, v63
    v_exp_f32 v64, v64
    v_exp_f32 v65, v65
    v_exp_f32 v66, v66
    v_exp_f32 v67, v67
    v_exp_f32 v208, v208
    v_exp_f32 v209, v209
    v_smfmac_f32_32x32x32_bf16 v[160:175], v[48:51], v[60:67], v126
    v_exp_f32 v210, v210
    v_exp_f32 v211, v211
    v_exp_f32 v212, v212
    v_mfma_f32_32x32x16_bf16 v[52:67], v[116:119], v[192:195], 0
    v_exp_f32 v213, v213
    v_exp_f32 v214, v214
    v_exp_f32 v215, v215
    v_exp_f32 v216, v216
    v_exp_f32 v217, v217
    v_smfmac_f32_32x32x32_bf16 v[176:191], v[44:47], v[208:215], v126
    v_exp_f32 v218, v218
    v_exp_f32 v219, v219
    v_exp_f32 v220, v220
    v_exp_f32 v221, v221
    v_exp_f32 v222, v222
    v_exp_f32 v223, v223
    v_exp_f32 v52, v52
    v_exp_f32 v53, v53
    v_smfmac_f32_32x32x32_bf16 v[176:191], v[48:51], v[216:223], v126
    s_mov_b64 exec, s[66:67]
    buffer_load_dwordx4 v[44:47], v125, s[16:19], s62 offen offset:1024 sc1
    buffer_load_dwordx4 v[48:51], v125, s[16:19], s62 offen offset:1536 sc1
    s_mov_b64 exec, -1
    v_exp_f32 v54, v54
    v_exp_f32 v55, v55
    v_exp_f32 v56, v56
    v_mfma_f32_32x32x16_bf16 v[208:223], v[116:119], v[196:199], 0
    s_waitcnt vmcnt(3)
    v_exp_f32 v57, v57
    v_exp_f32 v58, v58
    v_exp_f32 v59, v59
    v_exp_f32 v60, v60
    v_exp_f32 v61, v61
    v_smfmac_f32_32x32x32_bf16 v[128:143], v[36:39], v[52:59], v126
    s_addk_i32 s62, 2048
    s_bitset0_b32 s62, 15
    s_cmp_lg_u32 s44, 7
    s_cbranch_scc1 Ltc_23
    v_lshlrev_b32 v26, 7, v0
    s_mul_i32 s68, s2, 5504
    s_lshl_b32 s69, s2, 11
    s_bfm_b64 exec, 43, 0
    buffer_load_dword v27, v26, s[24:27], s68 offen
    s_bfm_b64 exec, 16, 0
    buffer_load_dword v28, v26, s[28:31], s69 offen
    s_mov_b64 exec, -1
Ltc_23:
    v_exp_f32 v62, v62
    v_exp_f32 v63, v63
    v_exp_f32 v64, v64
    v_exp_f32 v65, v65
    v_exp_f32 v66, v66
    v_exp_f32 v67, v67
    v_exp_f32 v208, v208
    v_exp_f32 v209, v209
    v_smfmac_f32_32x32x32_bf16 v[128:143], v[40:43], v[60:67], v126
    v_exp_f32 v210, v210
    v_exp_f32 v211, v211
    v_exp_f32 v212, v212
    v_mfma_f32_32x32x16_bf16 v[52:67], v[116:119], v[200:203], 0
    v_exp_f32 v213, v213
    v_exp_f32 v214, v214
    v_exp_f32 v215, v215
    v_exp_f32 v216, v216
    v_exp_f32 v217, v217
    v_smfmac_f32_32x32x32_bf16 v[144:159], v[36:39], v[208:215], v126
    v_exp_f32 v218, v218
    v_exp_f32 v219, v219
    v_exp_f32 v220, v220
    v_exp_f32 v221, v221
    v_exp_f32 v222, v222
    v_exp_f32 v223, v223
    v_exp_f32 v52, v52
    v_exp_f32 v53, v53
    v_smfmac_f32_32x32x32_bf16 v[144:159], v[40:43], v[216:223], v126
    v_exp_f32 v54, v54
    v_exp_f32 v55, v55
    v_exp_f32 v56, v56
    v_mfma_f32_32x32x16_bf16 v[208:223], v[116:119], v[204:207], 0
    buffer_load_dwordx4 v[116:119], v124, s[16:19], s62 offen sc1
    v_exp_f32 v57, v57
    v_exp_f32 v58, v58
    v_exp_f32 v59, v59
    v_exp_f32 v60, v60
    v_exp_f32 v61, v61
    v_smfmac_f32_32x32x32_bf16 v[160:175], v[36:39], v[52:59], v126
    s_waitcnt vmcnt(3)
    v_exp_f32 v62, v62
    v_exp_f32 v63, v63
    v_exp_f32 v64, v64
    v_exp_f32 v65, v65
    v_exp_f32 v66, v66
    v_exp_f32 v67, v67
    v_exp_f32 v208, v208
    v_exp_f32 v209, v209
    v_smfmac_f32_32x32x32_bf16 v[160:175], v[40:43], v[60:67], v126
    v_exp_f32 v210, v210
    v_exp_f32 v211, v211
    v_exp_f32 v212, v212
    v_mfma_f32_32x32x16_bf16 v[52:67], v[120:123], v[192:195], 0
    v_exp_f32 v213, v213
    v_exp_f32 v214, v214
    v_exp_f32 v215, v215
    v_exp_f32 v216, v216
    v_exp_f32 v217, v217
    v_smfmac_f32_32x32x32_bf16 v[176:191], v[36:39], v[208:215], v126
    v_exp_f32 v218, v218
    v_exp_f32 v219, v219
    v_exp_f32 v220, v220
    v_exp_f32 v221, v221
    v_exp_f32 v222, v222
    v_exp_f32 v223, v223
    v_exp_f32 v52, v52
    v_exp_f32 v53, v53
    v_smfmac_f32_32x32x32_bf16 v[176:191], v[40:43], v[216:223], v126
    s_mov_b64 exec, s[66:67]
    buffer_load_dwordx4 v[36:39], v125, s[16:19], s62 offen offset:1024 sc1
    buffer_load_dwordx4 v[40:43], v125, s[16:19], s62 offen offset:1536 sc1
    s_mov_b64 exec, -1
    v_exp_f32 v54, v54
    v_exp_f32 v55, v55
    v_exp_f32 v56, v56
    v_mfma_f32_32x32x16_bf16 v[208:223], v[120:123], v[196:199], 0
    s_waitcnt vmcnt(3)
    v_exp_f32 v57, v57
    v_exp_f32 v58, v58
    v_exp_f32 v59, v59
    v_exp_f32 v60, v60
    v_exp_f32 v61, v61
    v_smfmac_f32_32x32x32_bf16 v[128:143], v[44:47], v[52:59], v126
    s_addk_i32 s62, 2048
    s_bitset0_b32 s62, 15
    v_exp_f32 v62, v62
    v_exp_f32 v63, v63
    v_exp_f32 v64, v64
    v_exp_f32 v65, v65
    v_exp_f32 v66, v66
    v_exp_f32 v67, v67
    v_exp_f32 v208, v208
    v_exp_f32 v209, v209
    v_smfmac_f32_32x32x32_bf16 v[128:143], v[48:51], v[60:67], v126
    v_exp_f32 v210, v210
    v_exp_f32 v211, v211
    v_exp_f32 v212, v212
    v_mfma_f32_32x32x16_bf16 v[52:67], v[120:123], v[200:203], 0
    v_exp_f32 v213, v213
    v_exp_f32 v214, v214
    v_exp_f32 v215, v215
    v_exp_f32 v216, v216
    v_exp_f32 v217, v217
    v_smfmac_f32_32x32x32_bf16 v[144:159], v[44:47], v[208:215], v126
    s_add_u32 m0, s65, 4096
    v_exp_f32 v218, v218
    v_exp_f32 v219, v219
    v_exp_f32 v220, v220
    buffer_load_dwordx4 v2, s[24:27], s64 offen lds
    v_exp_f32 v221, v221
    v_exp_f32 v222, v222
    v_exp_f32 v223, v223
    v_exp_f32 v52, v52
    v_exp_f32 v53, v53
    v_smfmac_f32_32x32x32_bf16 v[144:159], v[48:51], v[216:223], v126
    buffer_load_dwordx4 v3, s[24:27], s64 offen offset:1024 lds
    s_addk_i32 s64, 16384
    v_exp_f32 v54, v54
    v_exp_f32 v55, v55
    v_exp_f32 v56, v56
    v_mfma_f32_32x32x16_bf16 v[208:223], v[120:123], v[204:207], 0
    buffer_load_dwordx4 v[120:123], v124, s[16:19], s62 offen sc1
    v_exp_f32 v57, v57
    v_exp_f32 v58, v58
    v_exp_f32 v59, v59
    v_exp_f32 v60, v60
    v_exp_f32 v61, v61
    v_smfmac_f32_32x32x32_bf16 v[160:175], v[44:47], v[52:59], v126
    s_waitcnt vmcnt(5)
    s_lshr_b32 s69, s49, 1
    s_lshl_b32 s69, s69, 11
    s_add_u32 s69, s69, 8421376
    v_lshl_add_u32 v6, v0, 7, s69
    s_mov_b64 exec, 0xffff
    buffer_load_dwordx2 v[14:15], v6, s[16:19], 0 offen sc1
    s_mov_b64 exec, -1
    v_exp_f32 v62, v62
    v_exp_f32 v63, v63
    v_exp_f32 v64, v64
    v_exp_f32 v65, v65
    v_exp_f32 v66, v66
    v_exp_f32 v67, v67
    v_exp_f32 v208, v208
    v_exp_f32 v209, v209
    v_smfmac_f32_32x32x32_bf16 v[160:175], v[48:51], v[60:67], v126
    v_exp_f32 v210, v210
    v_exp_f32 v211, v211
    v_exp_f32 v212, v212
    v_mfma_f32_32x32x16_bf16 v[52:67], v[116:119], v[192:195], 0
    v_exp_f32 v213, v213
    v_exp_f32 v214, v214
    v_exp_f32 v215, v215
    v_exp_f32 v216, v216
    v_exp_f32 v217, v217
    v_smfmac_f32_32x32x32_bf16 v[176:191], v[44:47], v[208:215], v126
    v_exp_f32 v218, v218
    v_exp_f32 v219, v219
    v_exp_f32 v220, v220
    v_exp_f32 v221, v221
    v_exp_f32 v222, v222
    v_exp_f32 v223, v223
    v_exp_f32 v52, v52
    v_exp_f32 v53, v53
    v_smfmac_f32_32x32x32_bf16 v[176:191], v[48:51], v[216:223], v126
    s_mov_b64 exec, s[66:67]
    buffer_load_dwordx4 v[44:47], v125, s[16:19], s62 offen offset:1024 sc1
    buffer_load_dwordx4 v[48:51], v125, s[16:19], s62 offen offset:1536 sc1
    s_mov_b64 exec, -1
    v_exp_f32 v54, v54
    v_exp_f32 v55, v55
    v_exp_f32 v56, v56
    v_mfma_f32_32x32x16_bf16 v[208:223], v[116:119], v[196:199], 0
    s_waitcnt vmcnt(6)
    v_exp_f32 v57, v57
    v_exp_f32 v58, v58
    v_exp_f32 v59, v59
    v_exp_f32 v60, v60
    v_exp_f32 v61, v61
    v_smfmac_f32_32x32x32_bf16 v[128:143], v[36:39], v[52:59], v126
    s_addk_i32 s62, 2048
    s_bitset0_b32 s62, 15
    s_waitcnt vmcnt(2)
    s_mov_b64 exec, 0xffff
    v_cmp_ne_u64 vcc, s[58:59], v[14:15]
    s_cbranch_vccnz Lp2r_24
Lp2c_25:
    s_mov_b64 exec, -1
    v_exp_f32 v62, v62
    v_exp_f32 v63, v63
    v_exp_f32 v64, v64
    buffer_load_dwordx4 v[240:243], v9, s[20:23], s63 offen sc1
    v_exp_f32 v65, v65
    v_exp_f32 v66, v66
    v_exp_f32 v67, v67
    v_exp_f32 v208, v208
    v_exp_f32 v209, v209
    v_smfmac_f32_32x32x32_bf16 v[128:143], v[40:43], v[60:67], v126
    v_exp_f32 v210, v210
    v_exp_f32 v211, v211
    v_exp_f32 v212, v212
    v_mfma_f32_32x32x16_bf16 v[52:67], v[116:119], v[200:203], 0
    buffer_load_dwordx4 v[244:247], v10, s[20:23], s63 offen sc1
    v_exp_f32 v213, v213
    v_exp_f32 v214, v214
    v_exp_f32 v215, v215
    v_exp_f32 v216, v216
    v_exp_f32 v217, v217
    v_smfmac_f32_32x32x32_bf16 v[144:159], v[36:39], v[208:215], v126
    s_addk_i32 s63, 2048
    s_add_u32 m0, s65, 6144
    v_exp_f32 v218, v218
    v_exp_f32 v219, v219
    v_exp_f32 v220, v220
    buffer_load_dwordx4 v2, s[24:27], s64 offen lds
    v_exp_f32 v221, v221
    v_exp_f32 v222, v222
    v_exp_f32 v223, v223
    v_exp_f32 v52, v52
    v_exp_f32 v53, v53
    v_smfmac_f32_32x32x32_bf16 v[144:159], v[40:43], v[216:223], v126
    buffer_load_dwordx4 v3, s[24:27], s64 offen offset:1024 lds
    s_addk_i32 s64, 16384
    v_exp_f32 v54, v54
    v_exp_f32 v55, v55
    v_exp_f32 v56, v56
    v_mfma_f32_32x32x16_bf16 v[208:223], v[116:119], v[204:207], 0
    buffer_load_dwordx4 v[116:119], v124, s[16:19], s62 offen sc1
    v_exp_f32 v57, v57
    v_exp_f32 v58, v58
    v_exp_f32 v59, v59
    v_exp_f32 v60, v60
    v_exp_f32 v61, v61
    v_smfmac_f32_32x32x32_bf16 v[160:175], v[36:39], v[52:59], v126
    v_exp_f32 v62, v62
    v_exp_f32 v63, v63
    v_exp_f32 v64, v64
    v_exp_f32 v65, v65
    v_exp_f32 v66, v66
    v_exp_f32 v67, v67
    v_exp_f32 v208, v208
    v_exp_f32 v209, v209
    v_smfmac_f32_32x32x32_bf16 v[160:175], v[40:43], v[60:67], v126
    ds_read_b64_tr_b16 v[16:17], v12 offset:4096
    ds_read_b64_tr_b16 v[18:19], v12 offset:4608
    v_exp_f32 v210, v210
    v_exp_f32 v211, v211
    v_exp_f32 v212, v212
    v_mfma_f32_32x32x16_bf16 v[52:67], v[120:123], v[192:195], 0
    v_exp_f32 v213, v213
    v_exp_f32 v214, v214
    v_exp_f32 v215, v215
    v_exp_f32 v216, v216
    v_exp_f32 v217, v217
    v_smfmac_f32_32x32x32_bf16 v[176:191], v[36:39], v[208:215], v126
    v_exp_f32 v218, v218
    v_exp_f32 v219, v219
    v_exp_f32 v220, v220
    v_exp_f32 v221, v221
    v_exp_f32 v222, v222
    v_exp_f32 v223, v223
    v_exp_f32 v52, v52
    v_exp_f32 v53, v53
    v_smfmac_f32_32x32x32_bf16 v[176:191], v[40:43], v[216:223], v126
    s_mov_b64 exec, s[66:67]
    buffer_load_dwordx4 v[36:39], v125, s[16:19], s62 offen offset:1024 sc1
    buffer_load_dwordx4 v[40:43], v125, s[16:19], s62 offen offset:1536 sc1
    s_mov_b64 exec, -1
    v_exp_f32 v54, v54
    v_exp_f32 v55, v55
    v_exp_f32 v56, v56
    v_mfma_f32_32x32x16_bf16 v[208:223], v[120:123], v[196:199], 0
    s_waitcnt vmcnt(5) lgkmcnt(0)
    v_exp_f32 v57, v57
    v_exp_f32 v58, v58
    v_exp_f32 v59, v59
    v_exp_f32 v60, v60
    v_exp_f32 v61, v61
    v_smfmac_f32_32x32x32_bf16 v[128:143], v[44:47], v[52:59], v126
    s_addk_i32 s62, 2048
    s_bitset0_b32 s62, 15
    v_exp_f32 v62, v62
    v_exp_f32 v63, v63
    v_exp_f32 v64, v64
    v_mfma_f32_32x32x16_bf16 v[68:83], v[16:19], v[240:243], 0
    buffer_load_dwordx4 v[248:251], v9, s[20:23], s63 offen sc1
    v_exp_f32 v65, v65
    v_exp_f32 v66, v66
    v_exp_f32 v67, v67
    v_exp_f32 v208, v208
    v_exp_f32 v209, v209
    v_smfmac_f32_32x32x32_bf16 v[128:143], v[48:51], v[60:67], v126
    ds_read_b64_tr_b16 v[20:21], v13 offset:4096
    ds_read_b64_tr_b16 v[22:23], v13 offset:4608
    v_exp_f32 v210, v210
    v_exp_f32 v211, v211
    v_exp_f32 v212, v212
    v_mfma_f32_32x32x16_bf16 v[52:67], v[120:123], v[200:203], 0
    buffer_load_dwordx4 v[252:255], v10, s[20:23], s63 offen sc1
    v_exp_f32 v213, v213
    v_exp_f32 v214, v214
    v_exp_f32 v215, v215
    v_exp_f32 v216, v216
    v_exp_f32 v217, v217
    v_smfmac_f32_32x32x32_bf16 v[144:159], v[44:47], v[208:215], v126
    s_addk_i32 s63, 2048
    s_add_u32 m0, s65, 8192
    v_exp_f32 v218, v218
    v_exp_f32 v219, v219
    v_exp_f32 v220, v220
    v_mfma_f32_32x32x16_bf16 v[100:115], v[16:19], v[244:247], 0
    buffer_load_dwordx4 v2, s[24:27], s64 offen lds
    v_exp_f32 v221, v221
    v_exp_f32 v222, v222
    v_exp_f32 v223, v223
    v_exp_f32 v52, v52
    v_exp_f32 v53, v53
    v_smfmac_f32_32x32x32_bf16 v[144:159], v[48:51], v[216:223], v126
    buffer_load_dwordx4 v3, s[24:27], s64 offen offset:1024 lds
    s_addk_i32 s64, 16384
    v_exp_f32 v54, v54
    v_exp_f32 v55, v55
    v_exp_f32 v56, v56
    v_mfma_f32_32x32x16_bf16 v[208:223], v[120:123], v[204:207], 0
    buffer_load_dwordx4 v[120:123], v124, s[16:19], s62 offen sc1
    v_exp_f32 v57, v57
    v_exp_f32 v58, v58
    v_exp_f32 v59, v59
    v_exp_f32 v60, v60
    v_exp_f32 v61, v61
    v_smfmac_f32_32x32x32_bf16 v[160:175], v[44:47], v[52:59], v126
    s_waitcnt vmcnt(7) lgkmcnt(0)
    s_sub_u32 s68, s45, 1
    s_and_b32 s68, s68, 3
    s_lshl_b32 s69, s46, 2
    s_add_u32 s68, s68, s69
    s_mul_i32 s68, s68, 7168
    v_add_u32 v26, s68, v1
    v_lshl_add_u32 v29, v0, 2, s68
    v_exp_f32 v62, v62
    v_exp_f32 v63, v63
    v_exp_f32 v64, v64
    v_mfma_f32_32x32x16_bf16 v[84:99], v[20:23], v[240:243], 0
    v_exp_f32 v65, v65
    v_exp_f32 v66, v66
    v_exp_f32 v67, v67
    v_exp_f32 v208, v208
    v_exp_f32 v209, v209
    v_smfmac_f32_32x32x32_bf16 v[160:175], v[48:51], v[60:67], v126
    ds_read_b64_tr_b16 v[16:17], v12 offset:6144
    ds_read_b64_tr_b16 v[18:19], v12 offset:6656
    v_exp_f32 v210, v210
    v_exp_f32 v211, v211
    v_exp_f32 v212, v212
    v_mfma_f32_32x32x16_bf16 v[52:67], v[116:119], v[192:195], 0
    v_exp_f32 v213, v213
    v_exp_f32 v214, v214
    v_exp_f32 v215, v215
    v_exp_f32 v216, v216
    v_exp_f32 v217, v217
    v_smfmac_f32_32x32x32_bf16 v[176:191], v[44:47], v[208:215], v126
    v_exp_f32 v218, v218
    v_exp_f32 v219, v219
    v_exp_f32 v220, v220
    v_mfma_f32_32x32x16_bf16 v[224:239], v[20:23], v[244:247], 0
    v_exp_f32 v221, v221
    v_exp_f32 v222, v222
    v_exp_f32 v223, v223
    v_exp_f32 v52, v52
    v_exp_f32 v53, v53
    v_smfmac_f32_32x32x32_bf16 v[176:191], v[48:51], v[216:223], v126
    s_mov_b64 exec, s[66:67]
    buffer_load_dwordx4 v[44:47], v125, s[16:19], s62 offen offset:1024 sc1
    buffer_load_dwordx4 v[48:51], v125, s[16:19], s62 offen offset:1536 sc1
    s_mov_b64 exec, -1
    v_exp_f32 v54, v54
    v_exp_f32 v55, v55
    v_exp_f32 v56, v56
    v_mfma_f32_32x32x16_bf16 v[208:223], v[116:119], v[196:199], 0
    s_waitcnt vmcnt(5) lgkmcnt(0)
    v_exp_f32 v57, v57
    v_exp_f32 v58, v58
    v_exp_f32 v59, v59
    v_exp_f32 v60, v60
    v_exp_f32 v61, v61
    v_smfmac_f32_32x32x32_bf16 v[128:143], v[36:39], v[52:59], v126
    s_addk_i32 s62, 2048
    s_bitset0_b32 s62, 15
    v_exp_f32 v62, v62
    v_exp_f32 v63, v63
    v_exp_f32 v64, v64
    v_mfma_f32_32x32x16_bf16 v[68:83], v[16:19], v[248:251], v[68:83]
    buffer_load_dwordx4 v[240:243], v9, s[20:23], s63 offen sc1
    v_exp_f32 v65, v65
    v_exp_f32 v66, v66
    v_exp_f32 v67, v67
    v_exp_f32 v208, v208
    v_exp_f32 v209, v209
    v_smfmac_f32_32x32x32_bf16 v[128:143], v[40:43], v[60:67], v126
    ds_read_b64_tr_b16 v[20:21], v13 offset:6144
    ds_read_b64_tr_b16 v[22:23], v13 offset:6656
    v_exp_f32 v210, v210
    v_exp_f32 v211, v211
    v_exp_f32 v212, v212
    v_mfma_f32_32x32x16_bf16 v[52:67], v[116:119], v[200:203], 0
    buffer_load_dwordx4 v[244:247], v10, s[20:23], s63 offen sc1
    v_exp_f32 v213, v213
    v_exp_f32 v214, v214
    v_exp_f32 v215, v215
    v_exp_f32 v216, v216
    v_exp_f32 v217, v217
    v_smfmac_f32_32x32x32_bf16 v[144:159], v[36:39], v[208:215], v126
    s_addk_i32 s63, 2048
    s_add_u32 m0, s65, 4096
    v_exp_f32 v218, v218
    v_exp_f32 v219, v219
    v_exp_f32 v220, v220
    v_mfma_f32_32x32x16_bf16 v[100:115], v[16:19], v[252:255], v[100:115]
    buffer_load_dwordx4 v2, s[24:27], s64 offen lds
    v_exp_f32 v221, v221
    v_exp_f32 v222, v222
    v_exp_f32 v223, v223
    v_exp_f32 v52, v52
    v_exp_f32 v53, v53
    v_smfmac_f32_32x32x32_bf16 v[144:159], v[40:43], v[216:223], v126
    buffer_load_dwordx4 v3, s[24:27], s64 offen offset:1024 lds
    s_addk_i32 s64, 16384
    v_exp_f32 v54, v54
    v_exp_f32 v55, v55
    v_exp_f32 v56, v56
    v_mfma_f32_32x32x16_bf16 v[208:223], v[116:119], v[204:207], 0
    buffer_load_dwordx4 v[116:119], v124, s[16:19], s62 offen sc1
    v_exp_f32 v57, v57
    v_exp_f32 v58, v58
    v_exp_f32 v59, v59
    v_exp_f32 v60, v60
    v_exp_f32 v61, v61
    v_smfmac_f32_32x32x32_bf16 v[160:175], v[36:39], v[52:59], v126
    s_waitcnt vmcnt(7) lgkmcnt(0)
    s_sub_u32 s68, s45, 2
    s_and_b32 s68, s68, 3
    s_lshl_b32 s69, s46, 2
    s_add_u32 s68, s68, s69
    s_mul_i32 s68, s68, 7168
    v_add_u32 v27, s68, v1
    v_lshl_add_u32 v30, v0, 2, s68
    v_exp_f32 v62, v62
    v_exp_f32 v63, v63
    v_exp_f32 v64, v64
    v_mfma_f32_32x32x16_bf16 v[84:99], v[20:23], v[248:251], v[84:99]
    v_exp_f32 v65, v65
    v_exp_f32 v66, v66
    v_exp_f32 v67, v67
    v_exp_f32 v208, v208
    v_exp_f32 v209, v209
    v_smfmac_f32_32x32x32_bf16 v[160:175], v[40:43], v[60:67], v126
    ds_read_b64_tr_b16 v[16:17], v12 offset:8192
    ds_read_b64_tr_b16 v[18:19], v12 offset:8704
    v_exp_f32 v210, v210
    v_exp_f32 v211, v211
    v_exp_f32 v212, v212
    v_mfma_f32_32x32x16_bf16 v[52:67], v[120:123], v[192:195], 0
    v_exp_f32 v213, v213
    v_exp_f32 v214, v214
    v_exp_f32 v215, v215
    v_exp_f32 v216, v216
    v_exp_f32 v217, v217
    v_smfmac_f32_32x32x32_bf16 v[176:191], v[36:39], v[208:215], v126
    v_exp_f32 v218, v218
    v_exp_f32 v219, v219
    v_exp_f32 v220, v220
    v_mfma_f32_32x32x16_bf16 v[224:239], v[20:23], v[252:255], v[224:239]
    v_exp_f32 v221, v221
    v_exp_f32 v222, v222
    v_exp_f32 v223, v223
    v_exp_f32 v52, v52
    v_exp_f32 v53, v53
    v_smfmac_f32_32x32x32_bf16 v[176:191], v[40:43], v[216:223], v126
    s_mov_b64 exec, s[66:67]
    buffer_load_dwordx4 v[36:39], v125, s[16:19], s62 offen offset:1024 sc1
    buffer_load_dwordx4 v[40:43], v125, s[16:19], s62 offen offset:1536 sc1
    s_mov_b64 exec, -1
    v_exp_f32 v54, v54
    v_exp_f32 v55, v55
    v_exp_f32 v56, v56
    v_mfma_f32_32x32x16_bf16 v[208:223], v[120:123], v[196:199], 0
    s_waitcnt vmcnt(5) lgkmcnt(0)
    v_exp_f32 v57, v57
    v_exp_f32 v58, v58
    v_exp_f32 v59, v59
    v_exp_f32 v60, v60
    v_exp_f32 v61, v61
    v_smfmac_f32_32x32x32_bf16 v[128:143], v[44:47], v[52:59], v126
    s_addk_i32 s62, 2048
    s_bitset0_b32 s62, 15
    v_exp_f32 v62, v62
    v_exp_f32 v63, v63
    v_exp_f32 v64, v64
    v_mfma_f32_32x32x16_bf16 v[68:83], v[16:19], v[240:243], v[68:83]
    buffer_load_dwordx4 v[248:251], v9, s[20:23], s63 offen sc1
    v_exp_f32 v65, v65
    v_exp_f32 v66, v66
    v_exp_f32 v67, v67
    v_exp_f32 v208, v208
    v_exp_f32 v209, v209
    v_smfmac_f32_32x32x32_bf16 v[128:143], v[48:51], v[60:67], v126
    ds_read_b64_tr_b16 v[20:21], v13 offset:8192
    ds_read_b64_tr_b16 v[22:23], v13 offset:8704
    v_exp_f32 v210, v210
    v_exp_f32 v211, v211
    v_exp_f32 v212, v212
    v_mfma_f32_32x32x16_bf16 v[52:67], v[120:123], v[200:203], 0
    buffer_load_dwordx4 v[252:255], v10, s[20:23], s63 offen sc1
    v_exp_f32 v213, v213
    v_exp_f32 v214, v214
    v_exp_f32 v215, v215
    v_exp_f32 v216, v216
    v_exp_f32 v217, v217
    v_smfmac_f32_32x32x32_bf16 v[144:159], v[44:47], v[208:215], v126
    s_addk_i32 s63, 2048
    s_add_u32 m0, s65, 6144
    v_exp_f32 v218, v218
    v_exp_f32 v219, v219
    v_exp_f32 v220, v220
    v_mfma_f32_32x32x16_bf16 v[100:115], v[16:19], v[244:247], v[100:115]
    buffer_load_dwordx4 v2, s[24:27], s64 offen lds
    v_exp_f32 v221, v221
    v_exp_f32 v222, v222
    v_exp_f32 v223, v223
    v_exp_f32 v52, v52
    v_exp_f32 v53, v53
    v_smfmac_f32_32x32x32_bf16 v[144:159], v[48:51], v[216:223], v126
    buffer_load_dwordx4 v3, s[24:27], s64 offen offset:1024 lds
    s_addk_i32 s64, 16384
    v_exp_f32 v54, v54
    v_exp_f32 v55, v55
    v_exp_f32 v56, v56
    v_mfma_f32_32x32x16_bf16 v[208:223], v[120:123], v[204:207], 0
    buffer_load_dwordx4 v[120:123], v124, s[16:19], s62 offen sc1
    v_exp_f32 v57, v57
    v_exp_f32 v58, v58
    v_exp_f32 v59, v59
    v_exp_f32 v60, v60
    v_exp_f32 v61, v61
    v_smfmac_f32_32x32x32_bf16 v[160:175], v[44:47], v[52:59], v126
    s_waitcnt vmcnt(7) lgkmcnt(0)
    s_sub_u32 s68, s45, 3
    s_and_b32 s68, s68, 3
    s_lshl_b32 s69, s46, 2
    s_add_u32 s68, s68, s69
    s_mul_i32 s68, s68, 7168
    v_add_u32 v28, s68, v1
    v_lshl_add_u32 v31, v0, 2, s68
    v_exp_f32 v62, v62
    v_exp_f32 v63, v63
    v_exp_f32 v64, v64
    v_mfma_f32_32x32x16_bf16 v[84:99], v[20:23], v[240:243], v[84:99]
    v_exp_f32 v65, v65
    v_exp_f32 v66, v66
    v_exp_f32 v67, v67
    v_exp_f32 v208, v208
    v_exp_f32 v209, v209
    v_smfmac_f32_32x32x32_bf16 v[160:175], v[48:51], v[60:67], v126
    ds_read_b64_tr_b16 v[16:17], v12 offset:4096
    ds_read_b64_tr_b16 v[18:19], v12 offset:4608
    v_exp_f32 v210, v210
    v_exp_f32 v211, v211
    v_exp_f32 v212, v212
    v_mfma_f32_32x32x16_bf16 v[52:67], v[116:119], v[192:195], 0
    v_exp_f32 v213, v213
    v_exp_f32 v214, v214
    v_exp_f32 v215, v215
    v_exp_f32 v216, v216
    v_exp_f32 v217, v217
    v_smfmac_f32_32x32x32_bf16 v[176:191], v[44:47], v[208:215], v126
    v_exp_f32 v218, v218
    v_exp_f32 v219, v219
    v_exp_f32 v220, v220
    v_mfma_f32_32x32x16_bf16 v[224:239], v[20:23], v[244:247], v[224:239]
    v_exp_f32 v221, v221
    v_exp_f32 v222, v222
    v_exp_f32 v223, v223
    v_exp_f32 v52, v52
    v_exp_f32 v53, v53
    v_smfmac_f32_32x32x32_bf16 v[176:191], v[48:51], v[216:223], v126
    s_mov_b64 exec, s[66:67]
    buffer_load_dwordx4 v[44:47], v125, s[16:19], s62 offen offset:1024 sc1
    buffer_load_dwordx4 v[48:51], v125, s[16:19], s62 offen offset:1536 sc1
    s_mov_b64 exec, -1
    v_exp_f32 v54, v54
    v_exp_f32 v55, v55
    v_exp_f32 v56, v56
    v_mfma_f32_32x32x16_bf16 v[208:223], v[116:119], v[196:199], 0
    s_waitcnt vmcnt(5) lgkmcnt(0)
    v_exp_f32 v57, v57
    v_exp_f32 v58, v58
    v_exp_f32 v59, v59
    v_exp_f32 v60, v60
    v_exp_f32 v61, v61
    v_smfmac_f32_32x32x32_bf16 v[128:143], v[36:39], v[52:59], v126
    s_addk_i32 s62, 2048
    s_bitset0_b32 s62, 15
    v_exp_f32 v62, v62
    v_exp_f32 v63, v63
    v_exp_f32 v64, v64
    v_mfma_f32_32x32x16_bf16 v[68:83], v[16:19], v[248:251], v[68:83]
    buffer_load_dwordx4 v[240:243], v9, s[20:23], s63 offen sc1
    v_exp_f32 v65, v65
    v_exp_f32 v66, v66
    v_exp_f32 v67, v67
    v_exp_f32 v208, v208
    v_exp_f32 v209, v209
    v_smfmac_f32_32x32x32_bf16 v[128:143], v[40:43], v[60:67], v126
    ds_read_b64_tr_b16 v[20:21], v13 offset:4096
    ds_read_b64_tr_b16 v[22:23], v13 offset:4608
    v_exp_f32 v210, v210
    v_exp_f32 v211, v211
    v_exp_f32 v212, v212
    v_mfma_f32_32x32x16_bf16 v[52:67], v[116:119], v[200:203], 0
    buffer_load_dwordx4 v[244:247], v10, s[20:23], s63 offen sc1
    v_exp_f32 v213, v213
    v_exp_f32 v214, v214
    v_exp_f32 v215, v215
    v_exp_f32 v216, v216
    v_exp_f32 v217, v217
    v_smfmac_f32_32x32x32_bf16 v[144:159], v[36:39], v[208:215], v126
    s_addk_i32 s63, 2048
    s_add_u32 m0, s65, 8192
    v_exp_f32 v218, v218
    v_exp_f32 v219, v219
    v_exp_f32 v220, v220
    v_mfma_f32_32x32x16_bf16 v[100:115], v[16:19], v[252:255], v[100:115]
    buffer_load_dwordx4 v2, s[24:27], s64 offen lds
    v_exp_f32 v221, v221
    v_exp_f32 v222, v222
    v_exp_f32 v223, v223
    v_exp_f32 v52, v52
    v_exp_f32 v53, v53
    v_smfmac_f32_32x32x32_bf16 v[144:159], v[40:43], v[216:223], v126
    buffer_load_dwordx4 v3, s[24:27], s64 offen offset:1024 lds
    s_addk_i32 s64, 16384
    v_exp_f32 v54, v54
    v_exp_f32 v55, v55
    v_exp_f32 v56, v56
    v_mfma_f32_32x32x16_bf16 v[208:223], v[116:119], v[204:207], 0
    buffer_load_dwordx4 v[116:119], v124, s[16:19], s62 offen sc1
    v_exp_f32 v57, v57
    v_exp_f32 v58, v58
    v_exp_f32 v59, v59
    v_exp_f32 v60, v60
    v_exp_f32 v61, v61
    v_smfmac_f32_32x32x32_bf16 v[160:175], v[36:39], v[52:59], v126
    s_waitcnt vmcnt(7) lgkmcnt(0)
    s_lshl_b32 s4, s49, 1
    s_and_b32 s68, s44, 1
    s_add_u32 s4, s4, s68
    s_lshl_b32 s4, s4, 2
    v_exp_f32 v62, v62
    v_exp_f32 v63, v63
    v_exp_f32 v64, v64
    v_mfma_f32_32x32x16_bf16 v[84:99], v[20:23], v[248:251], v[84:99]
    s_lshl_b32 s53, s44, 16
    s_lshl_b32 s68, s50, 7
    s_add_u32 s53, s53, s68
    s_lshl_b32 s56, s44, 13
    v_exp_f32 v65, v65
    v_exp_f32 v66, v66
    v_exp_f32 v67, v67
    v_exp_f32 v208, v208
    v_exp_f32 v209, v209
    v_smfmac_f32_32x32x32_bf16 v[160:175], v[40:43], v[60:67], v126
    ds_read_b64_tr_b16 v[16:17], v12 offset:6144
    ds_read_b64_tr_b16 v[18:19], v12 offset:6656
    v_exp_f32 v210, v210
    v_exp_f32 v211, v211
    v_exp_f32 v212, v212
    v_mfma_f32_32x32x16_bf16 v[52:67], v[120:123], v[192:195], 0
    s_add_u32 m0, s56, 65536
    v_exp_f32 v213, v213
    v_exp_f32 v214, v214
    v_exp_f32 v215, v215
    v_exp_f32 v216, v216
    v_exp_f32 v217, v217
    v_smfmac_f32_32x32x32_bf16 v[176:191], v[36:39], v[208:215], v126
    buffer_load_dwordx4 v2, s[28:31], s53 offen lds
    buffer_load_dwordx4 v3, s[28:31], s53 offen offset:1024 lds
    v_exp_f32 v218, v218
    v_exp_f32 v219, v219
    v_exp_f32 v220, v220
    v_mfma_f32_32x32x16_bf16 v[224:239], v[20:23], v[252:255], v[224:239]
    s_addk_i32 s53, 16384
    v_exp_f32 v221, v221
    v_exp_f32 v222, v222
    v_exp_f32 v223, v223
    v_exp_f32 v52, v52
    v_exp_f32 v53, v53
    v_smfmac_f32_32x32x32_bf16 v[176:191], v[40:43], v[216:223], v126
    s_mov_b64 exec, s[66:67]
    buffer_load_dwordx4 v[36:39], v125, s[16:19], s62 offen offset:1024 sc1
    buffer_load_dwordx4 v[40:43], v125, s[16:19], s62 offen offset:1536 sc1
    s_mov_b64 exec, -1
    v_exp_f32 v54, v54
    v_exp_f32 v55, v55
    v_exp_f32 v56, v56
    v_mfma_f32_32x32x16_bf16 v[208:223], v[120:123], v[196:199], 0
    s_waitcnt vmcnt(7) lgkmcnt(0)
    v_exp_f32 v57, v57
    v_exp_f32 v58, v58
    v_exp_f32 v59, v59
    v_exp_f32 v60, v60
    v_exp_f32 v61, v61
    v_smfmac_f32_32x32x32_bf16 v[128:143], v[44:47], v[52:59], v126
    s_addk_i32 s62, 2048
    s_bitset0_b32 s62, 15
    v_exp_f32 v62, v62
    v_exp_f32 v63, v63
    v_exp_f32 v64, v64
    v_mfma_f32_32x32x16_bf16 v[68:83], v[16:19], v[240:243], v[68:83]
    buffer_load_dwordx4 v[248:251], v9, s[20:23], s63 offen sc1
    v_exp_f32 v65, v65
    v_exp_f32 v66, v66
    v_exp_f32 v67, v67
    v_exp_f32 v208, v208
    v_exp_f32 v209, v209
    v_smfmac_f32_32x32x32_bf16 v[128:143], v[48:51], v[60:67], v126
    ds_read_b64_tr_b16 v[20:21], v13 offset:6144
    ds_read_b64_tr_b16 v[22:23], v13 offset:6656
    v_exp_f32 v210, v210
    v_exp_f32 v211, v211
    v_exp_f32 v212, v212
    v_mfma_f32_32x32x16_bf16 v[52:67], v[120:123], v[200:203], 0
    buffer_load_dwordx4 v[252:255], v10, s[20:23], s63 offen sc1
    v_exp_f32 v213, v213
    v_exp_f32 v214, v214
    v_exp_f32 v215, v215
    v_exp_f32 v216, v216
    v_exp_f32 v217, v217
    v_smfmac_f32_32x32x32_bf16 v[144:159], v[44:47], v[208:215], v126
    s_addk_i32 s63, 2048
    s_add_u32 m0, s65, 4096
    v_exp_f32 v218, v218
    v_exp_f32 v219, v219
    v_exp_f32 v220, v220
    v_mfma_f32_32x32x16_bf16 v[100:115], v[16:19], v[244:247], v[100:115]
    buffer_load_dwordx4 v2, s[24:27], s64 offen lds
    v_exp_f32 v221, v221
    v_exp_f32 v222, v222
    v_exp_f32 v223, v223
    v_exp_f32 v52, v52
    v_exp_f32 v53, v53
    v_smfmac_f32_32x32x32_bf16 v[144:159], v[48:51], v[216:223], v126
    buffer_load_dwordx4 v3, s[24:27], s64 offen offset:1024 lds
    s_addk_i32 s64, 16384
    v_exp_f32 v54, v54
    v_exp_f32 v55, v55
    v_exp_f32 v56, v56
    v_mfma_f32_32x32x16_bf16 v[208:223], v[120:123], v[204:207], 0
    buffer_load_dwordx4 v[120:123], v124, s[16:19], s62 offen sc1
    v_exp_f32 v57, v57
    v_exp_f32 v58, v58
    v_exp_f32 v59, v59
    v_exp_f32 v60, v60
    v_exp_f32 v61, v61
    v_smfmac_f32_32x32x32_bf16 v[160:175], v[44:47], v[52:59], v126
    s_waitcnt vmcnt(9) lgkmcnt(0)
    s_lshr_b32 s68, s44, 1
    s_add_u32 s4, s4, s68
    s_lshl_b32 s4, s4, 13
    s_add_u32 s4, s4, 6291456
    s_add_u32 s5, s4, 4096
    v_exp_f32 v62, v62
    v_exp_f32 v63, v63
    v_exp_f32 v64, v64
    v_mfma_f32_32x32x16_bf16 v[84:99], v[20:23], v[240:243], v[84:99]
    v_exp_f32 v65, v65
    v_exp_f32 v66, v66
    v_exp_f32 v67, v67
    v_exp_f32 v208, v208
    v_exp_f32 v209, v209
    v_smfmac_f32_32x32x32_bf16 v[160:175], v[48:51], v[60:67], v126
    ds_read_b64_tr_b16 v[16:17], v12 offset:8192
    ds_read_b64_tr_b16 v[18:19], v12 offset:8704
    v_exp_f32 v210, v210
    v_exp_f32 v211, v211
    v_exp_f32 v212, v212
    v_mfma_f32_32x32x16_bf16 v[52:67], v[116:119], v[192:195], 0
    s_add_u32 m0, s56, 67584
    v_exp_f32 v213, v213
    v_exp_f32 v214, v214
    v_exp_f32 v215, v215
    v_exp_f32 v216, v216
    v_exp_f32 v217, v217
    v_smfmac_f32_32x32x32_bf16 v[176:191], v[44:47], v[208:215], v126
    buffer_load_dwordx4 v2, s[28:31], s53 offen lds
    buffer_load_dwordx4 v3, s[28:31], s53 offen offset:1024 lds
    v_exp_f32 v218, v218
    v_exp_f32 v219, v219
    v_exp_f32 v220, v220
    v_mfma_f32_32x32x16_bf16 v[224:239], v[20:23], v[244:247], v[224:239]
    s_addk_i32 s53, 16384
    v_exp_f32 v221, v221
    v_exp_f32 v222, v222
    v_exp_f32 v223, v223
    v_exp_f32 v52, v52
    v_exp_f32 v53, v53
    v_smfmac_f32_32x32x32_bf16 v[176:191], v[48:51], v[216:223], v126
    s_mov_b64 exec, s[66:67]
    buffer_load_dwordx4 v[44:47], v125, s[16:19], s62 offen offset:1024 sc1
    buffer_load_dwordx4 v[48:51], v125, s[16:19], s62 offen offset:1536 sc1
    s_mov_b64 exec, -1
    v_exp_f32 v54, v54
    v_exp_f32 v55, v55
    v_exp_f32 v56, v56
    v_mfma_f32_32x32x16_bf16 v[208:223], v[116:119], v[196:199], 0
    s_waitcnt vmcnt(7) lgkmcnt(0)
    v_exp_f32 v57, v57
    v_exp_f32 v58, v58
    v_exp_f32 v59, v59
    v_exp_f32 v60, v60
    v_exp_f32 v61, v61
    v_smfmac_f32_32x32x32_bf16 v[128:143], v[36:39], v[52:59], v126
    s_addk_i32 s62, 2048
    s_bitset0_b32 s62, 15
    v_exp_f32 v62, v62
    v_exp_f32 v63, v63
    v_exp_f32 v64, v64
    v_mfma_f32_32x32x16_bf16 v[68:83], v[16:19], v[248:251], v[68:83]
    buffer_load_dwordx4 v[240:243], v9, s[20:23], s63 offen sc1
    v_exp_f32 v65, v65
    v_exp_f32 v66, v66
    v_exp_f32 v67, v67
    v_exp_f32 v208, v208
    v_exp_f32 v209, v209
    v_smfmac_f32_32x32x32_bf16 v[128:143], v[40:43], v[60:67], v126
    ds_read_b64_tr_b16 v[20:21], v13 offset:8192
    ds_read_b64_tr_b16 v[22:23], v13 offset:8704
    v_exp_f32 v210, v210
    v_exp_f32 v211, v211
    v_exp_f32 v212, v212
    v_mfma_f32_32x32x16_bf16 v[52:67], v[116:119], v[200:203], 0
    buffer_load_dwordx4 v[244:247], v10, s[20:23], s63 offen sc1
    v_exp_f32 v213, v213
    v_exp_f32 v214, v214
    v_exp_f32 v215, v215
    v_exp_f32 v216, v216
    v_exp_f32 v217, v217
    v_smfmac_f32_32x32x32_bf16 v[144:159], v[36:39], v[208:215], v126
    s_addk_i32 s63, 2048
    s_add_u32 m0, s65, 6144
    v_exp_f32 v218, v218
    v_exp_f32 v219, v219
    v_exp_f32 v220, v220
    v_mfma_f32_32x32x16_bf16 v[100:115], v[16:19], v[252:255], v[100:115]
    buffer_load_dwordx4 v2, s[24:27], s64 offen lds
    v_exp_f32 v221, v221
    v_exp_f32 v222, v222
    v_exp_f32 v223, v223
    v_exp_f32 v52, v52
    v_exp_f32 v53, v53
    v_smfmac_f32_32x32x32_bf16 v[144:159], v[40:43], v[216:223], v126
    buffer_load_dwordx4 v3, s[24:27], s64 offen offset:1024 lds
    s_addk_i32 s64, 16384
    v_exp_f32 v54, v54
    v_exp_f32 v55, v55
    v_exp_f32 v56, v56
    v_mfma_f32_32x32x16_bf16 v[208:223], v[116:119], v[204:207], 0
    buffer_load_dwordx4 v[116:119], v124, s[16:19], s62 offen sc1
    v_exp_f32 v57, v57
    v_exp_f32 v58, v58
    v_exp_f32 v59, v59
    v_exp_f32 v60, v60
    v_exp_f32 v61, v61
    v_smfmac_f32_32x32x32_bf16 v[160:175], v[36:39], v[52:59], v126
    s_waitcnt vmcnt(9) lgkmcnt(0)
    v_exp_f32 v62, v62
    v_exp_f32 v63, v63
    v_exp_f32 v64, v64
    v_mfma_f32_32x32x16_bf16 v[84:99], v[20:23], v[248:251], v[84:99]
    v_exp_f32 v65, v65
    v_exp_f32 v66, v66
    v_exp_f32 v67, v67
    v_exp_f32 v208, v208
    v_exp_f32 v209, v209
    v_smfmac_f32_32x32x32_bf16 v[160:175], v[40:43], v[60:67], v126
    ds_read_b64_tr_b16 v[16:17], v12 offset:4096
    ds_read_b64_tr_b16 v[18:19], v12 offset:4608
    v_exp_f32 v210, v210
    v_exp_f32 v211, v211
    v_exp_f32 v212, v212
    v_mfma_f32_32x32x16_bf16 v[52:67], v[120:123], v[192:195], 0
    s_add_u32 m0, s56, 69632
    v_exp_f32 v213, v213
    v_exp_f32 v214, v214
    v_exp_f32 v215, v215
    v_exp_f32 v216, v216
    v_exp_f32 v217, v217
    v_smfmac_f32_32x32x32_bf16 v[176:191], v[36:39], v[208:215], v126
    buffer_load_dwordx4 v2, s[28:31], s53 offen lds
    buffer_load_dwordx4 v3, s[28:31], s53 offen offset:1024 lds
    v_exp_f32 v218, v218
    v_exp_f32 v219, v219
    v_exp_f32 v220, v220
    v_mfma_f32_32x32x16_bf16 v[224:239], v[20:23], v[252:255], v[224:239]
    s_addk_i32 s53, 16384
    v_exp_f32 v221, v221
    v_exp_f32 v222, v222
    v_exp_f32 v223, v223
    v_exp_f32 v52, v52
    v_exp_f32 v53, v53
    v_smfmac_f32_32x32x32_bf16 v[176:191], v[40:43], v[216:223], v126
    s_mov_b64 exec, s[66:67]
    buffer_load_dwordx4 v[36:39], v125, s[16:19], s62 offen offset:1024 sc1
    buffer_load_dwordx4 v[40:43], v125, s[16:19], s62 offen offset:1536 sc1
    s_mov_b64 exec, -1
    v_exp_f32 v54, v54
    v_exp_f32 v55, v55
    v_exp_f32 v56, v56
    v_mfma_f32_32x32x16_bf16 v[208:223], v[120:123], v[196:199], 0
    s_waitcnt vmcnt(7) lgkmcnt(0)
    v_exp_f32 v57, v57
    v_exp_f32 v58, v58
    v_exp_f32 v59, v59
    v_exp_f32 v60, v60
    v_exp_f32 v61, v61
    v_smfmac_f32_32x32x32_bf16 v[128:143], v[44:47], v[52:59], v126
    s_addk_i32 s62, 2048
    s_bitset0_b32 s62, 15
    v_exp_f32 v62, v62
    v_exp_f32 v63, v63
    v_exp_f32 v64, v64
    v_mfma_f32_32x32x16_bf16 v[68:83], v[16:19], v[240:243], v[68:83]
    buffer_load_dwordx4 v[248:251], v9, s[20:23], s63 offen sc1
    v_exp_f32 v65, v65
    v_exp_f32 v66, v66
    v_exp_f32 v67, v67
    v_exp_f32 v208, v208
    v_exp_f32 v209, v209
    v_smfmac_f32_32x32x32_bf16 v[128:143], v[48:51], v[60:67], v126
    ds_read_b64_tr_b16 v[20:21], v13 offset:4096
    ds_read_b64_tr_b16 v[22:23], v13 offset:4608
    v_exp_f32 v210, v210
    v_exp_f32 v211, v211
    v_exp_f32 v212, v212
    v_mfma_f32_32x32x16_bf16 v[52:67], v[120:123], v[200:203], 0
    buffer_load_dwordx4 v[252:255], v10, s[20:23], s63 offen sc1
    v_exp_f32 v213, v213
    v_exp_f32 v214, v214
    v_exp_f32 v215, v215
    v_exp_f32 v216, v216
    v_exp_f32 v217, v217
    v_smfmac_f32_32x32x32_bf16 v[144:159], v[44:47], v[208:215], v126
    s_addk_i32 s63, 2048
    s_add_u32 m0, s65, 8192
    v_exp_f32 v218, v218
    v_exp_f32 v219, v219
    v_exp_f32 v220, v220
    v_mfma_f32_32x32x16_bf16 v[100:115], v[16:19], v[244:247], v[100:115]
    buffer_load_dwordx4 v2, s[24:27], s64 offen lds
    v_exp_f32 v221, v221
    v_exp_f32 v222, v222
    v_exp_f32 v223, v223
    v_exp_f32 v52, v52
    v_exp_f32 v53, v53
    v_smfmac_f32_32x32x32_bf16 v[144:159], v[48:51], v[216:223], v126
    buffer_load_dwordx4 v3, s[24:27], s64 offen offset:1024 lds
    s_addk_i32 s64, 16384
    v_exp_f32 v54, v54
    v_exp_f32 v55, v55
    v_exp_f32 v56, v56
    v_mfma_f32_32x32x16_bf16 v[208:223], v[120:123], v[204:207], 0
    buffer_load_dwordx4 v[120:123], v124, s[16:19], s62 offen sc1
    v_exp_f32 v57, v57
    v_exp_f32 v58, v58
    v_exp_f32 v59, v59
    v_exp_f32 v60, v60
    v_exp_f32 v61, v61
    v_smfmac_f32_32x32x32_bf16 v[160:175], v[44:47], v[52:59], v126
    s_waitcnt vmcnt(9) lgkmcnt(0)
    v_exp_f32 v62, v62
    v_exp_f32 v63, v63
    v_exp_f32 v64, v64
    v_mfma_f32_32x32x16_bf16 v[84:99], v[20:23], v[240:243], v[84:99]
    v_exp_f32 v65, v65
    v_exp_f32 v66, v66
    v_exp_f32 v67, v67
    v_exp_f32 v208, v208
    v_exp_f32 v209, v209
    v_smfmac_f32_32x32x32_bf16 v[160:175], v[48:51], v[60:67], v126
    ds_read_b64_tr_b16 v[16:17], v12 offset:6144
    ds_read_b64_tr_b16 v[18:19], v12 offset:6656
    v_exp_f32 v210, v210
    v_exp_f32 v211, v211
    v_exp_f32 v212, v212
    v_mfma_f32_32x32x16_bf16 v[52:67], v[116:119], v[192:195], 0
    s_add_u32 m0, s56, 71680
    v_exp_f32 v213, v213
    v_exp_f32 v214, v214
    v_exp_f32 v215, v215
    v_exp_f32 v216, v216
    v_exp_f32 v217, v217
    v_smfmac_f32_32x32x32_bf16 v[176:191], v[44:47], v[208:215], v126
    buffer_load_dwordx4 v2, s[28:31], s53 offen lds
    buffer_load_dwordx4 v3, s[28:31], s53 offen offset:1024 lds
    v_exp_f32 v218, v218
    v_exp_f32 v219, v219
    v_exp_f32 v220, v220
    v_mfma_f32_32x32x16_bf16 v[224:239], v[20:23], v[244:247], v[224:239]
    s_addk_i32 s53, 16384
    v_exp_f32 v221, v221
    v_exp_f32 v222, v222
    v_exp_f32 v223, v223
    v_exp_f32 v52, v52
    v_exp_f32 v53, v53
    v_smfmac_f32_32x32x32_bf16 v[176:191], v[48:51], v[216:223], v126
    s_mov_b64 exec, s[66:67]
    buffer_load_dwordx4 v[44:47], v125, s[16:19], s62 offen offset:1024 sc1
    buffer_load_dwordx4 v[48:51], v125, s[16:19], s62 offen offset:1536 sc1
    s_mov_b64 exec, -1
    v_exp_f32 v54, v54
    v_exp_f32 v55, v55
    v_exp_f32 v56, v56
    v_mfma_f32_32x32x16_bf16 v[208:223], v[116:119], v[196:199], 0
    s_waitcnt vmcnt(7) lgkmcnt(0)
    v_exp_f32 v57, v57
    v_exp_f32 v58, v58
    v_exp_f32 v59, v59
    v_exp_f32 v60, v60
    v_exp_f32 v61, v61
    v_smfmac_f32_32x32x32_bf16 v[128:143], v[36:39], v[52:59], v126
    s_addk_i32 s62, 2048
    s_bitset0_b32 s62, 15
    v_exp_f32 v62, v62
    v_exp_f32 v63, v63
    v_exp_f32 v64, v64
    v_mfma_f32_32x32x16_bf16 v[68:83], v[16:19], v[248:251], v[68:83]
    buffer_load_dwordx4 v[240:243], v9, s[20:23], s63 offen sc1
    v_exp_f32 v65, v65
    v_exp_f32 v66, v66
    v_exp_f32 v67, v67
    v_exp_f32 v208, v208
    v_exp_f32 v209, v209
    v_smfmac_f32_32x32x32_bf16 v[128:143], v[40:43], v[60:67], v126
    ds_read_b64_tr_b16 v[20:21], v13 offset:6144
    ds_read_b64_tr_b16 v[22:23], v13 offset:6656
    v_exp_f32 v210, v210
    v_exp_f32 v211, v211
    v_exp_f32 v212, v212
    v_mfma_f32_32x32x16_bf16 v[52:67], v[116:119], v[200:203], 0
    buffer_load_dwordx4 v[244:247], v10, s[20:23], s63 offen sc1
    v_exp_f32 v213, v213
    v_exp_f32 v214, v214
    v_exp_f32 v215, v215
    v_exp_f32 v216, v216
    v_exp_f32 v217, v217
    v_smfmac_f32_32x32x32_bf16 v[144:159], v[36:39], v[208:215], v126
    s_addk_i32 s63, 2048
    s_add_u32 m0, s65, 4096
    v_exp_f32 v218, v218
    v_exp_f32 v219, v219
    v_exp_f32 v220, v220
    v_mfma_f32_32x32x16_bf16 v[100:115], v[16:19], v[252:255], v[100:115]
    buffer_load_dwordx4 v2, s[24:27], s64 offen lds
    v_exp_f32 v221, v221
    v_exp_f32 v222, v222
    v_exp_f32 v223, v223
    v_exp_f32 v52, v52
    v_exp_f32 v53, v53
    v_smfmac_f32_32x32x32_bf16 v[144:159], v[40:43], v[216:223], v126
    buffer_load_dwordx4 v3, s[24:27], s64 offen offset:1024 lds
    s_addk_i32 s64, 16384
    v_exp_f32 v54, v54
    v_exp_f32 v55, v55
    v_exp_f32 v56, v56
    v_mfma_f32_32x32x16_bf16 v[208:223], v[116:119], v[204:207], 0
    buffer_load_dwordx4 v[116:119], v124, s[16:19], s62 offen sc1
    v_exp_f32 v57, v57
    v_exp_f32 v58, v58
    v_exp_f32 v59, v59
    v_exp_f32 v60, v60
    v_exp_f32 v61, v61
    v_smfmac_f32_32x32x32_bf16 v[160:175], v[36:39], v[52:59], v126
    s_waitcnt vmcnt(9) lgkmcnt(0)
    v_exp_f32 v62, v62
    v_exp_f32 v63, v63
    v_exp_f32 v64, v64
    v_mfma_f32_32x32x16_bf16 v[84:99], v[20:23], v[248:251], v[84:99]
    v_exp_f32 v65, v65
    v_exp_f32 v66, v66
    v_exp_f32 v67, v67
    v_exp_f32 v208, v208
    v_exp_f32 v209, v209
    v_smfmac_f32_32x32x32_bf16 v[160:175], v[40:43], v[60:67], v126
    ds_read_b64_tr_b16 v[16:17], v12 offset:8192
    ds_read_b64_tr_b16 v[18:19], v12 offset:8704
    v_exp_f32 v210, v210
    v_exp_f32 v211, v211
    v_exp_f32 v212, v212
    v_mfma_f32_32x32x16_bf16 v[52:67], v[120:123], v[192:195], 0
    v_exp_f32 v213, v213
    v_exp_f32 v214, v214
    v_exp_f32 v215, v215
    v_exp_f32 v216, v216
    v_exp_f32 v217, v217
    v_smfmac_f32_32x32x32_bf16 v[176:191], v[36:39], v[208:215], v126
    v_exp_f32 v218, v218
    v_exp_f32 v219, v219
    v_exp_f32 v220, v220
    v_mfma_f32_32x32x16_bf16 v[224:239], v[20:23], v[252:255], v[224:239]
    v_exp_f32 v221, v221
    v_exp_f32 v222, v222
    v_exp_f32 v223, v223
    v_exp_f32 v52, v52
    v_exp_f32 v53, v53
    v_smfmac_f32_32x32x32_bf16 v[176:191], v[40:43], v[216:223], v126
    s_mov_b64 exec, s[66:67]
    buffer_load_dwordx4 v[36:39], v125, s[16:19], s62 offen offset:1024 sc1
    buffer_load_dwordx4 v[40:43], v125, s[16:19], s62 offen offset:1536 sc1
    s_mov_b64 exec, -1
    v_exp_f32 v54, v54
    v_exp_f32 v55, v55
    v_exp_f32 v56, v56
    v_mfma_f32_32x32x16_bf16 v[208:223], v[120:123], v[196:199], 0
    s_waitcnt vmcnt(5) lgkmcnt(0)
    v_exp_f32 v57, v57
    v_exp_f32 v58, v58
    v_exp_f32 v59, v59
    v_exp_f32 v60, v60
    v_exp_f32 v61, v61
    v_smfmac_f32_32x32x32_bf16 v[128:143], v[44:47], v[52:59], v126
    s_addk_i32 s62, 2048
    s_bitset0_b32 s62, 15
    s_setprio 1
    v_exp_f32 v62, v62
    v_exp_f32 v63, v63
    v_exp_f32 v64, v64
    v_mfma_f32_32x32x16_bf16 v[68:83], v[16:19], v[240:243], v[68:83]
    buffer_load_dwordx4 v[248:251], v9, s[20:23], s63 offen sc1
    v_exp_f32 v65, v65
    v_exp_f32 v66, v66
    v_exp_f32 v67, v67
    v_exp_f32 v208, v208
    v_exp_f32 v209, v209
    v_smfmac_f32_32x32x32_bf16 v[128:143], v[48:51], v[60:67], v126
    ds_read_b64_tr_b16 v[20:21], v13 offset:8192
    ds_read_b64_tr_b16 v[22:23], v13 offset:8704
    v_exp_f32 v210, v210
    v_exp_f32 v211, v211
    v_exp_f32 v212, v212
    v_mfma_f32_32x32x16_bf16 v[52:67], v[120:123], v[200:203], 0
    buffer_load_dwordx4 v[252:255], v10, s[20:23], s63 offen sc1
    v_exp_f32 v213, v213
    v_exp_f32 v214, v214
    v_exp_f32 v215, v215
    v_exp_f32 v216, v216
    v_exp_f32 v217, v217
    v_smfmac_f32_32x32x32_bf16 v[144:159], v[44:47], v[208:215], v126
    s_addk_i32 s63, 2048
    s_add_u32 m0, s65, 6144
    v_exp_f32 v218, v218
    v_exp_f32 v219, v219
    v_exp_f32 v220, v220
    v_mfma_f32_32x32x16_bf16 v[100:115], v[16:19], v[244:247], v[100:115]
    buffer_load_dwordx4 v2, s[24:27], s64 offen lds
    v_exp_f32 v221, v221
    v_exp_f32 v222, v222
    v_exp_f32 v223, v223
    v_exp_f32 v52, v52
    v_exp_f32 v53, v53
    v_smfmac_f32_32x32x32_bf16 v[144:159], v[48:51], v[216:223], v126
    buffer_load_dwordx4 v3, s[24:27], s64 offen offset:1024 lds
    s_addk_i32 s64, 16384
    v_exp_f32 v54, v54
    v_exp_f32 v55, v55
    v_exp_f32 v56, v56
    v_mfma_f32_32x32x16_bf16 v[208:223], v[120:123], v[204:207], 0
    buffer_load_dwordx4 v[120:123], v124, s[16:19], s62 offen sc1
    v_exp_f32 v57, v57
    v_exp_f32 v58, v58
    v_exp_f32 v59, v59
    v_exp_f32 v60, v60
    v_exp_f32 v61, v61
    v_smfmac_f32_32x32x32_bf16 v[160:175], v[44:47], v[52:59], v126
    s_waitcnt vmcnt(7) lgkmcnt(0)
    v_exp_f32 v62, v62
    v_exp_f32 v63, v63
    v_exp_f32 v64, v64
    v_mfma_f32_32x32x16_bf16 v[84:99], v[20:23], v[240:243], v[84:99]
    v_exp_f32 v65, v65
    v_exp_f32 v66, v66
    v_exp_f32 v67, v67
    v_exp_f32 v208, v208
    v_exp_f32 v209, v209
    v_smfmac_f32_32x32x32_bf16 v[160:175], v[48:51], v[60:67], v126
    ds_read_b64_tr_b16 v[16:17], v12 offset:4096
    ds_read_b64_tr_b16 v[18:19], v12 offset:4608
    v_exp_f32 v210, v210
    v_exp_f32 v211, v211
    v_exp_f32 v212, v212
    v_mfma_f32_32x32x16_bf16 v[52:67], v[116:119], v[192:195], 0
    v_exp_f32 v213, v213
    v_exp_f32 v214, v214
    v_exp_f32 v215, v215
    v_exp_f32 v216, v216
    v_exp_f32 v217, v217
    v_smfmac_f32_32x32x32_bf16 v[176:191], v[44:47], v[208:215], v126
    v_exp_f32 v218, v218
    v_exp_f32 v219, v219
    v_exp_f32 v220, v220
    v_mfma_f32_32x32x16_bf16 v[224:239], v[20:23], v[244:247], v[224:239]
    v_exp_f32 v221, v221
    v_exp_f32 v222, v222
    v_exp_f32 v223, v223
    v_exp_f32 v52, v52
    v_exp_f32 v53, v53
    v_smfmac_f32_32x32x32_bf16 v[176:191], v[48:51], v[216:223], v126
    s_mov_b64 exec, s[66:67]
    buffer_load_dwordx4 v[44:47], v125, s[16:19], s62 offen offset:1024 sc1
    buffer_load_dwordx4 v[48:51], v125, s[16:19], s62 offen offset:1536 sc1
    s_mov_b64 exec, -1
    v_exp_f32 v54, v54
    v_exp_f32 v55, v55
    v_exp_f32 v56, v56
    v_mfma_f32_32x32x16_bf16 v[208:223], v[116:119], v[196:199], 0
    s_waitcnt vmcnt(5) lgkmcnt(0)
    v_exp_f32 v57, v57
    v_exp_f32 v58, v58
    v_exp_f32 v59, v59
    v_exp_f32 v60, v60
    v_exp_f32 v61, v61
    v_smfmac_f32_32x32x32_bf16 v[128:143], v[36:39], v[52:59], v126
    s_addk_i32 s62, 2048
    s_bitset0_b32 s62, 15
    v_exp_f32 v62, v62
    v_exp_f32 v63, v63
    v_exp_f32 v64, v64
    v_mfma_f32_32x32x16_bf16 v[68:83], v[16:19], v[248:251], v[68:83]
    buffer_load_dwordx4 v[240:243], v9, s[20:23], s63 offen sc1
    v_exp_f32 v65, v65
    v_exp_f32 v66, v66
    v_exp_f32 v67, v67
    v_exp_f32 v208, v208
    v_exp_f32 v209, v209
    v_smfmac_f32_32x32x32_bf16 v[128:143], v[40:43], v[60:67], v126
    ds_read_b64_tr_b16 v[20:21], v13 offset:4096
    ds_read_b64_tr_b16 v[22:23], v13 offset:4608
    v_exp_f32 v210, v210
    v_exp_f32 v211, v211
    v_exp_f32 v212, v212
    v_mfma_f32_32x32x16_bf16 v[52:67], v[116:119], v[200:203], 0
    buffer_load_dwordx4 v[244:247], v10, s[20:23], s63 offen sc1
    v_exp_f32 v213, v213
    v_exp_f32 v214, v214
    v_exp_f32 v215, v215
    v_exp_f32 v216, v216
    v_exp_f32 v217, v217
    v_smfmac_f32_32x32x32_bf16 v[144:159], v[36:39], v[208:215], v126
    s_addk_i32 s63, 2048
    v_exp_f32 v218, v218
    v_exp_f32 v219, v219
    v_exp_f32 v220, v220
    v_mfma_f32_32x32x16_bf16 v[100:115], v[16:19], v[252:255], v[100:115]
    v_exp_f32 v221, v221
    v_exp_f32 v222, v222
    v_exp_f32 v223, v223
    v_exp_f32 v52, v52
    v_exp_f32 v53, v53
    v_smfmac_f32_32x32x32_bf16 v[144:159], v[40:43], v[216:223], v126
    v_exp_f32 v54, v54
    v_exp_f32 v55, v55
    v_exp_f32 v56, v56
    v_mfma_f32_32x32x16_bf16 v[208:223], v[116:119], v[204:207], 0
    v_exp_f32 v57, v57
    v_exp_f32 v58, v58
    v_exp_f32 v59, v59
    v_exp_f32 v60, v60
    v_exp_f32 v61, v61
    v_smfmac_f32_32x32x32_bf16 v[160:175], v[36:39], v[52:59], v126
    s_waitcnt vmcnt(4) lgkmcnt(0)
    v_exp_f32 v62, v62
    v_exp_f32 v63, v63
    v_exp_f32 v64, v64
    v_mfma_f32_32x32x16_bf16 v[84:99], v[20:23], v[248:251], v[84:99]
    v_exp_f32 v65, v65
    v_exp_f32 v66, v66
    v_exp_f32 v67, v67
    v_exp_f32 v208, v208
    v_exp_f32 v209, v209
    v_smfmac_f32_32x32x32_bf16 v[160:175], v[40:43], v[60:67], v126
    ds_read_b64_tr_b16 v[16:17], v12 offset:6144
    ds_read_b64_tr_b16 v[18:19], v12 offset:6656
    v_exp_f32 v210, v210
    v_exp_f32 v211, v211
    v_exp_f32 v212, v212
    v_mfma_f32_32x32x16_bf16 v[52:67], v[120:123], v[192:195], 0
    v_exp_f32 v213, v213
    v_exp_f32 v214, v214
    v_exp_f32 v215, v215
    v_exp_f32 v216, v216
    v_exp_f32 v217, v217
    v_smfmac_f32_32x32x32_bf16 v[176:191], v[36:39], v[208:215], v126
    v_exp_f32 v218, v218
    v_exp_f32 v219, v219
    v_exp_f32 v220, v220
    v_mfma_f32_32x32x16_bf16 v[224:239], v[20:23], v[252:255], v[224:239]
    v_exp_f32 v221, v221
    v_exp_f32 v222, v222
    v_exp_f32 v223, v223
    v_exp_f32 v52, v52
    v_exp_f32 v53, v53
    v_smfmac_f32_32x32x32_bf16 v[176:191], v[40:43], v[216:223], v126
    v_exp_f32 v54, v54
    v_exp_f32 v55, v55
    v_exp_f32 v56, v56
    v_mfma_f32_32x32x16_bf16 v[208:223], v[120:123], v[196:199], 0
    s_waitcnt vmcnt(0) lgkmcnt(0)
    v_exp_f32 v57, v57
    v_exp_f32 v58, v58
    v_exp_f32 v59, v59
    v_exp_f32 v60, v60
    v_exp_f32 v61, v61
    v_smfmac_f32_32x32x32_bf16 v[128:143], v[44:47], v[52:59], v126
    v_exp_f32 v62, v62
    v_exp_f32 v63, v63
    v_exp_f32 v64, v64
    v_mfma_f32_32x32x16_bf16 v[68:83], v[16:19], v[240:243], v[68:83]
    v_exp_f32 v65, v65
    v_exp_f32 v66, v66
    v_exp_f32 v67, v67
    v_exp_f32 v208, v208
    v_exp_f32 v209, v209
    v_smfmac_f32_32x32x32_bf16 v[128:143], v[48:51], v[60:67], v126
    ds_read_b64_tr_b16 v[20:21], v13 offset:6144
    ds_read_b64_tr_b16 v[22:23], v13 offset:6656
    v_exp_f32 v210, v210
    v_exp_f32 v211, v211
    v_exp_f32 v212, v212
    v_mfma_f32_32x32x16_bf16 v[52:67], v[120:123], v[200:203], 0
    v_exp_f32 v213, v213
    v_exp_f32 v214, v214
    v_exp_f32 v215, v215
    v_exp_f32 v216, v216
    v_exp_f32 v217, v217
    v_smfmac_f32_32x32x32_bf16 v[144:159], v[44:47], v[208:215], v126
    v_exp_f32 v218, v218
    v_exp_f32 v219, v219
    v_exp_f32 v220, v220
    v_mfma_f32_32x32x16_bf16 v[100:115], v[16:19], v[244:247], v[100:115]
    ds_write_b128 v7, v[128:131] offset:4096
    v_exp_f32 v221, v221
    v_exp_f32 v222, v222
    v_exp_f32 v223, v223
    v_exp_f32 v52, v52
    v_exp_f32 v53, v53
    v_smfmac_f32_32x32x32_bf16 v[144:159], v[48:51], v[216:223], v126
    ds_write_b128 v7, v[132:135] offset:5120
    ds_write_b32 v8, v136 offset:6144
    v_exp_f32 v54, v54
    v_exp_f32 v55, v55
    v_exp_f32 v56, v56
    v_mfma_f32_32x32x16_bf16 v[208:223], v[120:123], v[204:207], 0
    v_exp_f32 v57, v57
    v_exp_f32 v58, v58
    v_exp_f32 v59, v59
    v_exp_f32 v60, v60
    v_exp_f32 v61, v61
    v_smfmac_f32_32x32x32_bf16 v[160:175], v[44:47], v[52:59], v126
    s_waitcnt lgkmcnt(3)
    v_exp_f32 v62, v62
    v_exp_f32 v63, v63
    v_exp_f32 v64, v64
    v_mfma_f32_32x32x16_bf16 v[84:99], v[20:23], v[240:243], v[84:99]
    ds_write_b128 v7, v[144:147] offset:6400
    v_exp_f32 v65, v65
    v_exp_f32 v66, v66
    v_exp_f32 v67, v67
    v_exp_f32 v208, v208
    v_exp_f32 v209, v209
    v_smfmac_f32_32x32x32_bf16 v[160:175], v[48:51], v[60:67], v126
    ds_write_b128 v7, v[148:151] offset:7424
    ds_write_b32 v8, v152 offset:8448
    v_exp_f32 v210, v210
    v_exp_f32 v211, v211
    v_exp_f32 v212, v212
    v_exp_f32 v213, v213
    v_exp_f32 v214, v214
    v_exp_f32 v215, v215
    v_exp_f32 v216, v216
    v_exp_f32 v217, v217
    v_smfmac_f32_32x32x32_bf16 v[176:191], v[44:47], v[208:215], v126
    v_exp_f32 v218, v218
    v_exp_f32 v219, v219
    v_exp_f32 v220, v220
    v_mfma_f32_32x32x16_bf16 v[224:239], v[20:23], v[244:247], v[224:239]
    ds_write_b128 v7, v[160:163] offset:8704
    v_exp_f32 v221, v221
    v_exp_f32 v222, v222
    v_exp_f32 v223, v223
    ds_write_b128 v7, v[164:167] offset:9728
    ds_write_b32 v8, v168 offset:10752
    v_smfmac_f32_32x32x32_bf16 v[176:191], v[48:51], v[216:223], v126
    s_cmp_lg_u32 s46, 0
    s_setprio 3
    s_waitcnt lgkmcnt(0)
    s_cbranch_scc1 Ltail1
    s_barrier
    ds_read_b32 v152, v29 offset:6144
    ds_read_b32 v153, v30 offset:8448
    ds_read_b32 v154, v31 offset:10752
    ds_read_b128 v[128:131], v26 offset:4096
    ds_read_b128 v[132:135], v26 offset:5120
    ds_read_b128 v[136:139], v27 offset:6400
    ds_read_b128 v[140:143], v27 offset:7424
    ds_read_b128 v[144:147], v28 offset:8704
    ds_read_b128 v[148:151], v28 offset:9728
    buffer_load_dwordx4 v[240:243], v1, s[16:19], s4 offen offset:1024 sc1
    buffer_load_dwordx4 v[244:247], v1, s[16:19], s4 offen offset:3072 sc1
    buffer_load_dwordx4 v[248:251], v1, s[16:19], s5 offen offset:1024 sc1
    buffer_load_dwordx4 v[252:255], v1, s[16:19], s5 offen offset:3072 sc1
    s_waitcnt lgkmcnt(6)
    v_add_f32 v152, v152, v153
    v_add_f32 v184, v184, v154
    v_add_f32 v184, v184, v152
    v_subrev_u32 v152, 562036736, v184
    v_cmp_lt_u32 vcc, 1006632960, v152
    v_fma_f32 v156, v184, v24, v184
    v_rcp_f32 v156, v156
    s_waitcnt lgkmcnt(4)
    v_pk_add_f32 v[176:177], v[176:177], v[128:129]
    v_pk_add_f32 v[178:179], v[178:179], v[130:131]
    v_pk_add_f32 v[180:181], v[180:181], v[132:133]
    v_pk_add_f32 v[182:183], v[182:183], v[134:135]
    s_waitcnt lgkmcnt(2)
    v_pk_add_f32 v[176:177], v[176:177], v[136:137]
    v_pk_add_f32 v[178:179], v[178:179], v[138:139]
    v_pk_add_f32 v[180:181], v[180:181], v[140:141]
    v_pk_add_f32 v[182:183], v[182:183], v[142:143]
    s_waitcnt lgkmcnt(0)
    v_pk_add_f32 v[176:177], v[176:177], v[144:145]
    v_pk_add_f32 v[178:179], v[178:179], v[146:147]
    v_pk_add_f32 v[180:181], v[180:181], v[148:149]
    v_pk_add_f32 v[182:183], v[182:183], v[150:151]
    s_cbranch_vccnz Lsafe
Lsafe_done0:
    v_mul_f32 v176, v176, v156
    v_mul_f32 v177, v177, v156
    v_mul_f32 v178, v178, v156
    v_mul_f32 v179, v179, v156
    v_mul_f32 v180, v180, v156
    v_mul_f32 v181, v181, v156
    v_mul_f32 v182, v182, v156
    v_mul_f32 v183, v183, v156
    v_cvt_pk_bf16_f32 v116, v176, v177
    v_cvt_pk_bf16_f32 v117, v178, v179
    v_cvt_pk_bf16_f32 v118, v180, v181
    v_cvt_pk_bf16_f32 v119, v182, v183
    v_min_u32 v116, -2, v116
    v_min_u32 v117, -2, v117
    v_min_u32 v118, -2, v118
    v_min_u32 v119, -2, v119
    buffer_store_dwordx4 v[116:119], v1, s[16:19], s85 offen sc1
    s_lshr_b32 s69, s44, 1
    s_lshl_b32 s70, s69, 14
    s_mul_i32 s71, s44, 7168
    s_sub_u32 s70, s70, s71
    s_add_u32 s70, s70, 65536
    v_and_b32 v15, 32, v0
    v_lshlrev_b32 v15, 4, v15
    v_sub_u32 v15, s70, v15
    v_add_u32 v12, v15, v12
    v_add_u32 v13, v15, v13
    ds_read_b64_tr_b16 v[128:129], v12 offset:2048
    ds_read_b64_tr_b16 v[130:131], v12 offset:3072
    ds_read_b64_tr_b16 v[132:133], v13 offset:2048
    ds_read_b64_tr_b16 v[134:135], v13 offset:3072
    ds_read_b64_tr_b16 v[136:137], v12 offset:6144
    ds_read_b64_tr_b16 v[138:139], v12 offset:7168
    ds_read_b64_tr_b16 v[140:141], v13 offset:6144
    ds_read_b64_tr_b16 v[142:143], v13 offset:7168
    ds_read_b64_tr_b16 v[144:145], v12 offset:10240
    ds_read_b64_tr_b16 v[146:147], v12 offset:11264
    ds_read_b64_tr_b16 v[148:149], v13 offset:10240
    ds_read_b64_tr_b16 v[150:151], v13 offset:11264
    ds_read_b64_tr_b16 v[152:153], v12 offset:14336
    ds_read_b64_tr_b16 v[154:155], v12 offset:15360
    ds_read_b64_tr_b16 v[156:157], v13 offset:14336
    ds_read_b64_tr_b16 v[158:159], v13 offset:15360
    v_and_b32 v20, 31, v0
    v_lshrrev_b32 v122, 5, v0
    v_and_b32 v123, 7, v0
    v_xor_b32 v122, v122, v123
    v_lshlrev_b32 v122, 4, v122
    v_lshl_add_u32 v20, v20, 8, v122
    s_lshl_b32 s68, s45, 13
    s_add_u32 s68, s68, 0
    v_add_u32 v20, s68, v20
    v_xor_b32 v21, 32, v20
    v_xor_b32 v22, 64, v20
    v_xor_b32 v23, 96, v20
    s_barrier
    s_waitcnt lgkmcnt(8)
    s_waitcnt vmcnt(3)
    v_max3_u32 v14, v240, v241, v242
    v_max3_u32 v15, v243, v244, v245
    v_max3_u32 v14, v14, v246, v247
    v_max_u32 v14, v14, v15
    v_cmp_eq_u32 vcc, -1, v14
    s_cbranch_vccnz Lo0r_26
Lo0c_27:
    v_mfma_f32_32x32x16_bf16 v[68:83], v[128:131], v[240:243], v[68:83]
    ds_write_b128 v20, v[100:103] offset:0
    v_mfma_f32_32x32x16_bf16 v[68:83], v[136:139], v[244:247], v[68:83]
    ds_write_b128 v21, v[104:107] offset:0
    ds_read_b64_tr_b16 v[160:161], v12 offset:0
    ds_read_b64_tr_b16 v[162:163], v12 offset:1024
    ds_read_b64_tr_b16 v[164:165], v13 offset:0
    ds_read_b64_tr_b16 v[166:167], v13 offset:1024
    v_mfma_f32_32x32x16_bf16 v[84:99], v[132:135], v[240:243], v[84:99]
    ds_write_b128 v22, v[108:111] offset:0
    v_mfma_f32_32x32x16_bf16 v[84:99], v[140:143], v[244:247], v[84:99]
    ds_write_b128 v23, v[112:115] offset:0
    ds_read_b64_tr_b16 v[168:169], v12 offset:4096
    ds_read_b64_tr_b16 v[170:171], v12 offset:5120
    ds_read_b64_tr_b16 v[172:173], v13 offset:4096
    ds_read_b64_tr_b16 v[174:175], v13 offset:5120
    s_waitcnt lgkmcnt(12)
    s_waitcnt vmcnt(1)
    v_max3_u32 v14, v248, v249, v250
    v_max3_u32 v15, v251, v252, v253
    v_max3_u32 v14, v14, v254, v255
    v_max_u32 v14, v14, v15
    v_cmp_eq_u32 vcc, -1, v14
    s_cbranch_vccnz Lo1r_28
Lo1c_29:
    v_mfma_f32_32x32x16_bf16 v[68:83], v[144:147], v[248:251], v[68:83]
    ds_write_b128 v20, v[224:227] offset:128
    v_mfma_f32_32x32x16_bf16 v[68:83], v[152:155], v[252:255], v[68:83]
    ds_write_b128 v21, v[228:231] offset:128
    ds_read_b64_tr_b16 v[176:177], v12 offset:8192
    ds_read_b64_tr_b16 v[178:179], v12 offset:9216
    ds_read_b64_tr_b16 v[180:181], v13 offset:8192
    ds_read_b64_tr_b16 v[182:183], v13 offset:9216
    v_mfma_f32_32x32x16_bf16 v[84:99], v[148:151], v[248:251], v[84:99]
    ds_write_b128 v22, v[232:235] offset:128
    v_mfma_f32_32x32x16_bf16 v[84:99], v[156:159], v[252:255], v[84:99]
    ds_write_b128 v23, v[236:239] offset:128
    ds_read_b64_tr_b16 v[184:185], v12 offset:12288
    ds_read_b64_tr_b16 v[186:187], v12 offset:13312
    ds_read_b64_tr_b16 v[188:189], v13 offset:12288
    ds_read_b64_tr_b16 v[190:191], v13 offset:13312
    buffer_load_dwordx4 v[52:55], v1, s[16:19], s4 offen offset:0 sc1
    buffer_load_dwordx4 v[56:59], v1, s[16:19], s4 offen offset:2048 sc1
    buffer_load_dwordx4 v[60:63], v1, s[16:19], s5 offen offset:0 sc1
    buffer_load_dwordx4 v[64:67], v1, s[16:19], s5 offen offset:2048 sc1
    v_lshrrev_b32 v122, 3, v0
    v_lshlrev_b32 v25, 4, v123
    v_lshl_add_u32 v25, v122, 10, v25
    v_lshlrev_b32 v123, 1, v123
    v_xor_b32 v123, v123, v122
    v_lshlrev_b32 v123, 4, v123
    v_lshl_add_u32 v123, v122, 8, v123
    s_and_b32 s70, s44, 1
    s_lshl_b32 s70, s70, 2
    s_add_u32 s70, s70, s69
    s_lshl_b32 s71, s70, 11
    v_add_u32 v120, s71, v123
    v_xor_b32 v121, 16, v120
    v_xor_b32 v26, 139264, v120
    v_xor_b32 v27, 139264, v121
    ds_read_b128 v[192:195], v26 offset:0
    ds_read_b128 v[196:199], v27 offset:0
    ds_read_b128 v[200:203], v26 offset:16384
    ds_read_b128 v[204:207], v27 offset:16384
    v_xor_b32 v28, 8192, v120
    v_add_u32 v30, 98304, v120
    v_xor_b32 v29, 8192, v121
    v_add_u32 v31, 98304, v121
    s_lshl_b32 s68, s49, 3
    s_add_u32 s68, s68, s70
    s_lshl_b32 s68, s68, 13
    s_lshl_b32 s69, s50, 7
    s_add_u32 s68, s68, s69
    s_waitcnt lgkmcnt(15)
    s_waitcnt vmcnt(2)
    v_max3_u32 v14, v52, v53, v54
    v_max3_u32 v15, v55, v56, v57
    v_max3_u32 v14, v14, v58, v59
    v_max_u32 v14, v14, v15
    v_cmp_eq_u32 vcc, -1, v14
    s_cbranch_vccnz Lo2r_30
Lo2c_31:
    v_mfma_f32_32x32x16_bf16 v[68:83], v[160:163], v[52:55], v[68:83]
    v_mfma_f32_32x32x16_bf16 v[68:83], v[168:171], v[56:59], v[68:83]
    v_mfma_f32_32x32x16_bf16 v[84:99], v[164:167], v[52:55], v[84:99]
    v_mfma_f32_32x32x16_bf16 v[84:99], v[172:175], v[56:59], v[84:99]
    s_waitcnt lgkmcnt(4)
    s_waitcnt vmcnt(0)
    v_max3_u32 v14, v60, v61, v62
    v_max3_u32 v15, v63, v64, v65
    v_max3_u32 v14, v14, v66, v67
    v_max_u32 v14, v14, v15
    v_cmp_eq_u32 vcc, -1, v14
    s_cbranch_vccnz Lo3r_32
Lo3c_33:
    v_mfma_f32_32x32x16_bf16 v[68:83], v[176:179], v[60:63], v[68:83]
    s_waitcnt lgkmcnt(0)
    v_add_f32 v192, v192, v200
    v_add_f32 v193, v193, v201
    v_mfma_f32_32x32x16_bf16 v[68:83], v[184:187], v[64:67], v[68:83]
    v_add_f32 v194, v194, v202
    v_add_f32 v195, v195, v203
    v_mfma_f32_32x32x16_bf16 v[84:99], v[180:183], v[60:63], v[84:99]
    v_add_f32 v196, v196, v204
    v_add_f32 v197, v197, v205
    v_mfma_f32_32x32x16_bf16 v[84:99], v[188:191], v[64:67], v[84:99]
    v_add_f32 v198, v198, v206
    v_add_f32 v199, v199, v207
    s_nop 3
    ds_write_b128 v20, v[68:71] offset:32768
    ds_write_b128 v21, v[72:75] offset:32768
    ds_write_b128 v22, v[76:79] offset:32768
    ds_write_b128 v23, v[80:83] offset:32768
    s_nop 1
    ds_write_b128 v20, v[84:87] offset:32896
    ds_write_b128 v21, v[88:91] offset:32896
    ds_write_b128 v22, v[92:95] offset:32896
    ds_write_b128 v23, v[96:99] offset:32896
    s_waitcnt lgkmcnt(0)
Ltail2:
    s_barrier
    ds_read_b128 v[128:131], v28 offset:0
    ds_read_b128 v[132:135], v29 offset:0
    ds_read_b128 v[136:139], v28 offset:16384
    ds_read_b128 v[140:143], v29 offset:16384
    ds_read_b128 v[144:147], v30 offset:0
    ds_read_b128 v[148:151], v31 offset:0
    ds_read_b128 v[152:155], v30 offset:16384
    ds_read_b128 v[156:159], v31 offset:16384
    ds_read_b128 v[160:163], v120 offset:32768
    ds_read_b128 v[164:167], v121 offset:32768
    ds_read_b128 v[168:171], v120 offset:49152
    ds_read_b128 v[172:175], v121 offset:49152
    s_waitcnt lgkmcnt(10)
    v_pk_add_f32 v[192:193], v[192:193], v[128:129]
    v_pk_add_f32 v[194:195], v[194:195], v[130:131]
    v_pk_add_f32 v[196:197], v[196:197], v[132:133]
    v_pk_add_f32 v[198:199], v[198:199], v[134:135]
    s_waitcnt lgkmcnt(8)
    v_pk_add_f32 v[192:193], v[192:193], v[136:137]
    v_pk_add_f32 v[194:195], v[194:195], v[138:139]
    v_pk_add_f32 v[196:197], v[196:197], v[140:141]
    v_pk_add_f32 v[198:199], v[198:199], v[142:143]
    s_waitcnt lgkmcnt(6)
    v_pk_add_f32 v[192:193], v[192:193], v[144:145]
    v_pk_add_f32 v[194:195], v[194:195], v[146:147]
    v_pk_add_f32 v[196:197], v[196:197], v[148:149]
    v_pk_add_f32 v[198:199], v[198:199], v[150:151]
    s_waitcnt lgkmcnt(4)
    v_pk_add_f32 v[192:193], v[192:193], v[152:153]
    v_pk_add_f32 v[194:195], v[194:195], v[154:155]
    v_pk_add_f32 v[196:197], v[196:197], v[156:157]
    v_pk_add_f32 v[198:199], v[198:199], v[158:159]
    s_waitcnt lgkmcnt(2)
    v_pk_add_f32 v[192:193], v[192:193], v[160:161]
    v_pk_add_f32 v[194:195], v[194:195], v[162:163]
    v_pk_add_f32 v[196:197], v[196:197], v[164:165]
    v_pk_add_f32 v[198:199], v[198:199], v[166:167]
    s_waitcnt lgkmcnt(0)
    v_pk_add_f32 v[192:193], v[192:193], v[168:169]
    v_pk_add_f32 v[194:195], v[194:195], v[170:171]
    v_pk_add_f32 v[196:197], v[196:197], v[172:173]
    v_pk_add_f32 v[198:199], v[198:199], v[174:175]
    v_cvt_pk_bf16_f32 v128, v192, v193
    v_cvt_pk_bf16_f32 v129, v194, v195
    v_cvt_pk_bf16_f32 v130, v196, v197
    v_cvt_pk_bf16_f32 v131, v198, v199
    buffer_store_dwordx4 v[128:131], v25, s[32:35], s68 offen sc1
Lexit:
    s_endpgm
Ltail1:
    v_mov_b32 v6, 2048
    v_mov_b32 v14, 1
    s_mov_b64 exec, 1
    ds_add_u32 v6, v14 offset:4
    s_mov_b64 exec, -1
    ds_read_b64 v[14:15], v6
    s_waitcnt lgkmcnt(0)
    v_add_u32 v14, v14, v15
    v_cmp_ne_u32 vcc, 12, v14
    s_cbranch_vccnz Lg1r_34
Lg1c_35:
    ds_read_b32 v152, v29 offset:6144
    ds_read_b32 v153, v30 offset:8448
    ds_read_b32 v154, v31 offset:10752
    ds_read_b128 v[128:131], v26 offset:4096
    ds_read_b128 v[132:135], v26 offset:5120
    ds_read_b128 v[136:139], v27 offset:6400
    ds_read_b128 v[140:143], v27 offset:7424
    ds_read_b128 v[144:147], v28 offset:8704
    ds_read_b128 v[148:151], v28 offset:9728
    s_waitcnt lgkmcnt(6)
    v_add_f32 v152, v152, v153
    v_add_f32 v184, v184, v154
    v_add_f32 v184, v184, v152
    v_subrev_u32 v152, 562036736, v184
    v_cmp_lt_u32 vcc, 1006632960, v152
    v_fma_f32 v156, v184, v24, v184
    v_rcp_f32 v156, v156
    s_waitcnt lgkmcnt(4)
    v_add_f32 v176, v176, v128
    v_add_f32 v177, v177, v129
    v_add_f32 v178, v178, v130
    v_add_f32 v179, v179, v131
    v_add_f32 v180, v180, v132
    v_add_f32 v181, v181, v133
    v_add_f32 v182, v182, v134
    v_add_f32 v183, v183, v135
    s_waitcnt lgkmcnt(2)
    v_add_f32 v176, v176, v136
    v_add_f32 v177, v177, v137
    v_add_f32 v178, v178, v138
    v_add_f32 v179, v179, v139
    v_add_f32 v180, v180, v140
    v_add_f32 v181, v181, v141
    v_add_f32 v182, v182, v142
    v_add_f32 v183, v183, v143
    s_waitcnt lgkmcnt(0)
    v_add_f32 v176, v176, v144
    v_add_f32 v177, v177, v145
    v_add_f32 v178, v178, v146
    v_add_f32 v179, v179, v147
    v_add_f32 v180, v180, v148
    v_add_f32 v181, v181, v149
    v_add_f32 v182, v182, v150
    v_add_f32 v183, v183, v151
    s_cbranch_vccnz Lsafe
Lsafe_done1:
    v_mul_f32 v176, v176, v156
    v_mul_f32 v177, v177, v156
    v_mul_f32 v178, v178, v156
    v_mul_f32 v179, v179, v156
    v_mul_f32 v180, v180, v156
    v_mul_f32 v181, v181, v156
    v_mul_f32 v182, v182, v156
    v_mul_f32 v183, v183, v156
    v_cvt_pk_bf16_f32 v116, v176, v177
    v_cvt_pk_bf16_f32 v117, v178, v179
    v_cvt_pk_bf16_f32 v118, v180, v181
    v_cvt_pk_bf16_f32 v119, v182, v183
    v_min_u32 v116, -2, v116
    v_min_u32 v117, -2, v117
    v_min_u32 v118, -2, v118
    v_min_u32 v119, -2, v119
    buffer_store_dwordx4 v[116:119], v1, s[16:19], s85 offen sc1
    s_lshr_b32 s69, s44, 1
    s_lshl_b32 s70, s69, 14
    s_mul_i32 s71, s44, 7168
    s_sub_u32 s70, s70, s71
    s_add_u32 s70, s70, 65536
    v_and_b32 v15, 32, v0
    v_lshlrev_b32 v15, 4, v15
    v_sub_u32 v15, s70, v15
    v_add_u32 v12, v15, v12
    v_add_u32 v13, v15, v13
    v_and_b32 v20, 31, v0
    v_lshrrev_b32 v122, 5, v0
    v_and_b32 v123, 7, v0
    v_xor_b32 v122, v122, v123
    v_lshlrev_b32 v122, 4, v122
    v_lshl_add_u32 v20, v20, 8, v122
    s_lshl_b32 s68, s45, 13
    s_add_u32 s68, s68, 98304
    v_add_u32 v20, s68, v20
    v_xor_b32 v21, 32, v20
    v_xor_b32 v22, 64, v20
    v_xor_b32 v23, 96, v20
    s_setprio 0
    ds_read_b64_tr_b16 v[128:129], v12 offset:2048
    ds_read_b64_tr_b16 v[130:131], v12 offset:3072
    ds_read_b64_tr_b16 v[132:133], v13 offset:2048
    ds_read_b64_tr_b16 v[134:135], v13 offset:3072
    ds_write_b128 v20, v[100:103] offset:32768
    ds_read_b64_tr_b16 v[136:137], v12 offset:6144
    ds_read_b64_tr_b16 v[138:139], v12 offset:7168
    ds_read_b64_tr_b16 v[140:141], v13 offset:6144
    ds_read_b64_tr_b16 v[142:143], v13 offset:7168
    ds_write_b128 v21, v[104:107] offset:32768
    ds_read_b64_tr_b16 v[144:145], v12 offset:10240
    ds_read_b64_tr_b16 v[146:147], v12 offset:11264
    ds_read_b64_tr_b16 v[148:149], v13 offset:10240
    ds_read_b64_tr_b16 v[150:151], v13 offset:11264
    ds_write_b128 v22, v[108:111] offset:32768
    ds_read_b64_tr_b16 v[152:153], v12 offset:14336
    ds_read_b64_tr_b16 v[154:155], v12 offset:15360
    ds_read_b64_tr_b16 v[156:157], v13 offset:14336
    ds_read_b64_tr_b16 v[158:159], v13 offset:15360
    ds_write_b128 v23, v[112:115] offset:32768
    ds_read_b64_tr_b16 v[160:161], v12 offset:0
    ds_read_b64_tr_b16 v[162:163], v12 offset:1024
    ds_read_b64_tr_b16 v[164:165], v13 offset:0
    ds_read_b64_tr_b16 v[166:167], v13 offset:1024
    ds_write_b128 v20, v[224:227] offset:32896
    ds_read_b64_tr_b16 v[168:169], v12 offset:4096
    ds_read_b64_tr_b16 v[170:171], v12 offset:5120
    ds_read_b64_tr_b16 v[172:173], v13 offset:4096
    ds_read_b64_tr_b16 v[174:175], v13 offset:5120
    ds_write_b128 v21, v[228:231] offset:32896
    ds_read_b64_tr_b16 v[176:177], v12 offset:8192
    ds_read_b64_tr_b16 v[178:179], v12 offset:9216
    ds_read_b64_tr_b16 v[180:181], v13 offset:8192
    ds_read_b64_tr_b16 v[182:183], v13 offset:9216
    ds_write_b128 v22, v[232:235] offset:32896
    ds_read_b64_tr_b16 v[184:185], v12 offset:12288
    ds_read_b64_tr_b16 v[186:187], v12 offset:13312
    ds_read_b64_tr_b16 v[188:189], v13 offset:12288
    ds_read_b64_tr_b16 v[190:191], v13 offset:13312
    ds_write_b128 v23, v[236:239] offset:32896
    s_waitcnt lgkmcnt(0)
    s_barrier
    buffer_load_dwordx4 v[240:243], v1, s[16:19], s4 offen offset:1024 sc1
    buffer_load_dwordx4 v[244:247], v1, s[16:19], s4 offen offset:3072 sc1
    buffer_load_dwordx4 v[248:251], v1, s[16:19], s5 offen offset:1024 sc1
    buffer_load_dwordx4 v[252:255], v1, s[16:19], s5 offen offset:3072 sc1
    v_lshrrev_b32 v122, 3, v0
    v_lshlrev_b32 v25, 4, v123
    v_lshl_add_u32 v25, v122, 10, v25
    v_lshlrev_b32 v123, 1, v123
    v_xor_b32 v123, v123, v122
    v_lshlrev_b32 v123, 4, v123
    v_lshl_add_u32 v123, v122, 8, v123
    s_and_b32 s70, s44, 1
    s_lshl_b32 s70, s70, 2
    s_add_u32 s70, s70, s69
    s_lshl_b32 s71, s70, 11
    v_add_u32 v120, s71, v123
    v_xor_b32 v121, 16, v120
    v_xor_b32 v26, 139264, v120
    v_xor_b32 v27, 139264, v121
    ds_read_b128 v[192:195], v26 offset:0
    ds_read_b128 v[196:199], v27 offset:0
    ds_read_b128 v[200:203], v26 offset:16384
    ds_read_b128 v[204:207], v27 offset:16384
    v_xor_b32 v28, 8192, v120
    v_add_u32 v30, 98304, v120
    v_xor_b32 v29, 8192, v121
    v_add_u32 v31, 98304, v121
    s_lshl_b32 s68, s49, 3
    s_add_u32 s68, s68, s70
    s_lshl_b32 s68, s68, 13
    s_lshl_b32 s69, s50, 7
    s_add_u32 s68, s68, s69
    s_barrier
    s_waitcnt vmcnt(2)
    v_max3_u32 v14, v240, v241, v242
    v_max3_u32 v15, v243, v244, v245
    v_max3_u32 v14, v14, v246, v247
    v_max_u32 v14, v14, v15
    v_cmp_eq_u32 vcc, -1, v14
    s_cbranch_vccnz Lo0r_36
Lo0c_37:
    v_mfma_f32_32x32x16_bf16 v[68:83], v[128:131], v[240:243], v[68:83]
    v_mfma_f32_32x32x16_bf16 v[68:83], v[136:139], v[244:247], v[68:83]
    v_mfma_f32_32x32x16_bf16 v[84:99], v[132:135], v[240:243], v[84:99]
    v_mfma_f32_32x32x16_bf16 v[84:99], v[140:143], v[244:247], v[84:99]
    s_waitcnt vmcnt(0)
    v_max3_u32 v14, v248, v249, v250
    v_max3_u32 v15, v251, v252, v253
    v_max3_u32 v14, v14, v254, v255
    v_max_u32 v14, v14, v15
    v_cmp_eq_u32 vcc, -1, v14
    s_cbranch_vccnz Lo1r_38
Lo1c_39:
    v_mfma_f32_32x32x16_bf16 v[68:83], v[144:147], v[248:251], v[68:83]
    v_mfma_f32_32x32x16_bf16 v[68:83], v[152:155], v[252:255], v[68:83]
    v_mfma_f32_32x32x16_bf16 v[84:99], v[148:151], v[248:251], v[84:99]
    v_mfma_f32_32x32x16_bf16 v[84:99], v[156:159], v[252:255], v[84:99]
    buffer_load_dwordx4 v[52:55], v1, s[16:19], s4 offen offset:0 sc1
    buffer_load_dwordx4 v[56:59], v1, s[16:19], s4 offen offset:2048 sc1
    buffer_load_dwordx4 v[60:63], v1, s[16:19], s5 offen offset:0 sc1
    buffer_load_dwordx4 v[64:67], v1, s[16:19], s5 offen offset:2048 sc1
    s_waitcnt vmcnt(2)
    v_max3_u32 v14, v52, v53, v54
    v_max3_u32 v15, v55, v56, v57
    v_max3_u32 v14, v14, v58, v59
    v_max_u32 v14, v14, v15
    v_cmp_eq_u32 vcc, -1, v14
    s_cbranch_vccnz Lo2r_40
Lo2c_41:
    v_mfma_f32_32x32x16_bf16 v[68:83], v[160:163], v[52:55], v[68:83]
    v_mfma_f32_32x32x16_bf16 v[68:83], v[168:171], v[56:59], v[68:83]
    v_mfma_f32_32x32x16_bf16 v[84:99], v[164:167], v[52:55], v[84:99]
    v_mfma_f32_32x32x16_bf16 v[84:99], v[172:175], v[56:59], v[84:99]
    s_waitcnt vmcnt(0)
    v_max3_u32 v14, v60, v61, v62
    v_max3_u32 v15, v63, v64, v65
    v_max3_u32 v14, v14, v66, v67
    v_max_u32 v14, v14, v15
    v_cmp_eq_u32 vcc, -1, v14
    s_cbranch_vccnz Lo3r_42
Lo3c_43:
    v_mfma_f32_32x32x16_bf16 v[68:83], v[176:179], v[60:63], v[68:83]
    s_waitcnt lgkmcnt(0)
    v_add_f32 v192, v192, v200
    v_add_f32 v193, v193, v201
    v_mfma_f32_32x32x16_bf16 v[68:83], v[184:187], v[64:67], v[68:83]
    v_add_f32 v194, v194, v202
    v_add_f32 v195, v195, v203
    v_mfma_f32_32x32x16_bf16 v[84:99], v[180:183], v[60:63], v[84:99]
    v_add_f32 v196, v196, v204
    v_add_f32 v197, v197, v205
    v_mfma_f32_32x32x16_bf16 v[84:99], v[188:191], v[64:67], v[84:99]
    v_add_f32 v198, v198, v206
    v_add_f32 v199, v199, v207
    s_nop 3
    ds_write_b128 v20, v[68:71] offset:0
    ds_write_b128 v21, v[72:75] offset:0
    ds_write_b128 v22, v[76:79] offset:0
    ds_write_b128 v23, v[80:83] offset:0
    s_nop 1
    ds_write_b128 v20, v[84:87] offset:128
    ds_write_b128 v21, v[88:91] offset:128
    ds_write_b128 v22, v[92:95] offset:128
    ds_write_b128 v23, v[96:99] offset:128
    s_waitcnt lgkmcnt(0)
    s_branch Ltail2
Lnonr_1:
    s_mov_b32 s84, 400000
Lnonl_44:
    s_sleep 2
    buffer_load_dwordx2 v[116:117], off, s[36:39], 0 sc1
    s_waitcnt vmcnt(0)
    v_cmp_eq_u32 vcc, 0, v117
    s_cbranch_vccz Lnonc_2
    s_sub_u32 s84, s84, 1
    s_cbranch_scc0 Lnonl_44
    s_branch Lnonc_2
Lnonr_8:
    s_mov_b32 s84, 400000
Lnonl_45:
    s_sleep 2
    buffer_load_dwordx2 v[116:117], off, s[36:39], 0 sc1
    s_waitcnt vmcnt(0)
    v_cmp_eq_u32 vcc, 0, v117
    s_cbranch_vccz Lnonc_9
    s_sub_u32 s84, s84, 1
    s_cbranch_scc0 Lnonl_45
    s_branch Lnonc_9
Lnonr_15:
    s_mov_b32 s84, 400000
Lnonl_46:
    s_sleep 2
    buffer_load_dwordx2 v[116:117], off, s[36:39], 0 sc1
    s_waitcnt vmcnt(0)
    v_cmp_eq_u32 vcc, 0, v117
    s_cbranch_vccz Lnonc_16
    s_sub_u32 s84, s84, 1
    s_cbranch_scc0 Lnonl_46
    s_branch Lnonc_16
Llate:
    s_mov_b64 exec, 0xff
    buffer_load_dwordx2 v[14:15], v6, s[16:19], 0 offen sc1
    s_waitcnt vmcnt(0)
    v_cmp_ne_u64 vcc, s[58:59], v[14:15]
    s_cbranch_vccnz Lp1r_47
Lp1c_48:
    s_mov_b64 exec, -1
    buffer_load_dwordx4 v[116:119], v124, s[16:19], s62 offen sc1
    s_mov_b64 exec, s[66:67]
    buffer_load_dwordx4 v[36:39], v125, s[16:19], s62 offen offset:1024 sc1
    buffer_load_dwordx4 v[40:43], v125, s[16:19], s62 offen offset:1536 sc1
    s_mov_b64 exec, -1
    s_addk_i32 s62, 2048
    s_bitset0_b32 s62, 15
    buffer_load_dwordx4 v[120:123], v124, s[16:19], s62 offen sc1
    s_mov_b64 exec, s[66:67]
    buffer_load_dwordx4 v[44:47], v125, s[16:19], s62 offen offset:1024 sc1
    buffer_load_dwordx4 v[48:51], v125, s[16:19], s62 offen offset:1536 sc1
    s_mov_b64 exec, -1
    s_addk_i32 s62, 2048
    s_bitset0_b32 s62, 15
    s_waitcnt vmcnt(0)
    s_branch Llate_done
Lp2r_24:
    s_mov_b32 s84, 400000
Lp2l_49:
    s_sleep 8
    buffer_load_dwordx2 v[14:15], v6, s[16:19], 0 offen sc1
    s_waitcnt vmcnt(0)
    v_cmp_ne_u64 vcc, s[58:59], v[14:15]
    s_cbranch_vccz Lp2c_25
    s_sub_u32 s84, s84, 1
    s_cbranch_scc0 Lp2l_49
    s_branch Lp2c_25
Lsafe:
    s_and_b32 s70, s61, 4294868991
    s_mov_b32 s71, s70
    s_mov_b32 s72, 64
    v_mov_b32 v128, 0xff800000
Lsafe1:
    buffer_load_dwordx4 v[116:119], v1, s[16:19], s71 offen sc1
    s_add_u32 s71, s71, 2048
    s_waitcnt vmcnt(0)
    v_mfma_f32_32x32x16_bf16 v[52:67], v[116:119], v[204:207], 0
    s_nop 11
    v_max3_f32 v128, v128, v52, v53
    v_max3_f32 v128, v128, v54, v55
    v_max3_f32 v128, v128, v56, v57
    v_max3_f32 v128, v128, v58, v59
    v_max3_f32 v128, v128, v60, v61
    v_max3_f32 v128, v128, v62, v63
    v_max3_f32 v128, v128, v64, v65
    v_max3_f32 v128, v128, v66, v67
    s_sub_u32 s72, s72, 1
    s_cmp_lg_u32 s72, 0
    s_cbranch_scc1 Lsafe1
    v_mov_b32 v129, v128
    s_nop 1
    v_permlane32_swap_b32 v128, v129
    v_max_f32 v128, v128, v129
    v_sub_f32 v128, 0, v128
    v_mov_b32 v129, v128
    v_mov_b32 v130, v128
    v_mov_b32 v131, v128
    v_mov_b32 v132, v128
    v_mov_b32 v133, v128
    v_mov_b32 v134, v128
    v_mov_b32 v135, v128
    v_mov_b32 v136, v128
    v_mov_b32 v137, v128
    v_mov_b32 v138, v128
    v_mov_b32 v139, v128
    v_mov_b32 v140, v128
    v_mov_b32 v141, v128
    v_mov_b32 v142, v128
    v_mov_b32 v143, v128
    v_mov_b32 v176, 0
    v_mov_b32 v177, 0
    v_mov_b32 v178, 0
    v_mov_b32 v179, 0
    v_mov_b32 v180, 0
    v_mov_b32 v181, 0
    v_mov_b32 v182, 0
    v_mov_b32 v183, 0
    v_mov_b32 v184, 0
    v_mov_b32 v185, 0
    v_mov_b32 v186, 0
    v_mov_b32 v187, 0
    v_mov_b32 v188, 0
    v_mov_b32 v189, 0
    v_mov_b32 v190, 0
    v_mov_b32 v191, 0
    s_mov_b32 s71, s70
    s_mov_b32 s72, 64
Lsafe2:
    buffer_load_dwordx4 v[116:119], v1, s[16:19], s71 offen sc1
    s_mov_b64 exec, s[66:67]
    buffer_load_dwordx4 v[36:39], v127, s[16:19], s71 offen offset:1024 sc1
    buffer_load_dwordx4 v[40:43], v127, s[16:19], s71 offen offset:1536 sc1
    s_mov_b64 exec, -1
    s_add_u32 s71, s71, 2048
    s_waitcnt vmcnt(0)
    v_mfma_f32_32x32x16_bf16 v[52:67], v[116:119], v[204:207], v[128:143]
    s_nop 11
    v_exp_f32 v52, v52
    v_exp_f32 v53, v53
    v_exp_f32 v54, v54
    v_exp_f32 v55, v55
    v_exp_f32 v56, v56
    v_exp_f32 v57, v57
    v_exp_f32 v58, v58
    v_exp_f32 v59, v59
    v_exp_f32 v60, v60
    v_exp_f32 v61, v61
    v_exp_f32 v62, v62
    v_exp_f32 v63, v63
    v_exp_f32 v64, v64
    v_exp_f32 v65, v65
    v_exp_f32 v66, v66
    v_exp_f32 v67, v67
    v_smfmac_f32_32x32x32_bf16 v[176:191], v[36:39], v[52:59], v126
    s_nop 0
    v_smfmac_f32_32x32x32_bf16 v[176:191], v[40:43], v[60:67], v126
    s_sub_u32 s72, s72, 1
    s_cmp_lg_u32 s72, 0
    s_cbranch_scc1 Lsafe2
    s_nop 15
    v_fma_f32 v156, v184, v24, v184
    v_rcp_f32 v156, v156
    s_cmp_lg_u32 s46, 0
    s_cbranch_scc1 Lsafe_done1
    s_branch Lsafe_done0
Lo0r_26:
    s_mov_b32 s84, 400000
Lo0l_50:
    s_sleep 2
    buffer_load_dwordx4 v[240:243], v1, s[16:19], s4 offen offset:1024 sc1
    buffer_load_dwordx4 v[244:247], v1, s[16:19], s4 offen offset:3072 sc1
    buffer_load_dwordx4 v[248:251], v1, s[16:19], s5 offen offset:1024 sc1
    buffer_load_dwordx4 v[252:255], v1, s[16:19], s5 offen offset:3072 sc1
    s_waitcnt vmcnt(0)
    v_max3_u32 v14, v240, v241, v242
    v_max3_u32 v15, v243, v244, v245
    v_max3_u32 v14, v14, v246, v247
    v_max_u32 v14, v14, v15
    v_cmp_eq_u32 vcc, -1, v14
    s_cbranch_vccz Lo0c_27
    s_sub_u32 s84, s84, 1
    s_cbranch_scc0 Lo0l_50
    s_branch Lo0c_27
Lo1r_28:
    s_mov_b32 s84, 400000
Lo1l_51:
    s_sleep 2
    buffer_load_dwordx4 v[248:251], v1, s[16:19], s5 offen offset:1024 sc1
    buffer_load_dwordx4 v[252:255], v1, s[16:19], s5 offen offset:3072 sc1
    s_waitcnt vmcnt(0)
    v_max3_u32 v14, v248, v249, v250
    v_max3_u32 v15, v251, v252, v253
    v_max3_u32 v14, v14, v254, v255
    v_max_u32 v14, v14, v15
    v_cmp_eq_u32 vcc, -1, v14
    s_cbranch_vccz Lo1c_29
    s_sub_u32 s84, s84, 1
    s_cbranch_scc0 Lo1l_51
    s_branch Lo1c_29
Lo2r_30:
    s_mov_b32 s84, 400000
Lo2l_52:
    s_sleep 2
    buffer_load_dwordx4 v[52:55], v1, s[16:19], s4 offen offset:0 sc1
    buffer_load_dwordx4 v[56:59], v1, s[16:19], s4 offen offset:2048 sc1
    buffer_load_dwordx4 v[60:63], v1, s[16:19], s5 offen offset:0 sc1
    buffer_load_dwordx4 v[64:67], v1, s[16:19], s5 offen offset:2048 sc1
    s_waitcnt vmcnt(0)
    v_max3_u32 v14, v52, v53, v54
    v_max3_u32 v15, v55, v56, v57
    v_max3_u32 v14, v14, v58, v59
    v_max_u32 v14, v14, v15
    v_cmp_eq_u32 vcc, -1, v14
    s_cbranch_vccz Lo2c_31
    s_sub_u32 s84, s84, 1
    s_cbranch_scc0 Lo2l_52
    s_branch Lo2c_31
Lo3r_32:
    s_mov_b32 s84, 400000
Lo3l_53:
    s_sleep 2
    buffer_load_dwordx4 v[60:63], v1, s[16:19], s5 offen offset:0 sc1
    buffer_load_dwordx4 v[64:67], v1, s[16:19], s5 offen offset:2048 sc1
    s_waitcnt vmcnt(0)
    v_max3_u32 v14, v60, v61, v62
    v_max3_u32 v15, v63, v64, v65
    v_max3_u32 v14, v14, v66, v67
    v_max_u32 v14, v14, v15
    v_cmp_eq_u32 vcc, -1, v14
    s_cbranch_vccz Lo3c_33
    s_sub_u32 s84, s84, 1
    s_cbranch_scc0 Lo3l_53
    s_branch Lo3c_33
Lg1r_34:
    s_mov_b32 s84, 400000
Lg1l_54:
    s_sleep 1
    ds_read_b64 v[14:15], v6
    s_waitcnt lgkmcnt(0)
    s_waitcnt vmcnt(0)
    v_add_u32 v14, v14, v15
    v_cmp_ne_u32 vcc, 12, v14
    s_cbranch_vccz Lg1c_35
    s_sub_u32 s84, s84, 1
    s_cbranch_scc0 Lg1l_54
    s_branch Lg1c_35
Lo0r_36:
    s_mov_b32 s84, 400000
Lo0l_55:
    s_sleep 2
    buffer_load_dwordx4 v[240:243], v1, s[16:19], s4 offen offset:1024 sc1
    buffer_load_dwordx4 v[244:247], v1, s[16:19], s4 offen offset:3072 sc1
    buffer_load_dwordx4 v[248:251], v1, s[16:19], s5 offen offset:1024 sc1
    buffer_load_dwordx4 v[252:255], v1, s[16:19], s5 offen offset:3072 sc1
    s_waitcnt vmcnt(0)
    v_max3_u32 v14, v240, v241, v242
    v_max3_u32 v15, v243, v244, v245
    v_max3_u32 v14, v14, v246, v247
    v_max_u32 v14, v14, v15
    v_cmp_eq_u32 vcc, -1, v14
    s_cbranch_vccz Lo0c_37
    s_sub_u32 s84, s84, 1
    s_cbranch_scc0 Lo0l_55
    s_branch Lo0c_37
Lo1r_38:
    s_mov_b32 s84, 400000
Lo1l_56:
    s_sleep 2
    buffer_load_dwordx4 v[248:251], v1, s[16:19], s5 offen offset:1024 sc1
    buffer_load_dwordx4 v[252:255], v1, s[16:19], s5 offen offset:3072 sc1
    s_waitcnt vmcnt(0)
    v_max3_u32 v14, v248, v249, v250
    v_max3_u32 v15, v251, v252, v253
    v_max3_u32 v14, v14, v254, v255
    v_max_u32 v14, v14, v15
    v_cmp_eq_u32 vcc, -1, v14
    s_cbranch_vccz Lo1c_39
    s_sub_u32 s84, s84, 1
    s_cbranch_scc0 Lo1l_56
    s_branch Lo1c_39
Lo2r_40:
    s_mov_b32 s84, 400000
Lo2l_57:
    s_sleep 2
    buffer_load_dwordx4 v[52:55], v1, s[16:19], s4 offen offset:0 sc1
    buffer_load_dwordx4 v[56:59], v1, s[16:19], s4 offen offset:2048 sc1
    buffer_load_dwordx4 v[60:63], v1, s[16:19], s5 offen offset:0 sc1
    buffer_load_dwordx4 v[64:67], v1, s[16:19], s5 offen offset:2048 sc1
    s_waitcnt vmcnt(0)
    v_max3_u32 v14, v52, v53, v54
    v_max3_u32 v15, v55, v56, v57
    v_max3_u32 v14, v14, v58, v59
    v_max_u32 v14, v14, v15
    v_cmp_eq_u32 vcc, -1, v14
    s_cbranch_vccz Lo2c_41
    s_sub_u32 s84, s84, 1
    s_cbranch_scc0 Lo2l_57
    s_branch Lo2c_41
Lo3r_42:
    s_mov_b32 s84, 400000
Lo3l_58:
    s_sleep 2
    buffer_load_dwordx4 v[60:63], v1, s[16:19], s5 offen offset:0 sc1
    buffer_load_dwordx4 v[64:67], v1, s[16:19], s5 offen offset:2048 sc1
    s_waitcnt vmcnt(0)
    v_max3_u32 v14, v60, v61, v62
    v_max3_u32 v15, v63, v64, v65
    v_max3_u32 v14, v14, v66, v67
    v_max_u32 v14, v14, v15
    v_cmp_eq_u32 vcc, -1, v14
    s_cbranch_vccz Lo3c_43
    s_sub_u32 s84, s84, 1
    s_cbranch_scc0 Lo3l_58
    s_branch Lo3c_43
Lp1r_47:
    s_mov_b32 s84, 400000
Lp1l_59:
    s_sleep 4
    buffer_load_dwordx2 v[14:15], v6, s[16:19], 0 offen sc1
    s_waitcnt vmcnt(0)
    v_cmp_ne_u64 vcc, s[58:59], v[14:15]
    s_cbranch_vccz Lp1c_48
    s_sub_u32 s84, s84, 1
    s_cbranch_scc0 Lp1l_59
    s_branch Lp1c_48
Lcode_end:

.section .rodata,"a"
.p2align 6
.amdhsa_kernel gated_mix__softmax_full_mha__glu_gated_geglu__prompt_kernel
  .amdhsa_next_free_vgpr 256
  .amdhsa_next_free_sgpr 102
  .amdhsa_accum_offset 256
  .amdhsa_group_segment_fixed_size 0
  .amdhsa_kernarg_size 88
  .amdhsa_user_sgpr_count 2
  .amdhsa_user_sgpr_kernarg_segment_ptr 1
  .amdhsa_system_sgpr_workgroup_id_x 1
.end_amdhsa_kernel
```
